```python
import torch

def _softmax(x, axis=-1):
    return torch.softmax(x, dim=axis)

def _gelu(x):
    return torch.nn.functional.gelu(x, approximate='tanh')

def _silu(x):
    return torch.nn.functional.silu(x)

def _sigmoid(x):
    return torch.sigmoid(x)

def _layernorm(x, axis=-1, eps=1e-05):
    m = x.mean(dim=axis, keepdim=True)
    v = x.var(dim=axis, keepdim=True, unbiased=False)
    return (x - m) / torch.sqrt(v + eps)

def _scatter_add(tgt, idx, src, axis=0):
    return tgt.clone().index_add_(axis, idx, src)

def _segment_sum(src, seg, n):
    out = torch.zeros((n,) + src.shape[1:], dtype=src.dtype)
    return out.index_add_(0, seg, src)

def _pad(x, pw):
    flat = tuple((v for pair in reversed(pw) for v in pair))
    return torch.nn.functional.pad(x, flat)
kernel_name = 'gated_mix__memory_aug_recurrent_mem_tr__glu_gated_geglu__prompt'

def setup_inputs():

    _w = lambda a: (lambda t: t.to(torch.bfloat16) if t.is_floating_point() else t)(torch.as_tensor(a))

    def _A_setup():
        B, S, Dm = (1, 2048, 640)
        H, Dh = (32, 128)
        M, seg = (8, 32)
        seg = min(seg, S)
        S = S // seg * seg
        return {'x': _w((lambda *s: torch.randn(*s, dtype=torch.bfloat16) * 0.05)(B, S, Dm)), 'mem0': _w((lambda *s: torch.randn(*s, dtype=torch.bfloat16) * 0.4)(B, M, Dm)), 'Wq': _w((lambda *s: torch.randn(*s, dtype=torch.bfloat16) * 6.4)(Dm, H, Dh) * Dm ** (-0.5)), 'Wk': _w((lambda *s: torch.randn(*s, dtype=torch.bfloat16) * 6.4)(Dm, H, Dh) * Dm ** (-0.5)), 'Wv': _w((lambda *s: torch.randn(*s, dtype=torch.bfloat16) * 0.4)(Dm, H, Dh) * Dm ** (-0.5)), 'Wo': _w((lambda *s: torch.randn(*s, dtype=torch.bfloat16) * 0.4)(H, Dh, Dm) * (H * Dh) ** (-0.5)), 'seg_len': seg}
    _A_in = _A_setup()

    def _B_setup():
        B, S, Dm, Df = (1, 2048, 640, 1728)
        return {'x': _w((lambda *s: torch.randn(*s, dtype=torch.bfloat16) * 0.05)(B, S, Dm)), 'w_gate': _w((lambda *s: torch.randn(*s, dtype=torch.bfloat16) * 1.6)(Dm, Df) * Dm ** (-0.5)), 'w_up': _w((lambda *s: torch.randn(*s, dtype=torch.bfloat16) * 1.6)(Dm, Df) * Dm ** (-0.5)), 'w_down': _w((lambda *s: torch.randn(*s, dtype=torch.bfloat16) * 1.6)(Df, Dm) * Df ** (-0.5))}
    _B_in = _B_setup()
    return {'A_x': _A_in['x'], 'A_mem0': _A_in['mem0'], 'A_Wq': _A_in['Wq'], 'A_Wk': _A_in['Wk'], 'A_Wv': _A_in['Wv'], 'A_Wo': _A_in['Wo'], 'A_seg_len': _A_in['seg_len'], 'B_x': _B_in['x'], 'B_w_gate': _B_in['w_gate'], 'B_w_up': _B_in['w_up'], 'B_w_down': _B_in['w_down'], 'gate_w': _w((lambda *s: torch.randn(*s, dtype=torch.bfloat16) * 0.05)(640) * 16.0)}

def reference(A_x, A_mem0, A_Wq, A_Wk, A_Wv, A_Wo, A_seg_len, B_x, B_w_gate, B_w_up, B_w_down, gate_w):

    def _A_ref(x, mem0, Wq, Wk, Wv, Wo, seg_len):
        B, S, Dm = x.shape
        H, Dh = (Wq.shape[1], Wq.shape[2])
        M = mem0.shape[1]
        scale = Dh ** (-0.5)
        n_seg = S // seg_len
        L = M + seg_len
        idx = torch.arange(L)
        mask = (idx[:, None] < M) | (idx[:, None] >= idx[None, :])
        mem = mem0
        outs = []
        for s in range(n_seg):
            xs = x[:, s * seg_len:(s + 1) * seg_len, :].clone()
            h = torch.concatenate([mem, xs], axis=1)
            q = torch.einsum('btd,dhe->bhte', h, Wq)
            k = torch.einsum('btd,dhe->bhte', h, Wk)
            v = torch.einsum('btd,dhe->bhte', h, Wv)
            scores = torch.einsum('bhqe,bhke->bhqk', q, k) * scale
            scores = torch.where(mask[None, None], scores, -1000000000.0)
            p = _softmax(scores, axis=-1)
            o = torch.einsum('bhqk,bhke->bhqe', p, v)
            o = torch.einsum('bhte,hed->btd', o, Wo)
            mem = o[:, :M, :].clone()
            outs.append(o[:, M:, :])
        return torch.concatenate(outs, axis=1)

    def _B_ref(x, w_gate, w_up, w_down):
        g = torch.einsum('bsd,df->bsf', x, w_gate)
        u = torch.einsum('bsd,df->bsf', x, w_up)
        h = _gelu(g) * u
        return torch.einsum('bsf,fd->bsd', h, w_down)
    x = A_x
    g = _sigmoid((x * gate_w).sum(-1, keepdims=True))
    a = _A_ref(x, A_mem0, A_Wq, A_Wk, A_Wv, A_Wo, A_seg_len)
    b = _B_ref(x, B_w_gate, B_w_up, B_w_down)
    return g * a + (1 - g) * b
```

```asm
; @launch kernel=chain_kernel grid=(256,1,1) block=(256,1,1) lds=163840
.amdgcn_target "amdgcn-amd-amdhsa--gfx950"
.text
.globl chain_kernel
.p2align 8
.type chain_kernel,@function
chain_kernel:
    s_cmp_ge_u32 s2, 256
    s_cbranch_scc1 L_ch_done
    s_load_dwordx2 s[4:5], s[0:1], 112
    s_load_dwordx2 s[6:7], s[0:1], 104
    s_load_dwordx2 s[52:53], s[0:1], 8
    s_waitcnt lgkmcnt(0)
    s_mov_b32 s8, s4
    s_mov_b32 s9, s5
    s_mov_b32 s10, 268435456
    s_mov_b32 s11, 0x00020000
    s_mov_b32 s12, s6
    s_mov_b32 s13, s7
    s_mov_b32 s14, 256
    s_mov_b32 s15, 0x00020000
    s_mov_b32 s56, s52
    s_mov_b32 s57, s53
    s_mov_b32 s58, 10240
    s_mov_b32 s59, 0x00020000
    v_lshrrev_b32 v1, 6, v0
    s_nop 0
    v_readfirstlane_b32 s16, v1
    v_and_b32 v0, 63, v0
    s_getreg_b32 s34, hwreg(HW_REG_XCC_ID)
    s_and_b32 s34, s34, 15
    s_mov_b32 s93, s34
    s_mov_b32 s94, 0
    s_mov_b32 s95, 0
    s_mov_b32 s99, 0
    s_cmp_lg_u32 s16, 0
    s_cbranch_scc1 L_ch_tk
    s_mov_b64 exec, 1
    v_mov_b32 v3, s34
    v_lshlrev_b32 v3, 2, v3
    v_mov_b32 v4, 1
    buffer_atomic_add v4, v3, s[12:15], 0 offen sc0
    s_waitcnt vmcnt(0)
    v_mov_b32 v3, 69760
    ds_write_b32 v3, v4
    s_waitcnt lgkmcnt(0)
    s_mov_b64 exec, -1
L_ch_tk:
    s_barrier
    v_mov_b32 v3, 69760
    ds_read_b32 v4, v3
    s_waitcnt lgkmcnt(0)
    v_readfirstlane_b32 s35, v4
    s_mov_b32 s30, s2
    s_barrier
    s_cmp_lg_u32 s35, 31
    s_cbranch_scc1 L_ch_tk2
    s_cmp_ge_u32 s34, 2
    s_cbranch_scc1 L_ch_tk2
    s_cmp_lg_u32 s16, 0
    s_cbranch_scc1 L_ch_tk2
    s_mov_b64 exec, 1
    v_mov_b32 v3, 0
    v_mov_b32 v4, 1
    buffer_atomic_add v4, v3, s[12:15], 0 offen offset:128 sc1
    s_mov_b64 exec, -1
L_ch_tk2:
    s_mov_b32 s63, 0
    s_mov_b32 s92, 0
    s_cmp_lt_u32 s34, 2
    s_cselect_b32 s31, 1, 0
    s_cmp_lt_u32 s35, 32
    s_cselect_b32 s18, 1, 0
    s_and_b32 s31, s31, s18
    s_cmp_eq_u32 s31, 1
    s_cbranch_scc1 L_ch_setup
    s_sub_u32 s18, s34, 2
    s_cmp_ge_u32 s18, 6
    s_cbranch_scc1 L_ch_helper1
    s_mul_i32 s17, s35, 6
    s_add_u32 s17, s17, s18
    s_cmp_ge_u32 s17, 128
    s_cbranch_scc1 L_ch_nokv
    s_cmp_lt_u32 s17, 122
    s_cbranch_scc1 L_ch_hkv
    s_cmp_lg_u32 s16, 0
    s_cbranch_scc1 L_ch_hkv
    s_mov_b64 exec, 1
    v_mov_b32 v3, 0
    v_mov_b32 v4, 1
    buffer_atomic_add v4, v3, s[12:15], 0 offen offset:132 sc1
    s_mov_b64 exec, -1
    s_branch L_ch_hkv
L_ch_nokv:
    s_lshl_b32 s18, s35, 4
    s_or_b32 s18, s18, s34
    s_cmp_lg_u32 s18, 498
    s_cbranch_scc1 L_ch_helper1
    s_cmp_lg_u32 s94, 0
    s_cbranch_scc1 L_chd_1_d
    s_load_dwordx2 s[6:7], s[0:1], 104
    s_waitcnt lgkmcnt(0)
    s_mov_b32 s84, s6
    s_mov_b32 s85, s7
    s_mov_b32 s86, 256
    s_mov_b32 s87, 0x00020000
L_chd_1:
    v_mov_b32 v3, 0
    buffer_load_dword v4, v3, s[84:87], 0 offen offset:136 sc1
    s_waitcnt vmcnt(0)
    v_readfirstlane_b32 s7, v4
    s_cmp_ge_u32 s7, 52
    s_cbranch_scc1 L_chd_1_s
    s_sleep 8
    s_branch L_chd_1
L_chd_1_s:
    s_mov_b32 s94, 1
    s_lshl_b32 s7, s2, 2
    s_add_u32 s7, s7, 120599552
    v_mov_b32 v4, s93
    buffer_store_dword v4, v3, s[8:11], s7 offen sc1
L_chd_1_d:
    s_mul_i32 s19, s16, 49152
    s_add_u32 s19, s19, 119537664
    s_add_u32 s31, s19, 49152
    s_mov_b64 exec, 63
    v_lshlrev_b32 v3, 13, v0
    v_and_b32 v4, 2, v0
    v_lshl_add_u32 v3, v4, 11, v3
    v_mov_b32 v5, 0x7fc0dea1
    buffer_atomic_cmpswap v[4:5], v3, s[8:11], s19 offen sc0 sc1
    s_waitcnt vmcnt(0)
    s_mov_b64 exec, 1
    v_mov_b32 v3, 0
    s_mov_b32 s28, -1
    s_mov_b32 s29, -1
L_ch_cal:
    s_memtime s[20:21]
    s_waitcnt lgkmcnt(0)
    buffer_atomic_cmpswap v[4:5], v3, s[8:11], s19 offen sc0 sc1
    s_waitcnt vmcnt(0)
    s_memtime s[22:23]
    s_waitcnt lgkmcnt(0)
    s_sub_u32 s22, s22, s20
    s_min_u32 s28, s28, s22
    s_add_u32 s19, s19, 8192
    s_memtime s[20:21]
    s_waitcnt lgkmcnt(0)
    buffer_atomic_cmpswap v[4:5], v3, s[8:11], s19 offen sc0 sc1
    s_waitcnt vmcnt(0)
    s_memtime s[22:23]
    s_waitcnt lgkmcnt(0)
    s_sub_u32 s22, s22, s20
    s_min_u32 s29, s29, s22
    s_add_u32 s19, s19, 12288
    s_andn2_b32 s19, s19, 8192
    s_cmp_lt_u32 s19, s31
    s_cbranch_scc1 L_ch_cal
    s_lshl_b32 s18, s16, 3
    s_add_u32 s18, s18, 69776
    v_mov_b32 v6, s18
    v_mov_b32 v4, s28
    v_mov_b32 v5, s29
    ds_write_b64 v6, v[4:5]
    s_waitcnt lgkmcnt(0)
    s_barrier
    s_cmp_lg_u32 s16, 0
    s_cbranch_scc1 L_ch_cald
    ds_read_b128 v[8:11], v6
    ds_read_b128 v[12:15], v6 offset:16
    s_waitcnt lgkmcnt(0)
    v_min3_u32 v8, v8, v10, v12
    v_min_u32 v8, v8, v14
    v_min3_u32 v9, v9, v11, v13
    v_min_u32 v9, v9, v15
    v_cmp_lt_u32 vcc, v9, v8
    s_nop 1
    v_cndmask_b32 v4, 1, 2, vcc
    v_mov_b32 v5, 0
    buffer_atomic_cmpswap v[4:5], v3, s[12:15], 0 offen offset:148 sc1
L_ch_cald:
    s_mov_b64 exec, -1
    s_branch L_ch_helper1
L_ch_setup:
    s_lshr_b32 s36, s35, 1
    s_lshl_b32 s18, s34, 4
    s_add_u32 s36, s36, s18
    s_and_b32 s37, s35, 1
    s_lshr_b32 s38, s35, 3
    s_and_b32 s39, s35, 7
    s_lshl_b32 s40, s34, 2
    s_add_u32 s40, s40, s38
    v_and_b32 v1, 15, v0
    v_lshrrev_b32 v2, 4, v0
    v_cmp_gt_u32 s[20:21], 8, v1
    v_cmp_gt_u32 s[22:23], 8, v0
    v_cmp_gt_u32 s[24:25], 32, v0
    v_cmp_eq_u32 s[26:27], s16, v2
    s_nop 1
    s_and_b64 s[26:27], s[26:27], s[20:21]
    v_lshlrev_b32 v8, 4, v0
    s_load_dwordx2 s[64:65], s[0:1], 16
    s_load_dwordx2 s[68:69], s[0:1], 24
    s_load_dwordx2 s[72:73], s[0:1], 32
    s_load_dwordx2 s[76:77], s[0:1], 40
    s_mov_b32 s66, 5242880
    s_mov_b32 s67, 0x00020000
    s_mov_b32 s70, 5242880
    s_mov_b32 s71, 0x00020000
    s_mov_b32 s74, 5242880
    s_mov_b32 s75, 0x00020000
    s_mov_b32 s78, 5242880
    s_mov_b32 s79, 0x00020000
    v_lshrrev_b32 v24, 1, v1
    v_xor_b32 v24, v24, v2
    v_lshlrev_b32 v24, 5, v24
    v_lshl_add_u32 v24, v2, 13, v24
    v_and_b32 v25, 1, v0
    v_lshl_add_u32 v24, v25, 4, v24
    v_bfe_u32 v26, v0, 1, 2
    v_and_b32 v27, 1, v2
    v_xor_b32 v26, v26, v27
    v_lshlrev_b32 v26, 5, v26
    v_lshrrev_b32 v27, 3, v0
    v_lshl_add_u32 v26, v27, 13, v26
    v_lshl_add_u32 v26, v25, 4, v26
    v_xor_b32 v25, 128, v24
    v_xor_b32 v27, 64, v26
    v_lshrrev_b32 v31, 2, v1
    v_and_b32 v32, 1, v2
    v_lshl_add_u32 v33, v2, 3, v31
    v_and_b32 v34, 3, v1
    v_lshlrev_b32 v34, 3, v34
    v_lshl_add_u32 v28, v32, 2, v31
    s_lshl_b32 s18, s16, 1
    v_xor_b32 v28, s18, v28
    v_lshlrev_b32 v28, 5, v28
    v_lshl_add_u32 v28, v33, 8, v28
    v_add_u32 v28, v28, v34
    v_xor_b32 v29, 32, v28
    v_lshrrev_b32 v30, 3, v1
    v_lshl_add_u32 v30, v32, 1, v30
    v_xor_b32 v30, s16, v30
    v_lshlrev_b32 v30, 5, v30
    v_lshl_add_u32 v30, v33, 7, v30
    v_add_u32 v30, v30, v34
    v_add_u32 v30, 0x8000, v30
    v_lshl_add_u32 v39, v2, 2, v31
    v_mul_u32_u24 v39, 160, v39
    s_mul_i32 s18, s16, 10240
    s_add_u32 s18, s18, 81920
    v_add3_u32 v39, v39, v34, s18
    v_add_u32 v31, 0, v0
    v_mul_u32_u24 v32, 6554, v31
    v_lshrrev_b32 v32, 16, v32
    v_mul_u32_u24 v33, 10, v32
    v_sub_u32 v31, v31, v33
    v_mul_u32_u24 v32, 1280, v32
    v_lshl_add_u32 v34, v31, 4, v32
    v_add_u32 v31, 64, v0
    v_mul_u32_u24 v32, 6554, v31
    v_lshrrev_b32 v32, 16, v32
    v_mul_u32_u24 v33, 10, v32
    v_sub_u32 v31, v31, v33
    v_mul_u32_u24 v32, 1280, v32
    v_lshl_add_u32 v35, v31, 4, v32
    v_subrev_u32 v35, 1024, v35
    v_add_u32 v31, 128, v0
    v_mul_u32_u24 v32, 6554, v31
    v_lshrrev_b32 v32, 16, v32
    v_mul_u32_u24 v33, 10, v32
    v_sub_u32 v31, v31, v33
    v_mul_u32_u24 v32, 1280, v32
    v_lshl_add_u32 v36, v31, 4, v32
    v_subrev_u32 v36, 2048, v36
    v_add_u32 v31, 192, v0
    v_mul_u32_u24 v32, 6554, v31
    v_lshrrev_b32 v32, 16, v32
    v_mul_u32_u24 v33, 10, v32
    v_sub_u32 v31, v31, v33
    v_mul_u32_u24 v32, 1280, v32
    v_lshl_add_u32 v37, v31, 4, v32
    v_subrev_u32 v37, 3072, v37
    v_add_u32 v31, 256, v0
    v_mul_u32_u24 v32, 6554, v31
    v_lshrrev_b32 v32, 16, v32
    v_mul_u32_u24 v33, 10, v32
    v_sub_u32 v31, v31, v33
    v_mul_u32_u24 v32, 1280, v32
    v_lshl_add_u32 v38, v31, 4, v32
    s_lshl_b32 s18, s16, 12
    s_add_u32 s18, s18, 81920
    v_add_u32 v9, s18, v8
    v_add_u32 v10, 49152, v9
    s_lshl_b32 s41, s16, 17
    s_lshl_b32 s18, s36, 8
    s_add_u32 s41, s41, s18
    s_lshl_b32 s18, s37, 7
    s_add_u32 s42, s41, s18
    s_lshl_b32 s18, s40, 2
    s_add_u32 s18, s18, s16
    s_mul_i32 s43, s18, 163840
    s_mul_i32 s18, s39, 160
    s_add_u32 s43, s43, s18
    s_lshl_b32 s45, s16, 12
    s_lshl_b32 s46, s16, 11
    s_mul_i32 s47, s16, 10240
    s_waitcnt lgkmcnt(0)
    s_add_u32 s18, s47, 81920
    s_mov_b32 m0, s18
    s_add_u32 s44, s43, 0
    buffer_load_dwordx4 v34, s[76:79], s44 offen offset:0 lds
    buffer_load_dwordx4 v35, s[76:79], s44 offen offset:1024 lds
    buffer_load_dwordx4 v36, s[76:79], s44 offen offset:2048 lds
    buffer_load_dwordx4 v37, s[76:79], s44 offen offset:3072 lds
    s_add_u32 s18, s18, 4096
    s_mov_b32 m0, s18
    s_nop 0
    buffer_load_dwordx4 v38, s[76:79], s44 offen lds
    s_add_u32 s18, s47, 87040
    s_mov_b32 m0, s18
    s_add_u32 s44, s43, 40960
    buffer_load_dwordx4 v34, s[76:79], s44 offen offset:0 lds
    buffer_load_dwordx4 v35, s[76:79], s44 offen offset:1024 lds
    buffer_load_dwordx4 v36, s[76:79], s44 offen offset:2048 lds
    buffer_load_dwordx4 v37, s[76:79], s44 offen offset:3072 lds
    s_add_u32 s18, s18, 4096
    s_mov_b32 m0, s18
    s_nop 0
    buffer_load_dwordx4 v38, s[76:79], s44 offen lds
    s_add_u32 s18, s47, 122880
    s_mov_b32 m0, s18
    s_add_u32 s44, s43, 81920
    buffer_load_dwordx4 v34, s[76:79], s44 offen offset:0 lds
    buffer_load_dwordx4 v35, s[76:79], s44 offen offset:1024 lds
    buffer_load_dwordx4 v36, s[76:79], s44 offen offset:2048 lds
    buffer_load_dwordx4 v37, s[76:79], s44 offen offset:3072 lds
    s_add_u32 s18, s18, 4096
    s_mov_b32 m0, s18
    s_nop 0
    buffer_load_dwordx4 v38, s[76:79], s44 offen lds
    s_add_u32 s18, s47, 128000
    s_mov_b32 m0, s18
    s_add_u32 s44, s43, 122880
    buffer_load_dwordx4 v34, s[76:79], s44 offen offset:0 lds
    buffer_load_dwordx4 v35, s[76:79], s44 offen offset:1024 lds
    buffer_load_dwordx4 v36, s[76:79], s44 offen offset:2048 lds
    buffer_load_dwordx4 v37, s[76:79], s44 offen offset:3072 lds
    s_add_u32 s18, s18, 4096
    s_mov_b32 m0, s18
    s_nop 0
    buffer_load_dwordx4 v38, s[76:79], s44 offen lds
    s_add_u32 s18, s45, 0
    s_mov_b32 m0, s18
    s_add_u32 s44, s41, 0
    buffer_load_dwordx4 v24, s[64:67], s44 offen offset:0 lds
    s_add_u32 s44, s41, 31744
    buffer_load_dwordx4 v24, s[64:67], s44 offen offset:1024 lds
    s_add_u32 s44, s41, 63488
    buffer_load_dwordx4 v25, s[64:67], s44 offen offset:2048 lds
    s_add_u32 s44, s41, 95232
    buffer_load_dwordx4 v25, s[64:67], s44 offen offset:3072 lds
    s_add_u32 s18, s45, 16384
    s_mov_b32 m0, s18
    s_add_u32 s44, s41, 0
    buffer_load_dwordx4 v24, s[68:71], s44 offen offset:0 lds
    s_add_u32 s44, s41, 31744
    buffer_load_dwordx4 v24, s[68:71], s44 offen offset:1024 lds
    s_add_u32 s44, s41, 63488
    buffer_load_dwordx4 v25, s[68:71], s44 offen offset:2048 lds
    s_add_u32 s44, s41, 95232
    buffer_load_dwordx4 v25, s[68:71], s44 offen offset:3072 lds
    s_add_u32 s18, s46, 32768
    s_mov_b32 m0, s18
    s_add_u32 s44, s42, 0
    buffer_load_dwordx4 v26, s[72:75], s44 offen offset:0 lds
    s_add_u32 s44, s42, 64512
    buffer_load_dwordx4 v27, s[72:75], s44 offen offset:1024 lds
    s_add_u32 s18, s45, 40960
    s_mov_b32 m0, s18
    s_add_u32 s44, s41, 524288
    buffer_load_dwordx4 v24, s[64:67], s44 offen offset:0 lds
    s_add_u32 s44, s41, 556032
    buffer_load_dwordx4 v24, s[64:67], s44 offen offset:1024 lds
    s_add_u32 s44, s41, 587776
    buffer_load_dwordx4 v25, s[64:67], s44 offen offset:2048 lds
    s_add_u32 s44, s41, 619520
    buffer_load_dwordx4 v25, s[64:67], s44 offen offset:3072 lds
    s_add_u32 s18, s45, 57344
    s_mov_b32 m0, s18
    s_add_u32 s44, s41, 524288
    buffer_load_dwordx4 v24, s[68:71], s44 offen offset:0 lds
    s_add_u32 s44, s41, 556032
    buffer_load_dwordx4 v24, s[68:71], s44 offen offset:1024 lds
    s_add_u32 s44, s41, 587776
    buffer_load_dwordx4 v25, s[68:71], s44 offen offset:2048 lds
    s_add_u32 s44, s41, 619520
    buffer_load_dwordx4 v25, s[68:71], s44 offen offset:3072 lds
    s_add_u32 s18, s46, 73728
    s_mov_b32 m0, s18
    s_add_u32 s44, s42, 524288
    buffer_load_dwordx4 v26, s[72:75], s44 offen offset:0 lds
    s_add_u32 s44, s42, 588800
    buffer_load_dwordx4 v27, s[72:75], s44 offen offset:1024 lds
    s_lshl_b32 s18, s35, 2
    s_add_u32 s18, s18, s16
    s_add_u32 s28, s35, 128
    v_and_b32 v12, 7, v0
    v_mul_u32_u24 v14, 1280, v12
    v_lshrrev_b32 v13, 5, v0
    v_lshl_add_u32 v14, v13, 2, v14
    s_lshl_b32 s19, s18, 3
    v_add_u32 v5, s19, v14
    s_lshl_b32 s19, s28, 3
    v_add_u32 v6, s19, v14
    v_lshlrev_b32 v12, 4, v12
    v_lshl_add_u32 v12, v13, 7, v12
    s_lshr_b32 s19, s18, 2
    s_lshl_b32 s19, s19, 8
    v_add_u32 v18, s19, v12
    s_and_b32 s19, s18, 3
    s_lshl_b32 s19, s19, 2
    v_add_u32 v18, s19, v18
    s_lshr_b32 s19, s28, 2
    s_lshl_b32 s19, s19, 8
    v_add_u32 v19, s19, v12
    s_and_b32 s19, s28, 3
    s_lshl_b32 s19, s19, 2
    v_add_u32 v19, s19, v19
    v_and_b32 v13, 1, v2
    v_cmp_eq_u32 vcc, 0, v13
    s_nop 1
    v_cndmask_b32 v19, v19, v18, vcc
    v_cndmask_b32 v6, v6, v5, vcc
    s_and_b64 s[22:23], vcc, s[20:21]
    s_cmp_lg_u32 s16, 0
    s_cbranch_scc1 L_ch_pa
    v_mov_b32 v18, v19
    v_mov_b32 v5, v6
    s_mov_b64 s[22:23], s[20:21]
L_ch_pa:
    v_mov_b32 v7, 0
    s_mov_b32 s96, 0
    s_lshl_b32 s98, s36, 9
    s_add_u32 s98, s98, 120569856
    s_waitcnt vmcnt(30)
    ds_read_b64_tr_b16 v[40:41], v39 offset:0
    ds_read_b64_tr_b16 v[42:43], v39 offset:2560
    ds_read_b64_tr_b16 v[44:45], v39 offset:32
    ds_read_b64_tr_b16 v[46:47], v39 offset:2592
    ds_read_b64_tr_b16 v[48:49], v39 offset:64
    ds_read_b64_tr_b16 v[50:51], v39 offset:2624
    ds_read_b64_tr_b16 v[52:53], v39 offset:96
    ds_read_b64_tr_b16 v[54:55], v39 offset:2656
    ds_read_b64_tr_b16 v[56:57], v39 offset:128
    ds_read_b64_tr_b16 v[58:59], v39 offset:2688
    ds_read_b64_tr_b16 v[60:61], v39 offset:5120
    ds_read_b64_tr_b16 v[62:63], v39 offset:7680
    ds_read_b64_tr_b16 v[64:65], v39 offset:5152
    ds_read_b64_tr_b16 v[66:67], v39 offset:7712
    ds_read_b64_tr_b16 v[68:69], v39 offset:5184
    ds_read_b64_tr_b16 v[70:71], v39 offset:7744
    ds_read_b64_tr_b16 v[72:73], v39 offset:5216
    ds_read_b64_tr_b16 v[74:75], v39 offset:7776
    ds_read_b64_tr_b16 v[76:77], v39 offset:5248
    ds_read_b64_tr_b16 v[78:79], v39 offset:7808
    s_waitcnt lgkmcnt(0)
    s_barrier
    s_add_u32 s18, s45, 81920
    s_mov_b32 m0, s18
    s_add_u32 s44, s41, 1048576
    buffer_load_dwordx4 v24, s[64:67], s44 offen offset:0 lds
    s_add_u32 s44, s41, 1080320
    buffer_load_dwordx4 v24, s[64:67], s44 offen offset:1024 lds
    s_add_u32 s44, s41, 1112064
    buffer_load_dwordx4 v25, s[64:67], s44 offen offset:2048 lds
    s_add_u32 s44, s41, 1143808
    buffer_load_dwordx4 v25, s[64:67], s44 offen offset:3072 lds
    s_add_u32 s18, s45, 98304
    s_mov_b32 m0, s18
    s_add_u32 s44, s41, 1048576
    buffer_load_dwordx4 v24, s[68:71], s44 offen offset:0 lds
    s_add_u32 s44, s41, 1080320
    buffer_load_dwordx4 v24, s[68:71], s44 offen offset:1024 lds
    s_add_u32 s44, s41, 1112064
    buffer_load_dwordx4 v25, s[68:71], s44 offen offset:2048 lds
    s_add_u32 s44, s41, 1143808
    buffer_load_dwordx4 v25, s[68:71], s44 offen offset:3072 lds
    s_add_u32 s18, s46, 114688
    s_mov_b32 m0, s18
    s_add_u32 s44, s42, 1048576
    buffer_load_dwordx4 v26, s[72:75], s44 offen offset:0 lds
    s_add_u32 s44, s42, 1113088
    buffer_load_dwordx4 v27, s[72:75], s44 offen offset:1024 lds
    s_waitcnt vmcnt(30)
    ds_read_b64_tr_b16 v[80:81], v39 offset:40960
    ds_read_b64_tr_b16 v[82:83], v39 offset:43520
    ds_read_b64_tr_b16 v[84:85], v39 offset:40992
    ds_read_b64_tr_b16 v[86:87], v39 offset:43552
    ds_read_b64_tr_b16 v[88:89], v39 offset:41024
    ds_read_b64_tr_b16 v[90:91], v39 offset:43584
    ds_read_b64_tr_b16 v[92:93], v39 offset:41056
    ds_read_b64_tr_b16 v[94:95], v39 offset:43616
    ds_read_b64_tr_b16 a[240:241], v39 offset:41088
    ds_read_b64_tr_b16 a[242:243], v39 offset:43648
    ds_read_b64_tr_b16 a[244:245], v39 offset:46080
    ds_read_b64_tr_b16 a[246:247], v39 offset:48640
    ds_read_b64_tr_b16 a[248:249], v39 offset:46112
    ds_read_b64_tr_b16 a[250:251], v39 offset:48672
    ds_read_b64_tr_b16 a[252:253], v39 offset:46144
    ds_read_b64_tr_b16 a[254:255], v39 offset:48704
    ds_read_b64_tr_b16 v[20:21], v39 offset:46176
    ds_read_b64_tr_b16 v[22:23], v39 offset:48736
    ds_read_b64_tr_b16 v[34:35], v39 offset:46208
    ds_read_b64_tr_b16 v[36:37], v39 offset:48768
    s_waitcnt lgkmcnt(0)
    s_barrier
    s_add_u32 s18, s45, 122880
    s_mov_b32 m0, s18
    s_add_u32 s44, s41, 1572864
    buffer_load_dwordx4 v24, s[64:67], s44 offen offset:0 lds
    s_add_u32 s44, s41, 1604608
    buffer_load_dwordx4 v24, s[64:67], s44 offen offset:1024 lds
    s_add_u32 s44, s41, 1636352
    buffer_load_dwordx4 v25, s[64:67], s44 offen offset:2048 lds
    s_add_u32 s44, s41, 1668096
    buffer_load_dwordx4 v25, s[64:67], s44 offen offset:3072 lds
    s_add_u32 s18, s45, 139264
    s_mov_b32 m0, s18
    s_add_u32 s44, s41, 1572864
    buffer_load_dwordx4 v24, s[68:71], s44 offen offset:0 lds
    s_add_u32 s44, s41, 1604608
    buffer_load_dwordx4 v24, s[68:71], s44 offen offset:1024 lds
    s_add_u32 s44, s41, 1636352
    buffer_load_dwordx4 v25, s[68:71], s44 offen offset:2048 lds
    s_add_u32 s44, s41, 1668096
    buffer_load_dwordx4 v25, s[68:71], s44 offen offset:3072 lds
    s_add_u32 s18, s46, 155648
    s_mov_b32 m0, s18
    s_add_u32 s44, s42, 1572864
    buffer_load_dwordx4 v26, s[72:75], s44 offen offset:0 lds
    s_add_u32 s44, s42, 1637376
    buffer_load_dwordx4 v27, s[72:75], s44 offen offset:1024 lds
    v_add_u32 v31, 0, v28
    v_add_u32 v32, 0, v29
    v_add_u32 v33, 0, v30
    s_waitcnt vmcnt(30)
    s_barrier
    ds_read_b64_tr_b16 a[0:1], v31 offset:0
    ds_read_b64_tr_b16 a[80:81], v32 offset:0
    ds_read_b64_tr_b16 a[160:161], v31 offset:16384
    ds_read_b64_tr_b16 v[176:177], v32 offset:16384
    ds_read_b64_tr_b16 v[96:97], v33 offset:0
    ds_read_b64_tr_b16 a[2:3], v31 offset:1024
    ds_read_b64_tr_b16 a[82:83], v32 offset:1024
    ds_read_b64_tr_b16 a[162:163], v31 offset:17408
    ds_read_b64_tr_b16 v[178:179], v32 offset:17408
    ds_read_b64_tr_b16 v[98:99], v33 offset:512
    ds_read_b64_tr_b16 a[4:5], v31 offset:8192
    ds_read_b64_tr_b16 a[84:85], v32 offset:8192
    ds_read_b64_tr_b16 a[164:165], v31 offset:24576
    ds_read_b64_tr_b16 v[180:181], v32 offset:24576
    ds_read_b64_tr_b16 v[100:101], v33 offset:4096
    ds_read_b64_tr_b16 a[6:7], v31 offset:9216
    ds_read_b64_tr_b16 a[86:87], v32 offset:9216
    ds_read_b64_tr_b16 a[166:167], v31 offset:25600
    ds_read_b64_tr_b16 v[182:183], v32 offset:25600
    ds_read_b64_tr_b16 v[102:103], v33 offset:4608
    s_waitcnt lgkmcnt(0)
    s_barrier
    s_add_u32 s18, s45, 0
    s_mov_b32 m0, s18
    s_add_u32 s44, s41, 2097152
    buffer_load_dwordx4 v24, s[64:67], s44 offen offset:0 lds
    s_add_u32 s44, s41, 2128896
    buffer_load_dwordx4 v24, s[64:67], s44 offen offset:1024 lds
    s_add_u32 s44, s41, 2160640
    buffer_load_dwordx4 v25, s[64:67], s44 offen offset:2048 lds
    s_add_u32 s44, s41, 2192384
    buffer_load_dwordx4 v25, s[64:67], s44 offen offset:3072 lds
    s_add_u32 s18, s45, 16384
    s_mov_b32 m0, s18
    s_add_u32 s44, s41, 2097152
    buffer_load_dwordx4 v24, s[68:71], s44 offen offset:0 lds
    s_add_u32 s44, s41, 2128896
    buffer_load_dwordx4 v24, s[68:71], s44 offen offset:1024 lds
    s_add_u32 s44, s41, 2160640
    buffer_load_dwordx4 v25, s[68:71], s44 offen offset:2048 lds
    s_add_u32 s44, s41, 2192384
    buffer_load_dwordx4 v25, s[68:71], s44 offen offset:3072 lds
    s_add_u32 s18, s46, 32768
    s_mov_b32 m0, s18
    s_add_u32 s44, s42, 2097152
    buffer_load_dwordx4 v26, s[72:75], s44 offen offset:0 lds
    s_add_u32 s44, s42, 2161664
    buffer_load_dwordx4 v27, s[72:75], s44 offen offset:1024 lds
    v_add_u32 v31, 40960, v28
    v_add_u32 v32, 40960, v29
    v_add_u32 v33, 40960, v30
    s_waitcnt vmcnt(30)
    s_barrier
    ds_read_b64_tr_b16 a[8:9], v31 offset:0
    ds_read_b64_tr_b16 a[88:89], v32 offset:0
    ds_read_b64_tr_b16 a[168:169], v31 offset:16384
    ds_read_b64_tr_b16 v[184:185], v32 offset:16384
    ds_read_b64_tr_b16 v[104:105], v33 offset:0
    ds_read_b64_tr_b16 a[10:11], v31 offset:1024
    ds_read_b64_tr_b16 a[90:91], v32 offset:1024
    ds_read_b64_tr_b16 a[170:171], v31 offset:17408
    ds_read_b64_tr_b16 v[186:187], v32 offset:17408
    ds_read_b64_tr_b16 v[106:107], v33 offset:512
    ds_read_b64_tr_b16 a[12:13], v31 offset:8192
    ds_read_b64_tr_b16 a[92:93], v32 offset:8192
    ds_read_b64_tr_b16 a[172:173], v31 offset:24576
    ds_read_b64_tr_b16 v[188:189], v32 offset:24576
    ds_read_b64_tr_b16 v[108:109], v33 offset:4096
    ds_read_b64_tr_b16 a[14:15], v31 offset:9216
    ds_read_b64_tr_b16 a[94:95], v32 offset:9216
    ds_read_b64_tr_b16 a[174:175], v31 offset:25600
    ds_read_b64_tr_b16 v[190:191], v32 offset:25600
    ds_read_b64_tr_b16 v[110:111], v33 offset:4608
    s_waitcnt lgkmcnt(0)
    s_barrier
    s_add_u32 s18, s45, 40960
    s_mov_b32 m0, s18
    s_add_u32 s44, s41, 2621440
    buffer_load_dwordx4 v24, s[64:67], s44 offen offset:0 lds
    s_add_u32 s44, s41, 2653184
    buffer_load_dwordx4 v24, s[64:67], s44 offen offset:1024 lds
    s_add_u32 s44, s41, 2684928
    buffer_load_dwordx4 v25, s[64:67], s44 offen offset:2048 lds
    s_add_u32 s44, s41, 2716672
    buffer_load_dwordx4 v25, s[64:67], s44 offen offset:3072 lds
    s_add_u32 s18, s45, 57344
    s_mov_b32 m0, s18
    s_add_u32 s44, s41, 2621440
    buffer_load_dwordx4 v24, s[68:71], s44 offen offset:0 lds
    s_add_u32 s44, s41, 2653184
    buffer_load_dwordx4 v24, s[68:71], s44 offen offset:1024 lds
    s_add_u32 s44, s41, 2684928
    buffer_load_dwordx4 v25, s[68:71], s44 offen offset:2048 lds
    s_add_u32 s44, s41, 2716672
    buffer_load_dwordx4 v25, s[68:71], s44 offen offset:3072 lds
    s_add_u32 s18, s46, 73728
    s_mov_b32 m0, s18
    s_add_u32 s44, s42, 2621440
    buffer_load_dwordx4 v26, s[72:75], s44 offen offset:0 lds
    s_add_u32 s44, s42, 2685952
    buffer_load_dwordx4 v27, s[72:75], s44 offen offset:1024 lds
    v_add_u32 v31, 81920, v28
    v_add_u32 v32, 81920, v29
    v_add_u32 v33, 81920, v30
    s_waitcnt vmcnt(30)
    s_barrier
    ds_read_b64_tr_b16 a[16:17], v31 offset:0
    ds_read_b64_tr_b16 a[96:97], v32 offset:0
    ds_read_b64_tr_b16 a[176:177], v31 offset:16384
    ds_read_b64_tr_b16 v[192:193], v32 offset:16384
    ds_read_b64_tr_b16 v[112:113], v33 offset:0
    ds_read_b64_tr_b16 a[18:19], v31 offset:1024
    ds_read_b64_tr_b16 a[98:99], v32 offset:1024
    ds_read_b64_tr_b16 a[178:179], v31 offset:17408
    ds_read_b64_tr_b16 v[194:195], v32 offset:17408
    ds_read_b64_tr_b16 v[114:115], v33 offset:512
    ds_read_b64_tr_b16 a[20:21], v31 offset:8192
    ds_read_b64_tr_b16 a[100:101], v32 offset:8192
    ds_read_b64_tr_b16 a[180:181], v31 offset:24576
    ds_read_b64_tr_b16 v[196:197], v32 offset:24576
    ds_read_b64_tr_b16 v[116:117], v33 offset:4096
    ds_read_b64_tr_b16 a[22:23], v31 offset:9216
    ds_read_b64_tr_b16 a[102:103], v32 offset:9216
    ds_read_b64_tr_b16 a[182:183], v31 offset:25600
    ds_read_b64_tr_b16 v[198:199], v32 offset:25600
    ds_read_b64_tr_b16 v[118:119], v33 offset:4608
    s_waitcnt lgkmcnt(0)
    s_barrier
    s_add_u32 s18, s45, 81920
    s_mov_b32 m0, s18
    s_add_u32 s44, s41, 3145728
    buffer_load_dwordx4 v24, s[64:67], s44 offen offset:0 lds
    s_add_u32 s44, s41, 3177472
    buffer_load_dwordx4 v24, s[64:67], s44 offen offset:1024 lds
    s_add_u32 s44, s41, 3209216
    buffer_load_dwordx4 v25, s[64:67], s44 offen offset:2048 lds
    s_add_u32 s44, s41, 3240960
    buffer_load_dwordx4 v25, s[64:67], s44 offen offset:3072 lds
    s_add_u32 s18, s45, 98304
    s_mov_b32 m0, s18
    s_add_u32 s44, s41, 3145728
    buffer_load_dwordx4 v24, s[68:71], s44 offen offset:0 lds
    s_add_u32 s44, s41, 3177472
    buffer_load_dwordx4 v24, s[68:71], s44 offen offset:1024 lds
    s_add_u32 s44, s41, 3209216
    buffer_load_dwordx4 v25, s[68:71], s44 offen offset:2048 lds
    s_add_u32 s44, s41, 3240960
    buffer_load_dwordx4 v25, s[68:71], s44 offen offset:3072 lds
    s_add_u32 s18, s46, 114688
    s_mov_b32 m0, s18
    s_add_u32 s44, s42, 3145728
    buffer_load_dwordx4 v26, s[72:75], s44 offen offset:0 lds
    s_add_u32 s44, s42, 3210240
    buffer_load_dwordx4 v27, s[72:75], s44 offen offset:1024 lds
    v_add_u32 v31, 122880, v28
    v_add_u32 v32, 122880, v29
    v_add_u32 v33, 122880, v30
    s_waitcnt vmcnt(30)
    s_barrier
    ds_read_b64_tr_b16 a[24:25], v31 offset:0
    ds_read_b64_tr_b16 a[104:105], v32 offset:0
    ds_read_b64_tr_b16 a[184:185], v31 offset:16384
    ds_read_b64_tr_b16 v[200:201], v32 offset:16384
    ds_read_b64_tr_b16 v[120:121], v33 offset:0
    ds_read_b64_tr_b16 a[26:27], v31 offset:1024
    ds_read_b64_tr_b16 a[106:107], v32 offset:1024
    ds_read_b64_tr_b16 a[186:187], v31 offset:17408
    ds_read_b64_tr_b16 v[202:203], v32 offset:17408
    ds_read_b64_tr_b16 v[122:123], v33 offset:512
    ds_read_b64_tr_b16 a[28:29], v31 offset:8192
    ds_read_b64_tr_b16 a[108:109], v32 offset:8192
    ds_read_b64_tr_b16 a[188:189], v31 offset:24576
    ds_read_b64_tr_b16 v[204:205], v32 offset:24576
    ds_read_b64_tr_b16 v[124:125], v33 offset:4096
    ds_read_b64_tr_b16 a[30:31], v31 offset:9216
    ds_read_b64_tr_b16 a[110:111], v32 offset:9216
    ds_read_b64_tr_b16 a[190:191], v31 offset:25600
    ds_read_b64_tr_b16 v[206:207], v32 offset:25600
    ds_read_b64_tr_b16 v[126:127], v33 offset:4608
    s_waitcnt lgkmcnt(0)
    s_barrier
    s_add_u32 s18, s45, 122880
    s_mov_b32 m0, s18
    s_add_u32 s44, s41, 3670016
    buffer_load_dwordx4 v24, s[64:67], s44 offen offset:0 lds
    s_add_u32 s44, s41, 3701760
    buffer_load_dwordx4 v24, s[64:67], s44 offen offset:1024 lds
    s_add_u32 s44, s41, 3733504
    buffer_load_dwordx4 v25, s[64:67], s44 offen offset:2048 lds
    s_add_u32 s44, s41, 3765248
    buffer_load_dwordx4 v25, s[64:67], s44 offen offset:3072 lds
    s_add_u32 s18, s45, 139264
    s_mov_b32 m0, s18
    s_add_u32 s44, s41, 3670016
    buffer_load_dwordx4 v24, s[68:71], s44 offen offset:0 lds
    s_add_u32 s44, s41, 3701760
    buffer_load_dwordx4 v24, s[68:71], s44 offen offset:1024 lds
    s_add_u32 s44, s41, 3733504
    buffer_load_dwordx4 v25, s[68:71], s44 offen offset:2048 lds
    s_add_u32 s44, s41, 3765248
    buffer_load_dwordx4 v25, s[68:71], s44 offen offset:3072 lds
    s_add_u32 s18, s46, 155648
    s_mov_b32 m0, s18
    s_add_u32 s44, s42, 3670016
    buffer_load_dwordx4 v26, s[72:75], s44 offen offset:0 lds
    s_add_u32 s44, s42, 3734528
    buffer_load_dwordx4 v27, s[72:75], s44 offen offset:1024 lds
    v_add_u32 v31, 0, v28
    v_add_u32 v32, 0, v29
    v_add_u32 v33, 0, v30
    s_waitcnt vmcnt(30)
    s_barrier
    ds_read_b64_tr_b16 a[32:33], v31 offset:0
    ds_read_b64_tr_b16 a[112:113], v32 offset:0
    ds_read_b64_tr_b16 a[192:193], v31 offset:16384
    ds_read_b64_tr_b16 v[208:209], v32 offset:16384
    ds_read_b64_tr_b16 v[128:129], v33 offset:0
    ds_read_b64_tr_b16 a[34:35], v31 offset:1024
    ds_read_b64_tr_b16 a[114:115], v32 offset:1024
    ds_read_b64_tr_b16 a[194:195], v31 offset:17408
    ds_read_b64_tr_b16 v[210:211], v32 offset:17408
    ds_read_b64_tr_b16 v[130:131], v33 offset:512
    ds_read_b64_tr_b16 a[36:37], v31 offset:8192
    ds_read_b64_tr_b16 a[116:117], v32 offset:8192
    ds_read_b64_tr_b16 a[196:197], v31 offset:24576
    ds_read_b64_tr_b16 v[212:213], v32 offset:24576
    ds_read_b64_tr_b16 v[132:133], v33 offset:4096
    ds_read_b64_tr_b16 a[38:39], v31 offset:9216
    ds_read_b64_tr_b16 a[118:119], v32 offset:9216
    ds_read_b64_tr_b16 a[198:199], v31 offset:25600
    ds_read_b64_tr_b16 v[214:215], v32 offset:25600
    ds_read_b64_tr_b16 v[134:135], v33 offset:4608
    s_waitcnt lgkmcnt(0)
    s_barrier
    buffer_load_dwordx4 v[12:15], v7, s[12:15], 0 offen offset:128 sc1
    buffer_load_dword v17, v5, s[56:59], 0 offen
    s_add_u32 s18, s45, 0
    s_mov_b32 m0, s18
    s_add_u32 s44, s41, 4194304
    buffer_load_dwordx4 v24, s[64:67], s44 offen offset:0 lds
    s_add_u32 s44, s41, 4226048
    buffer_load_dwordx4 v24, s[64:67], s44 offen offset:1024 lds
    s_add_u32 s44, s41, 4257792
    buffer_load_dwordx4 v25, s[64:67], s44 offen offset:2048 lds
    s_add_u32 s44, s41, 4289536
    buffer_load_dwordx4 v25, s[64:67], s44 offen offset:3072 lds
    s_add_u32 s18, s45, 16384
    s_mov_b32 m0, s18
    s_add_u32 s44, s41, 4194304
    buffer_load_dwordx4 v24, s[68:71], s44 offen offset:0 lds
    s_add_u32 s44, s41, 4226048
    buffer_load_dwordx4 v24, s[68:71], s44 offen offset:1024 lds
    s_add_u32 s44, s41, 4257792
    buffer_load_dwordx4 v25, s[68:71], s44 offen offset:2048 lds
    s_add_u32 s44, s41, 4289536
    buffer_load_dwordx4 v25, s[68:71], s44 offen offset:3072 lds
    s_add_u32 s18, s46, 32768
    s_mov_b32 m0, s18
    s_add_u32 s44, s42, 4194304
    buffer_load_dwordx4 v26, s[72:75], s44 offen offset:0 lds
    s_add_u32 s44, s42, 4258816
    buffer_load_dwordx4 v27, s[72:75], s44 offen offset:1024 lds
    v_add_u32 v31, 40960, v28
    v_add_u32 v32, 40960, v29
    v_add_u32 v33, 40960, v30
    s_waitcnt vmcnt(32)
    s_barrier
    ds_read_b64_tr_b16 a[40:41], v31 offset:0
    ds_read_b64_tr_b16 a[120:121], v32 offset:0
    ds_read_b64_tr_b16 a[200:201], v31 offset:16384
    ds_read_b64_tr_b16 v[216:217], v32 offset:16384
    ds_read_b64_tr_b16 v[136:137], v33 offset:0
    ds_read_b64_tr_b16 a[42:43], v31 offset:1024
    ds_read_b64_tr_b16 a[122:123], v32 offset:1024
    ds_read_b64_tr_b16 a[202:203], v31 offset:17408
    ds_read_b64_tr_b16 v[218:219], v32 offset:17408
    ds_read_b64_tr_b16 v[138:139], v33 offset:512
    ds_read_b64_tr_b16 a[44:45], v31 offset:8192
    ds_read_b64_tr_b16 a[124:125], v32 offset:8192
    ds_read_b64_tr_b16 a[204:205], v31 offset:24576
    ds_read_b64_tr_b16 v[220:221], v32 offset:24576
    ds_read_b64_tr_b16 v[140:141], v33 offset:4096
    ds_read_b64_tr_b16 a[46:47], v31 offset:9216
    ds_read_b64_tr_b16 a[126:127], v32 offset:9216
    ds_read_b64_tr_b16 a[206:207], v31 offset:25600
    ds_read_b64_tr_b16 v[222:223], v32 offset:25600
    ds_read_b64_tr_b16 v[142:143], v33 offset:4608
    s_waitcnt lgkmcnt(0)
    s_barrier
    s_add_u32 s18, s45, 40960
    s_mov_b32 m0, s18
    s_add_u32 s44, s41, 4718592
    buffer_load_dwordx4 v24, s[64:67], s44 offen offset:0 lds
    s_add_u32 s44, s41, 4750336
    buffer_load_dwordx4 v24, s[64:67], s44 offen offset:1024 lds
    s_add_u32 s44, s41, 4782080
    buffer_load_dwordx4 v25, s[64:67], s44 offen offset:2048 lds
    s_add_u32 s44, s41, 4813824
    buffer_load_dwordx4 v25, s[64:67], s44 offen offset:3072 lds
    s_add_u32 s18, s45, 57344
    s_mov_b32 m0, s18
    s_add_u32 s44, s41, 4718592
    buffer_load_dwordx4 v24, s[68:71], s44 offen offset:0 lds
    s_add_u32 s44, s41, 4750336
    buffer_load_dwordx4 v24, s[68:71], s44 offen offset:1024 lds
    s_add_u32 s44, s41, 4782080
    buffer_load_dwordx4 v25, s[68:71], s44 offen offset:2048 lds
    s_add_u32 s44, s41, 4813824
    buffer_load_dwordx4 v25, s[68:71], s44 offen offset:3072 lds
    s_add_u32 s18, s46, 73728
    s_mov_b32 m0, s18
    s_add_u32 s44, s42, 4718592
    buffer_load_dwordx4 v26, s[72:75], s44 offen offset:0 lds
    s_add_u32 s44, s42, 4783104
    buffer_load_dwordx4 v27, s[72:75], s44 offen offset:1024 lds
    v_add_u32 v31, 81920, v28
    v_add_u32 v32, 81920, v29
    v_add_u32 v33, 81920, v30
    s_waitcnt vmcnt(32)
    s_barrier
    ds_read_b64_tr_b16 a[48:49], v31 offset:0
    ds_read_b64_tr_b16 a[128:129], v32 offset:0
    ds_read_b64_tr_b16 a[208:209], v31 offset:16384
    ds_read_b64_tr_b16 v[224:225], v32 offset:16384
    ds_read_b64_tr_b16 v[144:145], v33 offset:0
    ds_read_b64_tr_b16 a[50:51], v31 offset:1024
    ds_read_b64_tr_b16 a[130:131], v32 offset:1024
    ds_read_b64_tr_b16 a[210:211], v31 offset:17408
    ds_read_b64_tr_b16 v[226:227], v32 offset:17408
    ds_read_b64_tr_b16 v[146:147], v33 offset:512
    ds_read_b64_tr_b16 a[52:53], v31 offset:8192
    ds_read_b64_tr_b16 a[132:133], v32 offset:8192
    ds_read_b64_tr_b16 a[212:213], v31 offset:24576
    ds_read_b64_tr_b16 v[228:229], v32 offset:24576
    ds_read_b64_tr_b16 v[148:149], v33 offset:4096
    ds_read_b64_tr_b16 a[54:55], v31 offset:9216
    ds_read_b64_tr_b16 a[134:135], v32 offset:9216
    ds_read_b64_tr_b16 a[214:215], v31 offset:25600
    ds_read_b64_tr_b16 v[230:231], v32 offset:25600
    ds_read_b64_tr_b16 v[150:151], v33 offset:4608
    s_waitcnt lgkmcnt(0)
    s_barrier
    v_add_u32 v31, 122880, v28
    v_add_u32 v32, 122880, v29
    v_add_u32 v33, 122880, v30
    s_waitcnt vmcnt(22)
    s_barrier
    ds_read_b64_tr_b16 a[56:57], v31 offset:0
    ds_read_b64_tr_b16 a[136:137], v32 offset:0
    ds_read_b64_tr_b16 a[216:217], v31 offset:16384
    ds_read_b64_tr_b16 v[232:233], v32 offset:16384
    ds_read_b64_tr_b16 v[152:153], v33 offset:0
    ds_read_b64_tr_b16 a[58:59], v31 offset:1024
    ds_read_b64_tr_b16 a[138:139], v32 offset:1024
    ds_read_b64_tr_b16 a[218:219], v31 offset:17408
    ds_read_b64_tr_b16 v[234:235], v32 offset:17408
    ds_read_b64_tr_b16 v[154:155], v33 offset:512
    ds_read_b64_tr_b16 a[60:61], v31 offset:8192
    ds_read_b64_tr_b16 a[140:141], v32 offset:8192
    ds_read_b64_tr_b16 a[220:221], v31 offset:24576
    ds_read_b64_tr_b16 v[236:237], v32 offset:24576
    ds_read_b64_tr_b16 v[156:157], v33 offset:4096
    ds_read_b64_tr_b16 a[62:63], v31 offset:9216
    ds_read_b64_tr_b16 a[142:143], v32 offset:9216
    ds_read_b64_tr_b16 a[222:223], v31 offset:25600
    ds_read_b64_tr_b16 v[238:239], v32 offset:25600
    ds_read_b64_tr_b16 v[158:159], v33 offset:4608
    s_waitcnt lgkmcnt(0)
    s_barrier
    v_add_u32 v31, 0, v28
    v_add_u32 v32, 0, v29
    v_add_u32 v33, 0, v30
    s_waitcnt vmcnt(10)
    s_barrier
    ds_read_b64_tr_b16 a[64:65], v31 offset:0
    ds_read_b64_tr_b16 a[144:145], v32 offset:0
    ds_read_b64_tr_b16 a[224:225], v31 offset:16384
    ds_read_b64_tr_b16 v[240:241], v32 offset:16384
    ds_read_b64_tr_b16 v[160:161], v33 offset:0
    ds_read_b64_tr_b16 a[66:67], v31 offset:1024
    ds_read_b64_tr_b16 a[146:147], v32 offset:1024
    ds_read_b64_tr_b16 a[226:227], v31 offset:17408
    ds_read_b64_tr_b16 v[242:243], v32 offset:17408
    ds_read_b64_tr_b16 v[162:163], v33 offset:512
    ds_read_b64_tr_b16 a[68:69], v31 offset:8192
    ds_read_b64_tr_b16 a[148:149], v32 offset:8192
    ds_read_b64_tr_b16 a[228:229], v31 offset:24576
    ds_read_b64_tr_b16 v[244:245], v32 offset:24576
    ds_read_b64_tr_b16 v[164:165], v33 offset:4096
    ds_read_b64_tr_b16 a[70:71], v31 offset:9216
    ds_read_b64_tr_b16 a[150:151], v32 offset:9216
    ds_read_b64_tr_b16 a[230:231], v31 offset:25600
    ds_read_b64_tr_b16 v[246:247], v32 offset:25600
    ds_read_b64_tr_b16 v[166:167], v33 offset:4608
    v_readfirstlane_b32 s18, v12
    v_readfirstlane_b32 s19, v14
    s_cmp_lg_u32 s92, 0
    s_cbranch_scc1 L_ch_nct
    s_cmp_lg_u32 s18, 2
    s_cbranch_scc1 L_ch_nct
    s_cmp_lt_u32 s19, 52
    s_cbranch_scc1 L_ch_nct
    buffer_load_dword v16, v7, s[12:15], 0 offen offset:148 sc1
    s_mov_b32 s96, 1
    s_mov_b32 s92, 1
    s_mov_b32 s94, 1
    s_mov_b64 exec, s[24:25]
    buffer_load_dword v38, v8, s[8:11], s98 offen sc1
    s_mov_b64 exec, -1
    s_mul_i32 s18, s34, 40960
    s_add_u32 s18, s18, 120193024
    v_min_u32 v17, -2, v17
    s_mov_b64 exec, s[22:23]
    buffer_store_dword v17, v18, s[8:11], s18 offen
    s_mov_b64 exec, 1
    s_lshl_b32 s18, s2, 2
    s_add_u32 s18, s18, 120599552
    v_mov_b32 v12, s93
    buffer_store_dword v12, v7, s[8:11], s18 offen sc1
    s_mov_b64 exec, -1
L_ch_nct:
    s_waitcnt lgkmcnt(0)
    s_barrier
    v_add_u32 v31, 40960, v28
    v_add_u32 v32, 40960, v29
    v_add_u32 v33, 40960, v30
    s_waitcnt vmcnt(0)
    s_barrier
    ds_read_b64_tr_b16 a[72:73], v31 offset:0
    ds_read_b64_tr_b16 a[152:153], v32 offset:0
    ds_read_b64_tr_b16 a[232:233], v31 offset:16384
    ds_read_b64_tr_b16 v[248:249], v32 offset:16384
    ds_read_b64_tr_b16 v[168:169], v33 offset:0
    ds_read_b64_tr_b16 a[74:75], v31 offset:1024
    ds_read_b64_tr_b16 a[154:155], v32 offset:1024
    ds_read_b64_tr_b16 a[234:235], v31 offset:17408
    ds_read_b64_tr_b16 v[250:251], v32 offset:17408
    ds_read_b64_tr_b16 v[170:171], v33 offset:512
    ds_read_b64_tr_b16 a[76:77], v31 offset:8192
    ds_read_b64_tr_b16 a[156:157], v32 offset:8192
    ds_read_b64_tr_b16 a[236:237], v31 offset:24576
    ds_read_b64_tr_b16 v[252:253], v32 offset:24576
    ds_read_b64_tr_b16 v[172:173], v33 offset:4096
    ds_read_b64_tr_b16 a[78:79], v31 offset:9216
    ds_read_b64_tr_b16 a[158:159], v32 offset:9216
    ds_read_b64_tr_b16 a[238:239], v31 offset:25600
    ds_read_b64_tr_b16 v[254:255], v32 offset:25600
    ds_read_b64_tr_b16 v[174:175], v33 offset:4608
    s_waitcnt lgkmcnt(0)
    s_barrier
    ds_write_b128 v9, v[40:43] offset:0
    ds_write_b128 v9, v[44:47] offset:16384
    ds_write_b128 v9, v[48:51] offset:32768
    ds_write_b128 v10, v[52:55] offset:0
    ds_write_b128 v10, v[56:59] offset:16384
    ds_write_b128 v9, v[60:63] offset:1024
    ds_write_b128 v9, v[64:67] offset:17408
    ds_write_b128 v9, v[68:71] offset:33792
    ds_write_b128 v10, v[72:75] offset:1024
    ds_write_b128 v10, v[76:79] offset:17408
    ds_write_b128 v9, v[80:83] offset:2048
    ds_write_b128 v9, v[84:87] offset:18432
    ds_write_b128 v9, v[88:91] offset:34816
    ds_write_b128 v10, v[92:95] offset:2048
    ds_write_b128 v10, a[240:243] offset:18432
    ds_write_b128 v9, a[244:247] offset:3072
    ds_write_b128 v9, a[248:251] offset:19456
    ds_write_b128 v9, a[252:255] offset:35840
    ds_write_b128 v10, v[20:23] offset:3072
    ds_write_b128 v10, v[34:37] offset:19456
    s_mov_b32 s32, 0
    s_cmp_eq_u32 s96, 0
    s_cbranch_scc1 L_ch_nk0
    v_readlane_b32 s32, v38, 0
    v_readlane_b32 s31, v38, 8
    s_min_i32 s32, s32, s31
    v_readlane_b32 s31, v38, 16
    s_min_i32 s32, s32, s31
    v_readlane_b32 s31, v38, 24
    s_min_i32 s32, s32, s31
    v_readfirstlane_b32 s97, v16
L_ch_nk0:
    s_waitcnt lgkmcnt(0)
    s_lshl_b32 s18, s16, 10
    v_add_u32 v3, s18, v8
    s_lshl_b32 s18, s16, 9
    s_add_u32 s18, s18, 8192
    v_add_u32 v4, s18, v8
    v_and_b32 v24, 1, v2
    v_lshlrev_b32 v24, 2, v24
    v_sub_u32 v24, v1, v24
    v_mov_b32 v25, 0x3f80
    v_mov_b32 v26, 0x3f800000
    v_cmp_eq_u32 vcc, 0, v24
    s_nop 1
    v_cndmask_b32 v27, 0, v25, vcc
    v_cmp_eq_u32 vcc, 1, v24
    s_nop 1
    v_cndmask_b32 v28, v27, v26, vcc
    v_cndmask_b32 v32, v28, 0, s[24:25]
    v_cndmask_b32 v28, 0, v28, s[24:25]
    v_cmp_eq_u32 vcc, 2, v24
    s_nop 1
    v_cndmask_b32 v27, 0, v25, vcc
    v_cmp_eq_u32 vcc, 3, v24
    s_nop 1
    v_cndmask_b32 v29, v27, v26, vcc
    v_cndmask_b32 v33, v29, 0, s[24:25]
    v_cndmask_b32 v29, 0, v29, s[24:25]
    v_cmp_eq_u32 vcc, 8, v24
    s_nop 1
    v_cndmask_b32 v27, 0, v25, vcc
    v_cmp_eq_u32 vcc, 9, v24
    s_nop 1
    v_cndmask_b32 v30, v27, v26, vcc
    v_cndmask_b32 v34, v30, 0, s[24:25]
    v_cndmask_b32 v30, 0, v30, s[24:25]
    v_cmp_eq_u32 vcc, 10, v24
    s_nop 1
    v_cndmask_b32 v27, 0, v25, vcc
    v_cmp_eq_u32 vcc, 11, v24
    s_nop 1
    v_cndmask_b32 v31, v27, v26, vcc
    v_cndmask_b32 v35, v31, 0, s[24:25]
    v_cndmask_b32 v31, 0, v31, s[24:25]
    ds_write_b128 v8, v[28:31] offset:10368
    ds_write_b128 v8, v[32:35] offset:11392
    s_lshl_b32 s18, s39, 1
    s_lshr_b32 s19, s16, 1
    s_add_u32 s18, s18, s19
    s_lshl_b32 s18, s18, 9
    s_and_b32 s19, s16, 1
    s_lshl_b32 s19, s19, 3
    s_add_u32 s18, s18, s19
    v_lshlrev_b32 v24, 6, v1
    v_lshlrev_b32 v25, 4, v2
    v_add3_u32 v11, v24, v25, s18
    v_and_b32 v24, 7, v1
    v_lshlrev_b32 v24, 6, v24
    s_lshl_b32 s18, s16, 11
    v_add3_u32 v12, v24, v25, s18
    v_lshrrev_b32 v24, 3, v1
    v_lshlrev_b32 v24, 9, v24
    v_add_u32 v12, v12, v24
    v_lshlrev_b32 v24, 7, v2
    v_and_b32 v25, 7, v1
    v_lshlrev_b32 v25, 4, v25
    v_add_u32 v24, v24, v25
    v_lshrrev_b32 v25, 3, v1
    s_mul_i32 s18, s16, 1536
    s_add_u32 s18, s18, 12416
    v_add_u32 v13, s18, v24
    v_lshl_add_u32 v26, v25, 9, v24
    v_add_u32 v94, 12928, v26
    v_lshl_add_u32 v26, v25, 3, v24
    v_add_u32 v93, 12416, v26
    s_mul_i32 s18, s16, 2560
    s_add_u32 s18, s18, 24704
    v_add_u32 v20, s18, v24
    v_mul_u32_u24 v26, 2560, v25
    v_add_u32 v26, v26, v24
    s_lshl_b32 s18, s16, 9
    s_add_u32 s18, s18, 24704
    v_add_u32 v21, s18, v26
    v_add_u32 v95, 26752, v26
    s_mul_i32 s18, s39, 5
    s_add_u32 s19, s18, s16
    s_lshl_b32 s19, s19, 2
    v_add_u32 v24, s19, v2
    v_lshrrev_b32 v26, 4, v24
    v_and_b32 v24, 15, v24
    v_lshlrev_b32 v24, 9, v24
    v_lshl_add_u32 v24, v26, 14, v24
    s_lshl_b32 s19, s38, 7
    v_lshlrev_b32 v25, 4, v1
    v_add3_u32 v14, v24, v25, s19
    s_add_u32 s18, s18, 4
    s_lshl_b32 s18, s18, 2
    v_add_u32 v24, s18, v2
    v_lshrrev_b32 v26, 4, v24
    v_and_b32 v24, 15, v24
    v_lshlrev_b32 v24, 9, v24
    v_lshl_add_u32 v24, v26, 14, v24
    v_and_b32 v25, 7, v1
    v_lshlrev_b32 v25, 4, v25
    v_add3_u32 v15, v24, v25, s19
    v_cndmask_b32 v14, v15, v14, s[20:21]
    v_cmp_eq_u32 s[26:27], s16, v2
    s_nop 1
    s_or_b64 s[26:27], s[26:27], s[20:21]
    v_and_b32 v24, 31, v0
    v_lshlrev_b32 v24, 4, v24
    s_lshl_b32 s18, s35, 2
    s_add_u32 s18, s18, s16
    s_lshr_b32 s19, s18, 4
    s_lshl_b32 s19, s19, 14
    v_add_u32 v16, s19, v24
    s_and_b32 s19, s18, 15
    s_lshl_b32 s19, s19, 9
    v_add_u32 v16, s19, v16
    s_add_u32 s28, s35, 128
    s_lshr_b32 s19, s28, 4
    s_lshl_b32 s19, s19, 14
    v_add_u32 v17, s19, v24
    s_and_b32 s19, s28, 15
    s_lshl_b32 s19, s19, 9
    v_add_u32 v17, s19, v17
    s_lshl_b32 s18, s37, 2
    s_add_u32 s18, s18, s16
    s_lshl_b32 s61, s18, 10
    s_lshl_b32 s19, s18, 9
    v_lshlrev_b32 v24, 3, v0
    v_add_u32 v23, s19, v24
    s_lshl_b32 s19, s16, 10
    v_add_u32 v22, s19, v8
    s_lshl_b32 s18, s36, 13
    s_add_u32 s47, s18, 44384256
    s_add_u32 s48, s18, 61161472
    s_add_u32 s48, s48, s61
    s_lshl_b32 s18, s36, 12
    s_add_u32 s49, s18, 77938688
    s_add_u32 s50, s18, 86327296
    s_mul_i32 s41, s34, 40960
    s_add_u32 s41, s41, 120193024
    s_lshl_b32 s45, s40, 13
    s_add_u32 s45, s45, 120274944
    s_mov_b32 s17, 0
    s_mov_b32 s51, s41
    s_mul_i32 s62, s16, 3072
    s_add_u32 s62, s62, 45184
    v_mov_b32 v1, v94
    v_mov_b32 v2, v95
    v_mov_b32 v19, v93
    s_lshl_b32 s61, s16, 11
    s_add_u32 s61, s61, 70272
    v_add_u32 v15, s61, v8
    s_not_b64 s[4:5], s[24:25]
    s_cmp_eq_u32 s37, 0
    s_cselect_b64 s[4:5], s[24:25], s[4:5]
    s_lshl_b32 s33, s34, 5
    s_add_u32 s33, s33, s35
    s_lshl_b32 s33, s33, 2
    s_add_u32 s33, s33, s16
    s_lshl_b32 s33, s33, 7
    s_add_u32 s33, s33, 120537088
    s_mov_b32 s54, 0
    s_cmp_eq_u32 s96, 0
    s_cbranch_scc1 L_ch_nsel
    s_mov_b32 s18, s97
    s_cmp_lg_u32 s18, 0
    s_cbranch_scc1 L_ch_sel
    s_branch L_ch_sel0
L_ch_nsel:
    s_cmp_eq_u32 s92, 0
    s_cbranch_scc1 L_ch_censusA
L_ch_setup2:
    s_cmp_lg_u32 s94, 0
    s_cbranch_scc1 L_chd_2_d
    s_load_dwordx2 s[6:7], s[0:1], 104
    s_waitcnt lgkmcnt(0)
    s_mov_b32 s84, s6
    s_mov_b32 s85, s7
    s_mov_b32 s86, 256
    s_mov_b32 s87, 0x00020000
L_chd_2:
    v_mov_b32 v36, 0
    buffer_load_dword v37, v36, s[84:87], 0 offen offset:136 sc1
    s_waitcnt vmcnt(0)
    v_readfirstlane_b32 s7, v37
    s_cmp_ge_u32 s7, 52
    s_cbranch_scc1 L_chd_2_s
    s_sleep 8
    s_branch L_chd_2
L_chd_2_s:
    s_mov_b32 s94, 1
    s_lshl_b32 s7, s2, 2
    s_add_u32 s7, s7, 120599552
    v_mov_b32 v37, s93
    buffer_store_dword v37, v36, s[8:11], s7 offen sc1
L_chd_2_d:
    s_mov_b64 exec, s[22:23]
    buffer_load_dword v36, v5, s[56:59], 0 offen
    s_waitcnt vmcnt(0)
    v_min_u32 v36, -2, v36
    s_cmp_lg_u32 s63, 0
    s_cbranch_scc1 L_chs_3
    buffer_store_dword v36, v18, s[8:11], s41 offen
L_chs_4:
    s_mov_b64 exec, -1
L_ch_sel0:
    s_mov_b32 s19, 16
L_ch_sel1:
    v_mov_b32 v36, 0
    buffer_load_dword v37, v36, s[12:15], 0 offen offset:148 sc1
    s_waitcnt vmcnt(0)
    v_readfirstlane_b32 s18, v37
    s_cmp_lg_u32 s18, 0
    s_cbranch_scc1 L_ch_sel
    s_sub_u32 s19, s19, 1
    s_cmp_lg_u32 s19, 0
    s_cbranch_scc1 L_ch_sel1
    s_mov_b64 exec, 1
    v_mov_b32 v38, 1
    v_mov_b32 v39, 0
    buffer_atomic_cmpswap v[38:39], v36, s[12:15], 0 offen offset:148 sc0 sc1
    s_waitcnt vmcnt(0)
    s_mov_b64 exec, -1
    v_readfirstlane_b32 s18, v38
    s_max_u32 s18, s18, 1
L_ch_sel:
    s_sub_u32 s18, s18, 1
    s_and_b32 s18, s18, 1
    s_lshl_b32 s18, s18, 13
    s_mul_i32 s19, s34, 163840
    s_add_u32 s19, s19, 119537664
    s_add_u32 s52, s19, s18
    s_xor_b32 s53, s52, 8192
    s_xor_b32 s19, s34, 1
    s_mul_i32 s19, s19, 163840
    s_add_u32 s19, s19, 119537664
    s_add_u32 s19, s19, s18
    v_mov_b32 v36, s19
    v_mov_b32 v37, s53
    v_cndmask_b32 v36, v36, v37, s[24:25]
    v_add_u32 v16, v16, v36
    v_add_u32 v17, v17, v36
    s_add_u32 s18, s41, 0
    s_add_u32 s28, s45, 0
    s_mul_i32 s19, s16, 2560
    v_lshlrev_b32 v60, 6, v0
    v_min_u32 v60, 2556, v60
    v_add_u32 v60, s19, v60
    buffer_load_dword v61, v60, s[8:11], s18 offen sc1
    s_lshl_b32 s19, s16, 11
    v_lshlrev_b32 v60, 5, v0
    v_add_u32 v60, s19, v60
    buffer_load_dword v61, v60, s[8:11], s28 offen sc1
    s_add_u32 s18, s41, 10240
    s_add_u32 s28, s45, 65536
    s_mul_i32 s19, s16, 2560
    v_lshlrev_b32 v60, 6, v0
    v_min_u32 v60, 2556, v60
    v_add_u32 v60, s19, v60
    buffer_load_dword v61, v60, s[8:11], s18 offen sc1
    s_lshl_b32 s19, s16, 11
    v_lshlrev_b32 v60, 5, v0
    v_add_u32 v60, s19, v60
    buffer_load_dword v61, v60, s[8:11], s28 offen sc1
    s_add_u32 s18, s41, 20480
    s_add_u32 s28, s45, 131072
    s_mul_i32 s19, s16, 2560
    v_lshlrev_b32 v60, 6, v0
    v_min_u32 v60, 2556, v60
    v_add_u32 v60, s19, v60
    buffer_load_dword v61, v60, s[8:11], s18 offen sc1
    s_lshl_b32 s19, s16, 11
    v_lshlrev_b32 v60, 5, v0
    v_add_u32 v60, s19, v60
    buffer_load_dword v61, v60, s[8:11], s28 offen sc1
    s_add_u32 s18, s41, 30720
    s_add_u32 s28, s45, 196608
    s_mul_i32 s19, s16, 2560
    v_lshlrev_b32 v60, 6, v0
    v_min_u32 v60, 2556, v60
    v_add_u32 v60, s19, v60
    buffer_load_dword v61, v60, s[8:11], s18 offen sc1
    s_lshl_b32 s19, s16, 11
    v_lshlrev_b32 v60, 5, v0
    v_add_u32 v60, s19, v60
    buffer_load_dword v61, v60, s[8:11], s28 offen sc1
    s_lshr_b32 s19, s54, 2
    s_cmp_gt_i32 s32, s19
    s_cbranch_scc1 L_ch_flok0
L_ch_fl0:
    s_mov_b64 exec, s[24:25]
    buffer_load_dword v37, v8, s[8:11], s98 offen sc1
    s_mov_b64 exec, -1
    s_waitcnt vmcnt(0)
    v_readlane_b32 s32, v37, 0
    v_readlane_b32 s31, v37, 8
    s_min_i32 s32, s32, s31
    v_readlane_b32 s31, v37, 16
    s_min_i32 s32, s32, s31
    v_readlane_b32 s31, v37, 24
    s_min_i32 s32, s32, s31
    s_cmp_le_i32 s32, s19
    s_cbranch_scc1 L_ch_fl0
L_ch_flok0:
    s_and_b32 s18, s54, 1
    s_mul_i32 s18, s18, 12288
    s_add_u32 s18, s18, s62
    s_mov_b32 m0, s18
    s_add_u32 s19, s47, 3072
    s_nop 0
    buffer_load_dwordx4 v22, s[8:11], s47 offen sc1 lds
    buffer_load_dwordx4 v22, s[8:11], s19 offen offset:1024 sc1 lds
    s_sub_u32 s19, s48, 2048
    buffer_load_dwordx4 v8, s[8:11], s19 offen offset:2048 sc1 lds
    s_waitcnt lgkmcnt(0)
    s_barrier
    s_and_b32 s18, s17, 3
    s_mul_i32 s51, s18, 10240
    s_add_u32 s51, s51, s41
    s_add_u32 s56, s51, 4096
    s_lshl_b32 s18, s18, 16
    s_add_u32 s42, s45, s18
    v_mov_b32 v60, -1
    v_mov_b32 v61, -1
    v_mov_b32 v62, -1
    v_mov_b32 v63, -1
    v_mov_b32 v64, -1
    v_mov_b32 v65, -1
    v_mov_b32 v66, -1
    v_mov_b32 v67, -1
    v_cndmask_b32 v68, 0, -1, s[24:25]
    v_cndmask_b32 v69, 0, -1, s[24:25]
    v_cndmask_b32 v70, 0, -1, s[24:25]
    v_cndmask_b32 v71, 0, -1, s[24:25]
    v_mov_b32 v50, 0x44444444
    v_mov_b32 v51, 0xeeeeeeee
    v_cndmask_b32 v95, v51, v50, s[20:21]
    v_mov_b32 v49, 0
    v_mov_b32 v50, 0
    v_mov_b32 v51, 0
    v_mov_b32 v52, 0
    v_mov_b32 v53, 0
    v_mov_b32 v54, 0
    v_mov_b32 v55, 0
    v_mov_b32 v56, 0
    v_mov_b32 v57, 0
    v_mov_b32 v58, 0
    v_mov_b32 v59, 0
    ds_read_b128 v[86:89], v8 offset:10368
    ds_read_b128 v[72:75], v15
    ds_read_b64 v[84:85], v15 offset:1024
    s_lshr_b32 s60, s17, 1
    s_and_b32 s60, s60, 1
    s_add_u32 s18, s17, 3
    s_and_b32 s18, s18, 3
    s_lshl_b32 s28, s18, 16
    s_add_u32 s28, s28, s45
    s_mul_i32 s29, s18, 10240
    s_add_u32 s29, s29, s41
    s_and_b32 s18, s17, 1
    s_mul_i32 s19, s18, 12288
    s_add_u32 s19, s19, s62
    v_add_u32 v94, s19, v8
    s_branch L_ch_step
L_ch_censusA:
    v_mov_b32 v24, 0
    buffer_load_dwordx4 v[28:31], v24, s[12:15], 0 offen offset:128 sc1
    s_waitcnt vmcnt(0)
    v_readfirstlane_b32 s18, v28
    v_readfirstlane_b32 s19, v29
    v_readfirstlane_b32 s28, v30
    s_mov_b32 s92, 1
    s_cmp_eq_u32 s18, 2
    s_cbranch_scc1 L_ch_setup2
    s_cmp_ge_u32 s28, 52
    s_cbranch_scc1 L_ch_cen1A
    s_sleep 4
    s_branch L_ch_censusA
L_ch_cen1A:
    s_cmp_lg_u32 s94, 0
    s_cbranch_scc1 L_chd_5_d
    s_load_dwordx2 s[6:7], s[0:1], 104
    s_waitcnt lgkmcnt(0)
    s_mov_b32 s84, s6
    s_mov_b32 s85, s7
    s_mov_b32 s86, 256
    s_mov_b32 s87, 0x00020000
L_chd_5:
    v_mov_b32 v24, 0
    buffer_load_dword v25, v24, s[84:87], 0 offen offset:136 sc1
    s_waitcnt vmcnt(0)
    v_readfirstlane_b32 s7, v25
    s_cmp_ge_u32 s7, 52
    s_cbranch_scc1 L_chd_5_s
    s_sleep 8
    s_branch L_chd_5
L_chd_5_s:
    s_mov_b32 s94, 1
    s_lshl_b32 s7, s2, 2
    s_add_u32 s7, s7, 120599552
    v_mov_b32 v25, s93
    buffer_store_dword v25, v24, s[8:11], s7 offen sc1
L_chd_5_d:
    s_mov_b32 s18, 120599552
    v_lshlrev_b32 v24, 4, v0
    buffer_load_dwordx4 v[28:31], v24, s[8:11], s18 offen sc1
    s_waitcnt vmcnt(0)
    v_max_u32 v25, v28, v29
    v_max3_u32 v25, v25, v30, v31
    v_cmp_eq_u32 vcc, -1, v25
    s_cbranch_vccz L_ch_cen2A
    s_sleep 4
    s_branch L_ch_censusA
L_ch_cen2A:
    v_mov_b32 v24, 0
    buffer_load_dword v25, v24, s[12:15], 0 offen offset:132 sc1
    s_waitcnt vmcnt(0)
    v_readfirstlane_b32 s18, v25
    s_cmp_eq_u32 s18, 6
    s_cselect_b32 s92, 1, 2
    s_mov_b32 s18, 0
    s_mov_b32 s19, 0
    v_cmp_eq_u32 vcc, 0, v28
    s_nop 3
    s_bcnt1_i32_b64 s28, vcc
    s_add_u32 s18, s18, s28
    v_cmp_eq_u32 vcc, 1, v28
    s_nop 3
    s_bcnt1_i32_b64 s28, vcc
    s_add_u32 s19, s19, s28
    v_cmp_eq_u32 vcc, 0, v29
    s_nop 3
    s_bcnt1_i32_b64 s28, vcc
    s_add_u32 s18, s18, s28
    v_cmp_eq_u32 vcc, 1, v29
    s_nop 3
    s_bcnt1_i32_b64 s28, vcc
    s_add_u32 s19, s19, s28
    v_cmp_eq_u32 vcc, 0, v30
    s_nop 3
    s_bcnt1_i32_b64 s28, vcc
    s_add_u32 s18, s18, s28
    v_cmp_eq_u32 vcc, 1, v30
    s_nop 3
    s_bcnt1_i32_b64 s28, vcc
    s_add_u32 s19, s19, s28
    v_cmp_eq_u32 vcc, 0, v31
    s_nop 3
    s_bcnt1_i32_b64 s28, vcc
    s_add_u32 s18, s18, s28
    v_cmp_eq_u32 vcc, 1, v31
    s_nop 3
    s_bcnt1_i32_b64 s28, vcc
    s_add_u32 s19, s19, s28
    s_min_u32 s18, s18, s19
    s_cmp_ge_u32 s18, 32
    s_cbranch_scc1 L_ch_setup2
    s_cmp_lg_u32 s16, 0
    s_cbranch_scc1 L_ch_cen3A
    s_mov_b64 exec, 1
    v_mov_b32 v3, 144
    v_mov_b32 v4, 1
    buffer_atomic_add v4, v3, s[12:15], 0 offen sc0 sc1
    s_waitcnt vmcnt(0)
    v_mov_b32 v3, 69760
    ds_write_b32 v3, v4
    s_waitcnt lgkmcnt(0)
    s_mov_b64 exec, -1
L_ch_cen3A:
    s_barrier
    v_mov_b32 v3, 69760
    ds_read_b32 v4, v3
    s_waitcnt lgkmcnt(0)
    v_readfirstlane_b32 s30, v4
    s_barrier
    s_cmp_lt_u32 s30, 64
    s_cbranch_scc0 L_ch_helper
    s_load_dwordx2 s[52:53], s[0:1], 8
    s_waitcnt lgkmcnt(0)
    s_mov_b32 s56, s52
    s_mov_b32 s57, s53
    s_mov_b32 s58, 10240
    s_mov_b32 s59, 0x00020000
    s_mov_b32 s63, 1
    s_lshr_b32 s34, s30, 5
    s_and_b32 s35, s30, 31
    s_branch L_ch_setup
L_ch_censusB:
    v_mov_b32 v24, 0
    buffer_load_dwordx4 v[28:31], v24, s[12:15], 0 offen offset:128 sc1
    s_waitcnt vmcnt(0)
    v_readfirstlane_b32 s18, v28
    v_readfirstlane_b32 s19, v29
    v_readfirstlane_b32 s28, v30
    s_mov_b32 s92, 1
    s_add_u32 s18, s18, s19
    s_cmp_eq_u32 s18, 8
    s_cbranch_scc1 L_ch_helper
    s_cmp_ge_u32 s28, 52
    s_cbranch_scc1 L_ch_cen1B
    s_sleep 4
    s_branch L_ch_censusB
L_ch_cen1B:
    s_cmp_lg_u32 s94, 0
    s_cbranch_scc1 L_chd_6_d
    s_load_dwordx2 s[6:7], s[0:1], 104
    s_waitcnt lgkmcnt(0)
    s_mov_b32 s84, s6
    s_mov_b32 s85, s7
    s_mov_b32 s86, 256
    s_mov_b32 s87, 0x00020000
L_chd_6:
    v_mov_b32 v24, 0
    buffer_load_dword v25, v24, s[84:87], 0 offen offset:136 sc1
    s_waitcnt vmcnt(0)
    v_readfirstlane_b32 s7, v25
    s_cmp_ge_u32 s7, 52
    s_cbranch_scc1 L_chd_6_s
    s_sleep 8
    s_branch L_chd_6
L_chd_6_s:
    s_mov_b32 s94, 1
    s_lshl_b32 s7, s2, 2
    s_add_u32 s7, s7, 120599552
    v_mov_b32 v25, s93
    buffer_store_dword v25, v24, s[8:11], s7 offen sc1
L_chd_6_d:
    s_mov_b32 s18, 120599552
    v_lshlrev_b32 v24, 4, v0
    buffer_load_dwordx4 v[28:31], v24, s[8:11], s18 offen sc1
    s_waitcnt vmcnt(0)
    v_max_u32 v25, v28, v29
    v_max3_u32 v25, v25, v30, v31
    v_cmp_eq_u32 vcc, -1, v25
    s_cbranch_vccz L_ch_cen2B
    s_sleep 4
    s_branch L_ch_censusB
L_ch_cen2B:
    v_mov_b32 v24, 0
    buffer_load_dword v25, v24, s[12:15], 0 offen offset:132 sc1
    s_waitcnt vmcnt(0)
    v_readfirstlane_b32 s18, v25
    s_cmp_eq_u32 s18, 6
    s_cselect_b32 s92, 1, 2
    s_mov_b32 s18, 0
    s_mov_b32 s19, 0
    v_cmp_eq_u32 vcc, 0, v28
    s_nop 3
    s_bcnt1_i32_b64 s28, vcc
    s_add_u32 s18, s18, s28
    v_cmp_eq_u32 vcc, 1, v28
    s_nop 3
    s_bcnt1_i32_b64 s28, vcc
    s_add_u32 s19, s19, s28
    v_cmp_eq_u32 vcc, 0, v29
    s_nop 3
    s_bcnt1_i32_b64 s28, vcc
    s_add_u32 s18, s18, s28
    v_cmp_eq_u32 vcc, 1, v29
    s_nop 3
    s_bcnt1_i32_b64 s28, vcc
    s_add_u32 s19, s19, s28
    v_cmp_eq_u32 vcc, 0, v30
    s_nop 3
    s_bcnt1_i32_b64 s28, vcc
    s_add_u32 s18, s18, s28
    v_cmp_eq_u32 vcc, 1, v30
    s_nop 3
    s_bcnt1_i32_b64 s28, vcc
    s_add_u32 s19, s19, s28
    v_cmp_eq_u32 vcc, 0, v31
    s_nop 3
    s_bcnt1_i32_b64 s28, vcc
    s_add_u32 s18, s18, s28
    v_cmp_eq_u32 vcc, 1, v31
    s_nop 3
    s_bcnt1_i32_b64 s28, vcc
    s_add_u32 s19, s19, s28
    s_min_u32 s18, s18, s19
    s_cmp_ge_u32 s18, 32
    s_cbranch_scc1 L_ch_helper
    s_cmp_lg_u32 s16, 0
    s_cbranch_scc1 L_ch_cen3B
    s_mov_b64 exec, 1
    v_mov_b32 v3, 144
    v_mov_b32 v4, 1
    buffer_atomic_add v4, v3, s[12:15], 0 offen sc0 sc1
    s_waitcnt vmcnt(0)
    v_mov_b32 v3, 69760
    ds_write_b32 v3, v4
    s_waitcnt lgkmcnt(0)
    s_mov_b64 exec, -1
L_ch_cen3B:
    s_barrier
    v_mov_b32 v3, 69760
    ds_read_b32 v4, v3
    s_waitcnt lgkmcnt(0)
    v_readfirstlane_b32 s30, v4
    s_barrier
    s_cmp_lt_u32 s30, 64
    s_cbranch_scc0 L_ch_helper
    s_load_dwordx2 s[52:53], s[0:1], 8
    s_waitcnt lgkmcnt(0)
    s_mov_b32 s56, s52
    s_mov_b32 s57, s53
    s_mov_b32 s58, 10240
    s_mov_b32 s59, 0x00020000
    s_mov_b32 s63, 1
    s_lshr_b32 s34, s30, 5
    s_and_b32 s35, s30, 31
    s_branch L_ch_setup
L_ch_step:
    v_mov_b32 v40, 0
    v_mov_b32 v41, 0
    v_mov_b32 v42, 0
    v_mov_b32 v43, 0
    v_mov_b32 v44, 0
    v_mov_b32 v45, 0
    v_mov_b32 v46, 0
    v_mov_b32 v47, 0
    v_mov_b32 v48, 0
    ds_read_b128 v[90:93], v8 offset:11392
    s_and_b32 s18, s17, 1
    s_mul_i32 s46, s18, 327680
    s_add_u32 s43, s53, s46
    s_add_u32 s44, s52, s46
    s_cmp_eq_u32 s17, 60
    s_cbranch_scc1 L_ch_q0
L_ch_q0d:
    s_cmp_ge_u32 s17, 63
    s_cbranch_scc1 L_ch_flok1
    s_add_u32 s47, s47, 262144
    s_add_u32 s48, s48, 262144
    s_add_u32 s54, s17, 1
    s_lshr_b32 s19, s54, 2
    s_cmp_le_i32 s32, s19
    s_cbranch_scc1 L_ch_kvo
L_ch_flok1:
    s_sleep 3
    buffer_load_dwordx4 v[60:63], v3, s[8:11], s51 offen sc1
    buffer_load_dwordx4 v[64:67], v3, s[8:11], s56 offen sc1
    s_mov_b64 exec, s[24:25]
    buffer_load_dwordx4 v[68:71], v4, s[8:11], s51 offen sc1
    s_mov_b64 exec, -1
    s_cmp_eq_u32 s16, 0
    s_cbranch_scc1 L_ch_w0
    s_cmp_eq_u32 s16, 1
    s_cbranch_scc1 L_ch_w1
    s_cmp_eq_u32 s16, 2
    s_cbranch_scc1 L_ch_w2
L_ch_w3:
L_ch_spg3:
    v_max3_u32 v36, v60, v61, v62
    v_max3_u32 v37, v63, v64, v65
    v_max3_u32 v38, v66, v67, v68
    v_max3_u32 v39, v69, v70, v71
    v_max_u32 v36, v36, v37
    v_max3_u32 v36, v36, v38, v39
    v_cmp_eq_u32 vcc, -1, v36
    s_cbranch_vccz L_ch_sdg3
    v_max3_u32 v36, v60, v61, v62
    v_max3_u32 v37, v63, v64, v65
    v_max3_u32 v38, v66, v67, v68
    v_max3_u32 v39, v69, v70, v71
    v_max_u32 v36, v36, v37
    v_max3_u32 v36, v36, v38, v39
    v_cmp_eq_u32 vcc, -1, v36
    s_cbranch_vccz L_ch_sdg3
    v_max3_u32 v36, v60, v61, v62
    v_max3_u32 v37, v63, v64, v65
    v_max3_u32 v38, v66, v67, v68
    v_max3_u32 v39, v69, v70, v71
    v_max_u32 v36, v36, v37
    v_max3_u32 v36, v36, v38, v39
    v_cmp_eq_u32 vcc, -1, v36
    s_cbranch_vccz L_ch_sdg3
    buffer_load_dwordx4 v[60:63], v3, s[8:11], s51 offen sc1
    buffer_load_dwordx4 v[64:67], v3, s[8:11], s56 offen sc1
    s_mov_b64 exec, s[24:25]
    buffer_load_dwordx4 v[68:71], v4, s[8:11], s51 offen sc1
    s_mov_b64 exec, -1
    s_branch L_ch_spg3
L_ch_sdg3:
    ds_write_b128 v3, v[60:63] offset:0
    ds_write_b128 v3, v[64:67] offset:4096
    s_mov_b64 exec, s[24:25]
    ds_write_b128 v4, v[68:71] offset:0
    s_mov_b64 exec, -1
    v_smfmac_f32_16x16x64_bf16 v[40:43], v[60:63], a[24:31], v95
    s_and_b32 s18, s54, 1
    s_mul_i32 s18, s18, 12288
    s_add_u32 s18, s18, s62
    s_mov_b32 m0, s18
    v_smfmac_f32_16x16x64_bf16 v[44:47], v[60:63], a[104:111], v95
    s_add_u32 s19, s47, 3072
    s_nop 0
    buffer_load_dwordx4 v22, s[8:11], s47 offen sc1 lds
    buffer_load_dwordx4 v22, s[8:11], s19 offen offset:1024 sc1 lds
    s_sub_u32 s19, s48, 2048
    buffer_load_dwordx4 v8, s[8:11], s19 offen offset:2048 sc1 lds
    v_smfmac_f32_16x16x64_bf16 v[48:51], v[60:63], a[184:191], v95
    s_mov_b64 exec, s[24:25]
    buffer_load_dword v7, v8, s[8:11], s98 offen sc1
    s_mov_b64 exec, -1
    s_waitcnt lgkmcnt(0)
    s_barrier
    ds_read_b128 v[32:35], v8 offset:0
    ds_read_b128 v[36:39], v8 offset:1024
    ds_read_b128 v[24:27], v8 offset:2048
    v_smfmac_f32_16x16x64_bf16 v[52:55], v[60:63], v[200:207], v95
    v_smfmac_f32_16x16x64_bf16 v[56:59], v[60:63], v[120:127], v95
    v_xor_b32 v78, 128, v22
    s_mov_b64 exec, s[4:5]
    buffer_store_dwordx4 v[72:75], v78, s[8:11], s49 offen sc1
    s_mov_b64 exec, -1
    v_smfmac_f32_16x16x64_bf16 v[40:43], v[64:67], a[56:63], v95
    v_smfmac_f32_16x16x64_bf16 v[44:47], v[64:67], a[136:143], v95
    v_smfmac_f32_16x16x64_bf16 v[48:51], v[64:67], a[216:223], v95
    v_smfmac_f32_16x16x64_bf16 v[52:55], v[64:67], v[232:239], v95
    buffer_store_dwordx2 v[84:85], v23, s[8:11], s50 offen sc1
    s_cmp_eq_u32 s17, 0
    s_cselect_b32 s18, 0, 131072
    s_add_u32 s49, s49, s18
    s_add_u32 s50, s50, s18
    v_smfmac_f32_16x16x64_bf16 v[56:59], v[64:67], v[152:159], v95
    ds_read_b128 v[28:31], v8 offset:4096
    s_waitcnt lgkmcnt(3)
    v_smfmac_f32_16x16x64_bf16 v[40:43], v[32:35], a[0:7], v95
    v_smfmac_f32_16x16x64_bf16 v[44:47], v[32:35], a[80:87], v95
    v_smfmac_f32_16x16x64_bf16 v[48:51], v[32:35], a[160:167], v95
    v_smfmac_f32_16x16x64_bf16 v[52:55], v[32:35], v[176:183], v95
    v_smfmac_f32_16x16x64_bf16 v[56:59], v[32:35], v[96:103], v95
    ds_read_b128 v[32:35], v8 offset:5120
    s_waitcnt lgkmcnt(3)
    v_smfmac_f32_16x16x64_bf16 v[40:43], v[36:39], a[8:15], v95
    v_smfmac_f32_16x16x64_bf16 v[44:47], v[36:39], a[88:95], v95
    v_smfmac_f32_16x16x64_bf16 v[48:51], v[36:39], a[168:175], v95
    v_smfmac_f32_16x16x64_bf16 v[52:55], v[36:39], v[184:191], v95
    v_smfmac_f32_16x16x64_bf16 v[56:59], v[36:39], v[104:111], v95
    v_mov_b32 v78, -1
    v_mov_b32 v79, -1
    s_mov_b64 exec, s[20:21]
    s_cmp_lg_u32 s63, 0
    s_cbranch_scc1 L_chs_7
    buffer_store_dwordx2 v[78:79], v11, s[8:11], s28 offen
L_chs_8:
    s_mov_b64 exec, -1
    ds_read_b128 v[36:39], v8 offset:6144
    s_waitcnt lgkmcnt(3)
    v_smfmac_f32_16x16x64_bf16 v[40:43], v[24:27], a[16:23], v95
    v_smfmac_f32_16x16x64_bf16 v[44:47], v[24:27], a[96:103], v95
    v_smfmac_f32_16x16x64_bf16 v[48:51], v[24:27], a[176:183], v95
    v_smfmac_f32_16x16x64_bf16 v[52:55], v[24:27], v[192:199], v95
    v_smfmac_f32_16x16x64_bf16 v[56:59], v[24:27], v[112:119], v95
    s_mov_b64 exec, s[22:23]
    s_cmp_lg_u32 s63, 0
    s_cbranch_scc1 L_chs_9
    buffer_store_dword v78, v18, s[8:11], s29 offen
L_chs_10:
    s_mov_b64 exec, -1
    ds_read_b128 v[24:27], v8 offset:8192
    s_waitcnt lgkmcnt(3)
    v_smfmac_f32_16x16x64_bf16 v[40:43], v[28:31], a[32:39], v95
    v_smfmac_f32_16x16x64_bf16 v[44:47], v[28:31], a[112:119], v95
    v_smfmac_f32_16x16x64_bf16 v[48:51], v[28:31], a[192:199], v95
    v_smfmac_f32_16x16x64_bf16 v[52:55], v[28:31], v[208:215], v95
    v_smfmac_f32_16x16x64_bf16 v[56:59], v[28:31], v[128:135], v95
    ds_read_b128 v[28:31], v8 offset:9216
    s_waitcnt lgkmcnt(3)
    v_smfmac_f32_16x16x64_bf16 v[40:43], v[32:35], a[40:47], v95
    v_smfmac_f32_16x16x64_bf16 v[44:47], v[32:35], a[120:127], v95
    v_smfmac_f32_16x16x64_bf16 v[48:51], v[32:35], a[200:207], v95
    v_smfmac_f32_16x16x64_bf16 v[52:55], v[32:35], v[216:223], v95
    s_waitcnt vmcnt(8)
    ds_read_b128 v[60:63], v94
    s_waitcnt lgkmcnt(3)
    v_smfmac_f32_16x16x64_bf16 v[40:43], v[36:39], a[48:55], v95
    v_smfmac_f32_16x16x64_bf16 v[44:47], v[36:39], a[128:135], v95
    v_smfmac_f32_16x16x64_bf16 v[48:51], v[36:39], a[208:215], v95
    v_smfmac_f32_16x16x64_bf16 v[52:55], v[36:39], v[224:231], v95
    ds_read_b128 v[64:67], v94 offset:1024
    s_waitcnt lgkmcnt(3)
    v_smfmac_f32_16x16x64_bf16 v[40:43], v[24:27], a[64:71], v95
    v_smfmac_f32_16x16x64_bf16 v[44:47], v[24:27], a[144:151], v95
    v_smfmac_f32_16x16x64_bf16 v[48:51], v[24:27], a[224:231], v95
    v_smfmac_f32_16x16x64_bf16 v[52:55], v[24:27], v[240:247], v95
    ds_read_b128 v[82:85], v94 offset:2048
    s_waitcnt lgkmcnt(3)
    v_smfmac_f32_16x16x64_bf16 v[40:43], v[28:31], a[72:79], v95
    v_smfmac_f32_16x16x64_bf16 v[44:47], v[28:31], a[152:159], v95
    v_smfmac_f32_16x16x64_bf16 v[48:51], v[28:31], a[232:239], v95
    v_smfmac_f32_16x16x64_bf16 v[52:55], v[28:31], v[248:255], v95
    v_smfmac_f32_16x16x64_bf16 v[56:59], v[32:35], v[136:143], v95
    v_smfmac_f32_16x16x64_bf16 v[56:59], v[36:39], v[144:151], v95
    s_branch L_ch_wj
L_ch_w2:
L_ch_spg2:
    v_max3_u32 v36, v60, v61, v62
    v_max3_u32 v37, v63, v64, v65
    v_max3_u32 v38, v66, v67, v68
    v_max3_u32 v39, v69, v70, v71
    v_max_u32 v36, v36, v37
    v_max3_u32 v36, v36, v38, v39
    v_cmp_eq_u32 vcc, -1, v36
    s_cbranch_vccz L_ch_sdg2
    v_max3_u32 v36, v60, v61, v62
    v_max3_u32 v37, v63, v64, v65
    v_max3_u32 v38, v66, v67, v68
    v_max3_u32 v39, v69, v70, v71
    v_max_u32 v36, v36, v37
    v_max3_u32 v36, v36, v38, v39
    v_cmp_eq_u32 vcc, -1, v36
    s_cbranch_vccz L_ch_sdg2
    v_max3_u32 v36, v60, v61, v62
    v_max3_u32 v37, v63, v64, v65
    v_max3_u32 v38, v66, v67, v68
    v_max3_u32 v39, v69, v70, v71
    v_max_u32 v36, v36, v37
    v_max3_u32 v36, v36, v38, v39
    v_cmp_eq_u32 vcc, -1, v36
    s_cbranch_vccz L_ch_sdg2
    buffer_load_dwordx4 v[60:63], v3, s[8:11], s51 offen sc1
    buffer_load_dwordx4 v[64:67], v3, s[8:11], s56 offen sc1
    s_mov_b64 exec, s[24:25]
    buffer_load_dwordx4 v[68:71], v4, s[8:11], s51 offen sc1
    s_mov_b64 exec, -1
    s_branch L_ch_spg2
L_ch_sdg2:
    ds_write_b128 v3, v[60:63] offset:0
    ds_write_b128 v3, v[64:67] offset:4096
    s_mov_b64 exec, s[24:25]
    ds_write_b128 v4, v[68:71] offset:0
    s_mov_b64 exec, -1
    v_smfmac_f32_16x16x64_bf16 v[40:43], v[60:63], a[16:23], v95
    s_and_b32 s18, s54, 1
    s_mul_i32 s18, s18, 12288
    s_add_u32 s18, s18, s62
    s_mov_b32 m0, s18
    v_smfmac_f32_16x16x64_bf16 v[44:47], v[60:63], a[96:103], v95
    s_add_u32 s19, s47, 3072
    s_nop 0
    buffer_load_dwordx4 v22, s[8:11], s47 offen sc1 lds
    buffer_load_dwordx4 v22, s[8:11], s19 offen offset:1024 sc1 lds
    s_sub_u32 s19, s48, 2048
    buffer_load_dwordx4 v8, s[8:11], s19 offen offset:2048 sc1 lds
    v_smfmac_f32_16x16x64_bf16 v[48:51], v[60:63], a[176:183], v95
    s_mov_b64 exec, s[24:25]
    buffer_load_dword v7, v8, s[8:11], s98 offen sc1
    s_mov_b64 exec, -1
    s_waitcnt lgkmcnt(0)
    s_barrier
    ds_read_b128 v[32:35], v8 offset:0
    ds_read_b128 v[36:39], v8 offset:1024
    ds_read_b128 v[24:27], v8 offset:3072
    v_smfmac_f32_16x16x64_bf16 v[52:55], v[60:63], v[192:199], v95
    v_smfmac_f32_16x16x64_bf16 v[56:59], v[60:63], v[112:119], v95
    v_xor_b32 v78, 128, v22
    s_mov_b64 exec, s[4:5]
    buffer_store_dwordx4 v[72:75], v78, s[8:11], s49 offen sc1
    s_mov_b64 exec, -1
    v_smfmac_f32_16x16x64_bf16 v[40:43], v[64:67], a[48:55], v95
    v_smfmac_f32_16x16x64_bf16 v[44:47], v[64:67], a[128:135], v95
    v_smfmac_f32_16x16x64_bf16 v[48:51], v[64:67], a[208:215], v95
    v_smfmac_f32_16x16x64_bf16 v[52:55], v[64:67], v[224:231], v95
    buffer_store_dwordx2 v[84:85], v23, s[8:11], s50 offen sc1
    s_cmp_eq_u32 s17, 0
    s_cselect_b32 s18, 0, 131072
    s_add_u32 s49, s49, s18
    s_add_u32 s50, s50, s18
    v_smfmac_f32_16x16x64_bf16 v[56:59], v[64:67], v[144:151], v95
    ds_read_b128 v[28:31], v8 offset:4096
    s_waitcnt lgkmcnt(3)
    v_smfmac_f32_16x16x64_bf16 v[40:43], v[32:35], a[0:7], v95
    v_smfmac_f32_16x16x64_bf16 v[44:47], v[32:35], a[80:87], v95
    v_smfmac_f32_16x16x64_bf16 v[48:51], v[32:35], a[160:167], v95
    v_smfmac_f32_16x16x64_bf16 v[52:55], v[32:35], v[176:183], v95
    v_smfmac_f32_16x16x64_bf16 v[56:59], v[32:35], v[96:103], v95
    ds_read_b128 v[32:35], v8 offset:5120
    s_waitcnt lgkmcnt(3)
    v_smfmac_f32_16x16x64_bf16 v[40:43], v[36:39], a[8:15], v95
    v_smfmac_f32_16x16x64_bf16 v[44:47], v[36:39], a[88:95], v95
    v_smfmac_f32_16x16x64_bf16 v[48:51], v[36:39], a[168:175], v95
    v_smfmac_f32_16x16x64_bf16 v[52:55], v[36:39], v[184:191], v95
    v_smfmac_f32_16x16x64_bf16 v[56:59], v[36:39], v[104:111], v95
    v_mov_b32 v78, -1
    v_mov_b32 v79, -1
    s_mov_b64 exec, s[20:21]
    s_cmp_lg_u32 s63, 0
    s_cbranch_scc1 L_chs_11
    buffer_store_dwordx2 v[78:79], v11, s[8:11], s28 offen
L_chs_12:
    s_mov_b64 exec, -1
    ds_read_b128 v[36:39], v8 offset:7168
    s_waitcnt lgkmcnt(3)
    v_smfmac_f32_16x16x64_bf16 v[40:43], v[24:27], a[24:31], v95
    v_smfmac_f32_16x16x64_bf16 v[44:47], v[24:27], a[104:111], v95
    v_smfmac_f32_16x16x64_bf16 v[48:51], v[24:27], a[184:191], v95
    v_smfmac_f32_16x16x64_bf16 v[52:55], v[24:27], v[200:207], v95
    v_smfmac_f32_16x16x64_bf16 v[56:59], v[24:27], v[120:127], v95
    s_mov_b64 exec, s[22:23]
    s_cmp_lg_u32 s63, 0
    s_cbranch_scc1 L_chs_13
    buffer_store_dword v78, v18, s[8:11], s29 offen
L_chs_14:
    s_mov_b64 exec, -1
    ds_read_b128 v[24:27], v8 offset:8192
    s_waitcnt lgkmcnt(3)
    v_smfmac_f32_16x16x64_bf16 v[40:43], v[28:31], a[32:39], v95
    v_smfmac_f32_16x16x64_bf16 v[44:47], v[28:31], a[112:119], v95
    v_smfmac_f32_16x16x64_bf16 v[48:51], v[28:31], a[192:199], v95
    v_smfmac_f32_16x16x64_bf16 v[52:55], v[28:31], v[208:215], v95
    v_smfmac_f32_16x16x64_bf16 v[56:59], v[28:31], v[128:135], v95
    ds_read_b128 v[28:31], v8 offset:9216
    s_waitcnt lgkmcnt(3)
    v_smfmac_f32_16x16x64_bf16 v[40:43], v[32:35], a[40:47], v95
    v_smfmac_f32_16x16x64_bf16 v[44:47], v[32:35], a[120:127], v95
    v_smfmac_f32_16x16x64_bf16 v[48:51], v[32:35], a[200:207], v95
    v_smfmac_f32_16x16x64_bf16 v[52:55], v[32:35], v[216:223], v95
    s_waitcnt vmcnt(8)
    ds_read_b128 v[60:63], v94
    s_waitcnt lgkmcnt(3)
    v_smfmac_f32_16x16x64_bf16 v[40:43], v[36:39], a[56:63], v95
    v_smfmac_f32_16x16x64_bf16 v[44:47], v[36:39], a[136:143], v95
    v_smfmac_f32_16x16x64_bf16 v[48:51], v[36:39], a[216:223], v95
    v_smfmac_f32_16x16x64_bf16 v[52:55], v[36:39], v[232:239], v95
    ds_read_b128 v[64:67], v94 offset:1024
    s_waitcnt lgkmcnt(3)
    v_smfmac_f32_16x16x64_bf16 v[40:43], v[24:27], a[64:71], v95
    v_smfmac_f32_16x16x64_bf16 v[44:47], v[24:27], a[144:151], v95
    v_smfmac_f32_16x16x64_bf16 v[48:51], v[24:27], a[224:231], v95
    v_smfmac_f32_16x16x64_bf16 v[52:55], v[24:27], v[240:247], v95
    ds_read_b128 v[82:85], v94 offset:2048
    s_waitcnt lgkmcnt(3)
    v_smfmac_f32_16x16x64_bf16 v[40:43], v[28:31], a[72:79], v95
    v_smfmac_f32_16x16x64_bf16 v[44:47], v[28:31], a[152:159], v95
    v_smfmac_f32_16x16x64_bf16 v[48:51], v[28:31], a[232:239], v95
    v_smfmac_f32_16x16x64_bf16 v[52:55], v[28:31], v[248:255], v95
    v_smfmac_f32_16x16x64_bf16 v[56:59], v[32:35], v[136:143], v95
    v_smfmac_f32_16x16x64_bf16 v[56:59], v[36:39], v[152:159], v95
    s_branch L_ch_wj
L_ch_w1:
L_ch_spg1:
    v_max3_u32 v36, v60, v61, v62
    v_max3_u32 v37, v63, v64, v65
    v_max3_u32 v38, v66, v67, v68
    v_max3_u32 v39, v69, v70, v71
    v_max_u32 v36, v36, v37
    v_max3_u32 v36, v36, v38, v39
    v_cmp_eq_u32 vcc, -1, v36
    s_cbranch_vccz L_ch_sdg1
    v_max3_u32 v36, v60, v61, v62
    v_max3_u32 v37, v63, v64, v65
    v_max3_u32 v38, v66, v67, v68
    v_max3_u32 v39, v69, v70, v71
    v_max_u32 v36, v36, v37
    v_max3_u32 v36, v36, v38, v39
    v_cmp_eq_u32 vcc, -1, v36
    s_cbranch_vccz L_ch_sdg1
    v_max3_u32 v36, v60, v61, v62
    v_max3_u32 v37, v63, v64, v65
    v_max3_u32 v38, v66, v67, v68
    v_max3_u32 v39, v69, v70, v71
    v_max_u32 v36, v36, v37
    v_max3_u32 v36, v36, v38, v39
    v_cmp_eq_u32 vcc, -1, v36
    s_cbranch_vccz L_ch_sdg1
    buffer_load_dwordx4 v[60:63], v3, s[8:11], s51 offen sc1
    buffer_load_dwordx4 v[64:67], v3, s[8:11], s56 offen sc1
    s_mov_b64 exec, s[24:25]
    buffer_load_dwordx4 v[68:71], v4, s[8:11], s51 offen sc1
    s_mov_b64 exec, -1
    s_branch L_ch_spg1
L_ch_sdg1:
    ds_write_b128 v3, v[60:63] offset:0
    ds_write_b128 v3, v[64:67] offset:4096
    s_mov_b64 exec, s[24:25]
    ds_write_b128 v4, v[68:71] offset:0
    s_mov_b64 exec, -1
    v_smfmac_f32_16x16x64_bf16 v[40:43], v[60:63], a[8:15], v95
    s_and_b32 s18, s54, 1
    s_mul_i32 s18, s18, 12288
    s_add_u32 s18, s18, s62
    s_mov_b32 m0, s18
    v_smfmac_f32_16x16x64_bf16 v[44:47], v[60:63], a[88:95], v95
    s_add_u32 s19, s47, 3072
    s_nop 0
    buffer_load_dwordx4 v22, s[8:11], s47 offen sc1 lds
    buffer_load_dwordx4 v22, s[8:11], s19 offen offset:1024 sc1 lds
    s_sub_u32 s19, s48, 2048
    buffer_load_dwordx4 v8, s[8:11], s19 offen offset:2048 sc1 lds
    v_smfmac_f32_16x16x64_bf16 v[48:51], v[60:63], a[168:175], v95
    s_mov_b64 exec, s[24:25]
    buffer_load_dword v7, v8, s[8:11], s98 offen sc1
    s_mov_b64 exec, -1
    s_waitcnt lgkmcnt(0)
    s_barrier
    ds_read_b128 v[32:35], v8 offset:0
    ds_read_b128 v[36:39], v8 offset:2048
    ds_read_b128 v[24:27], v8 offset:3072
    v_smfmac_f32_16x16x64_bf16 v[52:55], v[60:63], v[184:191], v95
    v_smfmac_f32_16x16x64_bf16 v[56:59], v[60:63], v[104:111], v95
    v_xor_b32 v78, 128, v22
    s_mov_b64 exec, s[4:5]
    buffer_store_dwordx4 v[72:75], v78, s[8:11], s49 offen sc1
    s_mov_b64 exec, -1
    v_smfmac_f32_16x16x64_bf16 v[40:43], v[64:67], a[40:47], v95
    v_smfmac_f32_16x16x64_bf16 v[44:47], v[64:67], a[120:127], v95
    v_smfmac_f32_16x16x64_bf16 v[48:51], v[64:67], a[200:207], v95
    v_smfmac_f32_16x16x64_bf16 v[52:55], v[64:67], v[216:223], v95
    buffer_store_dwordx2 v[84:85], v23, s[8:11], s50 offen sc1
    s_cmp_eq_u32 s17, 0
    s_cselect_b32 s18, 0, 131072
    s_add_u32 s49, s49, s18
    s_add_u32 s50, s50, s18
    v_smfmac_f32_16x16x64_bf16 v[56:59], v[64:67], v[136:143], v95
    ds_read_b128 v[28:31], v8 offset:4096
    s_waitcnt lgkmcnt(3)
    v_smfmac_f32_16x16x64_bf16 v[40:43], v[32:35], a[0:7], v95
    v_smfmac_f32_16x16x64_bf16 v[44:47], v[32:35], a[80:87], v95
    v_smfmac_f32_16x16x64_bf16 v[48:51], v[32:35], a[160:167], v95
    v_smfmac_f32_16x16x64_bf16 v[52:55], v[32:35], v[176:183], v95
    v_smfmac_f32_16x16x64_bf16 v[56:59], v[32:35], v[96:103], v95
    ds_read_b128 v[32:35], v8 offset:6144
    s_waitcnt lgkmcnt(3)
    v_smfmac_f32_16x16x64_bf16 v[40:43], v[36:39], a[16:23], v95
    v_smfmac_f32_16x16x64_bf16 v[44:47], v[36:39], a[96:103], v95
    v_smfmac_f32_16x16x64_bf16 v[48:51], v[36:39], a[176:183], v95
    v_smfmac_f32_16x16x64_bf16 v[52:55], v[36:39], v[192:199], v95
    v_smfmac_f32_16x16x64_bf16 v[56:59], v[36:39], v[112:119], v95
    v_mov_b32 v78, -1
    v_mov_b32 v79, -1
    s_mov_b64 exec, s[20:21]
    s_cmp_lg_u32 s63, 0
    s_cbranch_scc1 L_chs_15
    buffer_store_dwordx2 v[78:79], v11, s[8:11], s28 offen
L_chs_16:
    s_mov_b64 exec, -1
    ds_read_b128 v[36:39], v8 offset:7168
    s_waitcnt lgkmcnt(3)
    v_smfmac_f32_16x16x64_bf16 v[40:43], v[24:27], a[24:31], v95
    v_smfmac_f32_16x16x64_bf16 v[44:47], v[24:27], a[104:111], v95
    v_smfmac_f32_16x16x64_bf16 v[48:51], v[24:27], a[184:191], v95
    v_smfmac_f32_16x16x64_bf16 v[52:55], v[24:27], v[200:207], v95
    v_smfmac_f32_16x16x64_bf16 v[56:59], v[24:27], v[120:127], v95
    s_mov_b64 exec, s[22:23]
    s_cmp_lg_u32 s63, 0
    s_cbranch_scc1 L_chs_17
    buffer_store_dword v78, v18, s[8:11], s29 offen
L_chs_18:
    s_mov_b64 exec, -1
    ds_read_b128 v[24:27], v8 offset:8192
    s_waitcnt lgkmcnt(3)
    v_smfmac_f32_16x16x64_bf16 v[40:43], v[28:31], a[32:39], v95
    v_smfmac_f32_16x16x64_bf16 v[44:47], v[28:31], a[112:119], v95
    v_smfmac_f32_16x16x64_bf16 v[48:51], v[28:31], a[192:199], v95
    v_smfmac_f32_16x16x64_bf16 v[52:55], v[28:31], v[208:215], v95
    v_smfmac_f32_16x16x64_bf16 v[56:59], v[28:31], v[128:135], v95
    ds_read_b128 v[28:31], v8 offset:9216
    s_waitcnt lgkmcnt(3)
    v_smfmac_f32_16x16x64_bf16 v[40:43], v[32:35], a[48:55], v95
    v_smfmac_f32_16x16x64_bf16 v[44:47], v[32:35], a[128:135], v95
    v_smfmac_f32_16x16x64_bf16 v[48:51], v[32:35], a[208:215], v95
    v_smfmac_f32_16x16x64_bf16 v[52:55], v[32:35], v[224:231], v95
    s_waitcnt vmcnt(8)
    ds_read_b128 v[60:63], v94
    s_waitcnt lgkmcnt(3)
    v_smfmac_f32_16x16x64_bf16 v[40:43], v[36:39], a[56:63], v95
    v_smfmac_f32_16x16x64_bf16 v[44:47], v[36:39], a[136:143], v95
    v_smfmac_f32_16x16x64_bf16 v[48:51], v[36:39], a[216:223], v95
    v_smfmac_f32_16x16x64_bf16 v[52:55], v[36:39], v[232:239], v95
    ds_read_b128 v[64:67], v94 offset:1024
    s_waitcnt lgkmcnt(3)
    v_smfmac_f32_16x16x64_bf16 v[40:43], v[24:27], a[64:71], v95
    v_smfmac_f32_16x16x64_bf16 v[44:47], v[24:27], a[144:151], v95
    v_smfmac_f32_16x16x64_bf16 v[48:51], v[24:27], a[224:231], v95
    v_smfmac_f32_16x16x64_bf16 v[52:55], v[24:27], v[240:247], v95
    ds_read_b128 v[82:85], v94 offset:2048
    s_waitcnt lgkmcnt(3)
    v_smfmac_f32_16x16x64_bf16 v[40:43], v[28:31], a[72:79], v95
    v_smfmac_f32_16x16x64_bf16 v[44:47], v[28:31], a[152:159], v95
    v_smfmac_f32_16x16x64_bf16 v[48:51], v[28:31], a[232:239], v95
    v_smfmac_f32_16x16x64_bf16 v[52:55], v[28:31], v[248:255], v95
    v_smfmac_f32_16x16x64_bf16 v[56:59], v[32:35], v[144:151], v95
    v_smfmac_f32_16x16x64_bf16 v[56:59], v[36:39], v[152:159], v95
    s_branch L_ch_wj
L_ch_w0:
L_ch_spg0:
    v_max3_u32 v36, v60, v61, v62
    v_max3_u32 v37, v63, v64, v65
    v_max3_u32 v38, v66, v67, v68
    v_max3_u32 v39, v69, v70, v71
    v_max_u32 v36, v36, v37
    v_max3_u32 v36, v36, v38, v39
    v_cmp_eq_u32 vcc, -1, v36
    s_cbranch_vccz L_ch_sdg0
    v_max3_u32 v36, v60, v61, v62
    v_max3_u32 v37, v63, v64, v65
    v_max3_u32 v38, v66, v67, v68
    v_max3_u32 v39, v69, v70, v71
    v_max_u32 v36, v36, v37
    v_max3_u32 v36, v36, v38, v39
    v_cmp_eq_u32 vcc, -1, v36
    s_cbranch_vccz L_ch_sdg0
    v_max3_u32 v36, v60, v61, v62
    v_max3_u32 v37, v63, v64, v65
    v_max3_u32 v38, v66, v67, v68
    v_max3_u32 v39, v69, v70, v71
    v_max_u32 v36, v36, v37
    v_max3_u32 v36, v36, v38, v39
    v_cmp_eq_u32 vcc, -1, v36
    s_cbranch_vccz L_ch_sdg0
    buffer_load_dwordx4 v[60:63], v3, s[8:11], s51 offen sc1
    buffer_load_dwordx4 v[64:67], v3, s[8:11], s56 offen sc1
    s_mov_b64 exec, s[24:25]
    buffer_load_dwordx4 v[68:71], v4, s[8:11], s51 offen sc1
    s_mov_b64 exec, -1
    s_branch L_ch_spg0
L_ch_sdg0:
    ds_write_b128 v3, v[60:63] offset:0
    ds_write_b128 v3, v[64:67] offset:4096
    s_mov_b64 exec, s[24:25]
    ds_write_b128 v4, v[68:71] offset:0
    s_mov_b64 exec, -1
    v_smfmac_f32_16x16x64_bf16 v[40:43], v[60:63], a[0:7], v95
    s_and_b32 s18, s54, 1
    s_mul_i32 s18, s18, 12288
    s_add_u32 s18, s18, s62
    s_mov_b32 m0, s18
    v_smfmac_f32_16x16x64_bf16 v[44:47], v[60:63], a[80:87], v95
    s_add_u32 s19, s47, 3072
    s_nop 0
    buffer_load_dwordx4 v22, s[8:11], s47 offen sc1 lds
    buffer_load_dwordx4 v22, s[8:11], s19 offen offset:1024 sc1 lds
    s_sub_u32 s19, s48, 2048
    buffer_load_dwordx4 v8, s[8:11], s19 offen offset:2048 sc1 lds
    v_smfmac_f32_16x16x64_bf16 v[48:51], v[60:63], a[160:167], v95
    s_mov_b64 exec, s[24:25]
    buffer_load_dword v7, v8, s[8:11], s98 offen sc1
    s_mov_b64 exec, -1
    s_waitcnt lgkmcnt(0)
    s_barrier
    ds_read_b128 v[32:35], v8 offset:1024
    ds_read_b128 v[36:39], v8 offset:2048
    ds_read_b128 v[24:27], v8 offset:3072
    v_smfmac_f32_16x16x64_bf16 v[52:55], v[60:63], v[176:183], v95
    v_smfmac_f32_16x16x64_bf16 v[56:59], v[60:63], v[96:103], v95
    v_xor_b32 v78, 128, v22
    s_mov_b64 exec, s[4:5]
    buffer_store_dwordx4 v[72:75], v78, s[8:11], s49 offen sc1
    s_mov_b64 exec, -1
    v_smfmac_f32_16x16x64_bf16 v[40:43], v[64:67], a[32:39], v95
    v_smfmac_f32_16x16x64_bf16 v[44:47], v[64:67], a[112:119], v95
    v_smfmac_f32_16x16x64_bf16 v[48:51], v[64:67], a[192:199], v95
    v_smfmac_f32_16x16x64_bf16 v[52:55], v[64:67], v[208:215], v95
    buffer_store_dwordx2 v[84:85], v23, s[8:11], s50 offen sc1
    s_cmp_eq_u32 s17, 0
    s_cselect_b32 s18, 0, 131072
    s_add_u32 s49, s49, s18
    s_add_u32 s50, s50, s18
    v_smfmac_f32_16x16x64_bf16 v[56:59], v[64:67], v[128:135], v95
    ds_read_b128 v[28:31], v8 offset:5120
    s_waitcnt lgkmcnt(3)
    v_smfmac_f32_16x16x64_bf16 v[40:43], v[32:35], a[8:15], v95
    v_smfmac_f32_16x16x64_bf16 v[44:47], v[32:35], a[88:95], v95
    v_smfmac_f32_16x16x64_bf16 v[48:51], v[32:35], a[168:175], v95
    v_smfmac_f32_16x16x64_bf16 v[52:55], v[32:35], v[184:191], v95
    v_smfmac_f32_16x16x64_bf16 v[56:59], v[32:35], v[104:111], v95
    ds_read_b128 v[32:35], v8 offset:6144
    s_waitcnt lgkmcnt(3)
    v_smfmac_f32_16x16x64_bf16 v[40:43], v[36:39], a[16:23], v95
    v_smfmac_f32_16x16x64_bf16 v[44:47], v[36:39], a[96:103], v95
    v_smfmac_f32_16x16x64_bf16 v[48:51], v[36:39], a[176:183], v95
    v_smfmac_f32_16x16x64_bf16 v[52:55], v[36:39], v[192:199], v95
    v_smfmac_f32_16x16x64_bf16 v[56:59], v[36:39], v[112:119], v95
    v_mov_b32 v78, -1
    v_mov_b32 v79, -1
    s_mov_b64 exec, s[20:21]
    s_cmp_lg_u32 s63, 0
    s_cbranch_scc1 L_chs_19
    buffer_store_dwordx2 v[78:79], v11, s[8:11], s28 offen
L_chs_20:
    s_mov_b64 exec, -1
    ds_read_b128 v[36:39], v8 offset:7168
    s_waitcnt lgkmcnt(3)
    v_smfmac_f32_16x16x64_bf16 v[40:43], v[24:27], a[24:31], v95
    v_smfmac_f32_16x16x64_bf16 v[44:47], v[24:27], a[104:111], v95
    v_smfmac_f32_16x16x64_bf16 v[48:51], v[24:27], a[184:191], v95
    v_smfmac_f32_16x16x64_bf16 v[52:55], v[24:27], v[200:207], v95
    v_smfmac_f32_16x16x64_bf16 v[56:59], v[24:27], v[120:127], v95
    s_mov_b64 exec, s[22:23]
    s_cmp_lg_u32 s63, 0
    s_cbranch_scc1 L_chs_21
    buffer_store_dword v78, v18, s[8:11], s29 offen
L_chs_22:
    s_mov_b64 exec, -1
    ds_read_b128 v[24:27], v8 offset:8192
    s_waitcnt lgkmcnt(3)
    v_smfmac_f32_16x16x64_bf16 v[40:43], v[28:31], a[40:47], v95
    v_smfmac_f32_16x16x64_bf16 v[44:47], v[28:31], a[120:127], v95
    v_smfmac_f32_16x16x64_bf16 v[48:51], v[28:31], a[200:207], v95
    v_smfmac_f32_16x16x64_bf16 v[52:55], v[28:31], v[216:223], v95
    v_smfmac_f32_16x16x64_bf16 v[56:59], v[28:31], v[136:143], v95
    ds_read_b128 v[28:31], v8 offset:9216
    s_waitcnt lgkmcnt(3)
    v_smfmac_f32_16x16x64_bf16 v[40:43], v[32:35], a[48:55], v95
    v_smfmac_f32_16x16x64_bf16 v[44:47], v[32:35], a[128:135], v95
    v_smfmac_f32_16x16x64_bf16 v[48:51], v[32:35], a[208:215], v95
    v_smfmac_f32_16x16x64_bf16 v[52:55], v[32:35], v[224:231], v95
    s_waitcnt vmcnt(8)
    ds_read_b128 v[60:63], v94
    s_waitcnt lgkmcnt(3)
    v_smfmac_f32_16x16x64_bf16 v[40:43], v[36:39], a[56:63], v95
    v_smfmac_f32_16x16x64_bf16 v[44:47], v[36:39], a[136:143], v95
    v_smfmac_f32_16x16x64_bf16 v[48:51], v[36:39], a[216:223], v95
    v_smfmac_f32_16x16x64_bf16 v[52:55], v[36:39], v[232:239], v95
    ds_read_b128 v[64:67], v94 offset:1024
    s_waitcnt lgkmcnt(3)
    v_smfmac_f32_16x16x64_bf16 v[40:43], v[24:27], a[64:71], v95
    v_smfmac_f32_16x16x64_bf16 v[44:47], v[24:27], a[144:151], v95
    v_smfmac_f32_16x16x64_bf16 v[48:51], v[24:27], a[224:231], v95
    v_smfmac_f32_16x16x64_bf16 v[52:55], v[24:27], v[240:247], v95
    ds_read_b128 v[82:85], v94 offset:2048
    s_waitcnt lgkmcnt(3)
    v_smfmac_f32_16x16x64_bf16 v[40:43], v[28:31], a[72:79], v95
    v_smfmac_f32_16x16x64_bf16 v[44:47], v[28:31], a[152:159], v95
    v_smfmac_f32_16x16x64_bf16 v[48:51], v[28:31], a[232:239], v95
    v_smfmac_f32_16x16x64_bf16 v[52:55], v[28:31], v[248:255], v95
    v_smfmac_f32_16x16x64_bf16 v[56:59], v[32:35], v[144:151], v95
    v_smfmac_f32_16x16x64_bf16 v[56:59], v[36:39], v[152:159], v95
    s_nop 1
L_ch_wj:
    v_permlane32_swap_b32 v40, v44
    v_permlane32_swap_b32 v41, v45
    v_permlane32_swap_b32 v42, v46
    v_permlane32_swap_b32 v43, v47
    v_permlane32_swap_b32 v48, v52
    v_permlane32_swap_b32 v49, v53
    v_permlane32_swap_b32 v50, v54
    v_permlane32_swap_b32 v51, v55
    v_pk_add_f32 v[40:41], v[40:41], v[44:45]
    v_pk_add_f32 v[42:43], v[42:43], v[46:47]
    v_pk_add_f32 v[48:49], v[48:49], v[52:53]
    v_pk_add_f32 v[50:51], v[50:51], v[54:55]
    v_cvt_pk_bf16_f32 v68, v40, v41
    v_cvt_pk_bf16_f32 v69, v42, v43
    v_cvt_pk_bf16_f32 v70, v48, v49
    v_cvt_pk_bf16_f32 v71, v50, v51
    s_nop 0
    v_mfma_f32_16x16x32_bf16 v[72:75], v[68:71], v[86:89], 0
    v_mfma_f32_16x16x32_bf16 v[76:79], v[68:71], v[90:93], 0
    v_smfmac_f32_16x16x64_bf16 v[56:59], v[24:27], v[160:167], v95
    v_xor_b32 v36, 128, v22
    s_waitcnt lgkmcnt(0)
    s_nop 3
    v_cvt_pk_bf16_f32 v44, v72, v73
    v_cvt_pk_bf16_f32 v45, v74, v75
    v_cvt_pk_bf16_f32 v46, v76, v77
    v_cvt_pk_bf16_f32 v47, v78, v79
    s_cmp_eq_u32 s17, 63
    s_cbranch_scc1 L_ch_last
    v_mfma_f32_16x16x32_bf16 v[72:75], v[60:63], v[44:47], 0
    v_mfma_f32_16x16x32_bf16 v[76:79], v[64:67], v[44:47], 0
    v_mfma_f32_16x16x32_bf16 v[68:71], v[44:47], v[44:47], 0
    v_smfmac_f32_16x16x64_bf16 v[56:59], v[28:31], v[168:175], v95
    ds_write_b128 v15, v[44:47]
    v_mov_b32 v36, 0xff800000
    v_mov_b32 v39, 0x3e0293ee
    v_mov_b32 v66, 0
    v_mov_b32 v67, 0
    v_mov_b32 v86, 0
    v_mov_b32 v87, 0
    s_nop 1
    s_mov_b64 exec, s[20:21]
    ds_write_b128 v13, v[72:75] offset:512
    ds_write_b128 v13, v[76:79] offset:1024
    ds_write_b128 v13, v[68:71]
    s_mov_b64 exec, -1
    v_mov_b32 v40, v56
    v_mov_b32 v41, v57
    v_mov_b32 v42, v58
    v_mov_b32 v43, v59
    s_nop 1
    v_permlane32_swap_b32 v56, v40
    v_permlane32_swap_b32 v57, v41
    v_permlane32_swap_b32 v58, v42
    v_permlane32_swap_b32 v59, v43
    v_pk_add_f32 v[40:41], v[40:41], v[56:57]
    v_pk_add_f32 v[42:43], v[42:43], v[58:59]
    v_cvt_pk_bf16_f32 v80, v40, v41
    v_cvt_pk_bf16_f32 v81, v42, v43
    s_cmp_ge_u32 s17, 61
    s_cbranch_scc1 L_ch_e0
L_ch_e0d:
    s_waitcnt lgkmcnt(0)
    s_barrier
    ds_read2st64_b64 v[40:43], v19 offset1:3
    ds_read2st64_b64 v[44:47], v19 offset0:6 offset1:9
    ds_read_b128 v[24:27], v1 offset:0
    ds_read_b128 v[28:31], v1 offset:1536
    ds_read_b128 v[32:35], v1 offset:3072
    ds_read_b128 v[48:51], v1 offset:4608
    ds_write_b64 v15, v[80:81] offset:1024
    s_waitcnt lgkmcnt(5)
    v_pk_add_f32 v[40:41], v[40:41], v[42:43]
    v_pk_add_f32 v[44:45], v[44:45], v[46:47]
    v_pk_add_f32 v[40:41], v[40:41], v[44:45]
    s_waitcnt lgkmcnt(3)
    v_pk_add_f32 v[24:25], v[24:25], v[28:29]
    v_pk_add_f32 v[26:27], v[26:27], v[30:31]
    v_cndmask_b32 v28, v40, v36, s[24:25]
    v_cndmask_b32 v29, v41, v36, s[24:25]
    v_mov_b32 v30, 0x43c80000
    s_waitcnt lgkmcnt(1)
    v_pk_add_f32 v[32:33], v[32:33], v[48:49]
    v_pk_add_f32 v[34:35], v[34:35], v[50:51]
    v_pk_add_f32 v[24:25], v[24:25], v[32:33]
    v_pk_add_f32 v[26:27], v[26:27], v[34:35]
    v_max3_f32 v37, |v24|, |v25|, |v26|
    v_max3_f32 v38, |v27|, v28, v29
    v_max_f32 v37, v37, v38
    v_cmp_nle_f32 vcc, v37, v30
    s_cbranch_vccnz L_ch_mx
    v_pk_mul_f32 v[24:25], v[24:25], v[38:39] op_sel:[0,1] op_sel_hi:[1,1]
    v_pk_mul_f32 v[26:27], v[26:27], v[38:39] op_sel:[0,1] op_sel_hi:[1,1]
    v_pk_mul_f32 v[28:29], v[28:29], v[38:39] op_sel:[0,1] op_sel_hi:[1,1]
L_ch_mxd:
    v_exp_f32 v28, v28
    v_exp_f32 v29, v29
    v_exp_f32 v24, v24
    v_exp_f32 v25, v25
    v_exp_f32 v26, v26
    v_exp_f32 v27, v27
    v_cvt_pk_bf16_f32 v60, v28, v29
    v_cvt_pk_bf16_f32 v62, v24, v25
    v_cvt_pk_bf16_f32 v63, v26, v27
    v_add_f32 v37, v28, v29
    v_mov_b32_dpp v61, v60 row_ror:8 row_mask:0xf bank_mask:0xf
    v_mov_b32_dpp v64, v62 row_ror:8 row_mask:0xf bank_mask:0xf
    v_mov_b32_dpp v65, v63 row_ror:8 row_mask:0xf bank_mask:0xf
    v_mfma_f32_16x16x32_bf16 v[40:43], v[80:83], v[60:63], 0
    v_add_f32 v38, v24, v25
    v_add_f32 v37, v37, v26
    v_mfma_f32_16x16x32_bf16 v[40:43], v[84:87], v[64:67], v[40:43]
    v_add_f32 v38, v38, v27
    v_add_f32 v37, v37, v38
    s_nop 1
    v_add_f32 v37, v37, v37 row_ror:8
    v_mov_b32 v38, v37
    s_nop 1
    v_permlane16_swap_b32 v37, v38
    v_add_f32 v37, v37, v38
    v_mov_b32 v38, v37
    s_nop 1
    v_permlane32_swap_b32 v37, v38
    v_add_f32 v37, v37, v38
    v_rcp_f32 v37, v37
    ds_read_b128 a[240:243], v9 offset:0
    v_pk_mul_f32 v[40:41], v[40:41], v[36:37] op_sel:[0,1] op_sel_hi:[1,1]
    v_pk_mul_f32 v[42:43], v[42:43], v[36:37] op_sel:[0,1] op_sel_hi:[1,1]
    v_cvt_pk_bf16_f32 v40, v40, v41
    v_cvt_pk_bf16_f32 v41, v42, v43
    v_min_u32 v40, -2, v40
    v_min_u32 v41, -2, v41
    s_mov_b64 exec, s[20:21]
    s_cmp_lg_u32 s63, 0
    s_cbranch_scc1 L_chs_23
    buffer_store_dwordx2 v[40:41], v11, s[8:11], s42 offen
L_chs_24:
    s_mov_b64 exec, -1
    v_mov_b32 v24, -1
    v_mov_b32 v25, -1
    v_mov_b32 v26, -1
    v_mov_b32 v27, -1
    v_mov_b32 v28, -1
    v_mov_b32 v29, -1
    v_mov_b32 v30, -1
    v_mov_b32 v31, -1
    ds_read_b128 a[244:247], v9 offset:16384
    ds_read_b128 a[248:251], v9 offset:32768
    ds_read_b128 a[252:255], v10 offset:0
    ds_read_b128 v[88:91], v10 offset:16384
    ds_read_b128 v[92:95], v9 offset:1024
    ds_read_b128 v[56:59], v9 offset:17408
    ds_read_b128 v[44:47], v9 offset:33792
    ds_read_b128 v[48:51], v10 offset:1024
    ds_read_b128 v[52:55], v10 offset:17408
    ds_read_b128 v[84:87], v9 offset:2048
    ds_read_b128 v[80:83], v9 offset:18432
    s_sleep 2
    buffer_load_dwordx4 v[24:27], v12, s[8:11], s42 offen sc1
    buffer_load_dwordx4 v[28:31], v12, s[8:11], s42 offen offset:1024 sc1
L_ch_spo:
    v_max3_u32 v38, v24, v25, v26
    v_max3_u32 v39, v27, v28, v29
    v_max_u32 v37, v30, v31
    v_max3_u32 v38, v38, v39, v37
    v_cmp_eq_u32 vcc, -1, v38
    s_cbranch_vccz L_ch_sdo
    v_max3_u32 v38, v24, v25, v26
    v_max3_u32 v39, v27, v28, v29
    v_max_u32 v37, v30, v31
    v_max3_u32 v38, v38, v39, v37
    v_cmp_eq_u32 vcc, -1, v38
    s_cbranch_vccz L_ch_sdo
    v_max3_u32 v38, v24, v25, v26
    v_max3_u32 v39, v27, v28, v29
    v_max_u32 v37, v30, v31
    v_max3_u32 v38, v38, v39, v37
    v_cmp_eq_u32 vcc, -1, v38
    s_cbranch_vccz L_ch_sdo
    v_max3_u32 v38, v24, v25, v26
    v_max3_u32 v39, v27, v28, v29
    v_max_u32 v37, v30, v31
    v_max3_u32 v38, v38, v39, v37
    v_cmp_eq_u32 vcc, -1, v38
    s_cbranch_vccz L_ch_sdo
    buffer_load_dwordx4 v[24:27], v12, s[8:11], s42 offen sc1
    buffer_load_dwordx4 v[28:31], v12, s[8:11], s42 offen offset:1024 sc1
    s_branch L_ch_spo
L_ch_sdo:
    s_waitcnt lgkmcnt(0)
    v_mfma_f32_16x16x32_bf16 v[60:63], a[240:243], v[24:27], 0
    v_mov_b32_dpp v32, v24 row_ror:8 row_mask:0xf bank_mask:0xf
    v_mov_b32_dpp v33, v25 row_ror:8 row_mask:0xf bank_mask:0xf
    v_mov_b32_dpp v34, v26 row_ror:8 row_mask:0xf bank_mask:0xf
    v_mov_b32_dpp v35, v27 row_ror:8 row_mask:0xf bank_mask:0xf
    v_mfma_f32_16x16x32_bf16 v[64:67], a[244:247], v[24:27], 0
    v_mov_b32_dpp v36, v28 row_ror:8 row_mask:0xf bank_mask:0xf
    v_mov_b32_dpp v37, v29 row_ror:8 row_mask:0xf bank_mask:0xf
    v_mov_b32_dpp v38, v30 row_ror:8 row_mask:0xf bank_mask:0xf
    v_mov_b32_dpp v39, v31 row_ror:8 row_mask:0xf bank_mask:0xf
    ds_read_b128 a[240:243], v9 offset:34816
    v_mfma_f32_16x16x32_bf16 v[68:71], a[248:251], v[24:27], 0
    ds_read_b128 a[244:247], v10 offset:2048
    v_mfma_f32_16x16x32_bf16 v[72:75], a[252:255], v[24:27], 0
    ds_read_b128 a[248:251], v10 offset:18432
    v_mfma_f32_16x16x32_bf16 v[76:79], v[88:91], v[24:27], 0
    ds_read_b128 a[252:255], v9 offset:3072
    v_mfma_f32_16x16x32_bf16 v[60:63], v[92:95], v[32:35], v[60:63]
    ds_read_b128 v[88:91], v9 offset:19456
    v_mfma_f32_16x16x32_bf16 v[64:67], v[56:59], v[32:35], v[64:67]
    ds_read_b128 v[92:95], v9 offset:35840
    v_mfma_f32_16x16x32_bf16 v[68:71], v[44:47], v[32:35], v[68:71]
    ds_read_b128 v[56:59], v10 offset:3072
    v_mfma_f32_16x16x32_bf16 v[72:75], v[48:51], v[32:35], v[72:75]
    ds_read_b128 v[44:47], v10 offset:19456
    v_mfma_f32_16x16x32_bf16 v[76:79], v[52:55], v[32:35], v[76:79]
    v_mfma_f32_16x16x32_bf16 v[60:63], v[84:87], v[28:31], v[60:63]
    v_mov_b32 v42, 0
    v_mov_b32 v43, s17
    s_waitcnt vmcnt(5)
    s_mov_b64 exec, 1
    buffer_store_dword v43, v42, s[8:11], s33 offen sc1
    s_mov_b64 exec, -1
    v_mfma_f32_16x16x32_bf16 v[64:67], v[80:83], v[28:31], v[64:67]
    s_waitcnt lgkmcnt(7)
    v_mfma_f32_16x16x32_bf16 v[68:71], a[240:243], v[28:31], v[68:71]
    s_waitcnt lgkmcnt(6)
    v_mfma_f32_16x16x32_bf16 v[72:75], a[244:247], v[28:31], v[72:75]
    s_waitcnt lgkmcnt(5)
    v_mfma_f32_16x16x32_bf16 v[76:79], a[248:251], v[28:31], v[76:79]
    s_waitcnt lgkmcnt(4)
    v_mfma_f32_16x16x32_bf16 v[60:63], a[252:255], v[36:39], v[60:63]
    s_waitcnt lgkmcnt(3)
    v_mfma_f32_16x16x32_bf16 v[64:67], v[88:91], v[36:39], v[64:67]
    s_waitcnt lgkmcnt(2)
    v_mfma_f32_16x16x32_bf16 v[68:71], v[92:95], v[36:39], v[68:71]
    s_waitcnt lgkmcnt(1)
    v_mfma_f32_16x16x32_bf16 v[72:75], v[56:59], v[36:39], v[72:75]
    s_waitcnt lgkmcnt(0)
    v_mfma_f32_16x16x32_bf16 v[76:79], v[44:47], v[36:39], v[76:79]
    v_mov_b32 v92, s60
    s_mov_b64 exec, s[20:21]
    s_nop 2
    ds_write_b128 v20, v[60:63] offset:0
    ds_write_b128 v20, v[64:67] offset:512
    ds_write_b128 v20, v[68:71] offset:1024
    ds_write_b128 v20, v[72:75] offset:1536
    s_nop 4
    ds_write_b128 v20, v[76:79] offset:2048
    s_mov_b64 exec, -1
    s_waitcnt lgkmcnt(0)
    s_barrier
    ds_read_b128 v[60:63], v21
    ds_read_b128 v[64:67], v21 offset:5120
    ds_read_b128 v[68:71], v2
    ds_read_b128 v[72:75], v2 offset:5120
    s_waitcnt lgkmcnt(2)
    v_pk_add_f32 v[60:61], v[60:61], v[64:65]
    v_pk_add_f32 v[62:63], v[62:63], v[66:67]
    s_waitcnt lgkmcnt(0)
    v_pk_add_f32 v[68:69], v[68:69], v[72:73]
    v_pk_add_f32 v[70:71], v[70:71], v[74:75]
    v_add_f32 v32, v60, v60 row_ror:8 row_mask:0xf bank_mask:0x3
    v_add_f32 v33, v61, v61 row_ror:8 row_mask:0xf bank_mask:0x3
    v_add_f32 v34, v62, v62 row_ror:8 row_mask:0xf bank_mask:0x3
    v_add_f32 v35, v63, v63 row_ror:8 row_mask:0xf bank_mask:0x3
    v_add_f32 v32, v68, v68 row_ror:8 row_mask:0xf bank_mask:0xc
    v_add_f32 v33, v69, v69 row_ror:8 row_mask:0xf bank_mask:0xc
    v_add_f32 v34, v70, v70 row_ror:8 row_mask:0xf bank_mask:0xc
    v_add_f32 v35, v71, v71 row_ror:8 row_mask:0xf bank_mask:0xc
    v_and_or_b32 v32, v32, -2, v92
    v_and_or_b32 v33, v33, -2, v92
    v_and_or_b32 v34, v34, -2, v92
    v_and_or_b32 v35, v35, -2, v92
    s_mov_b64 exec, s[26:27]
    buffer_store_dwordx4 v[32:35], v14, s[8:11], s44 offen sc1
    s_cmp_lg_u32 s63, 0
    s_cbranch_scc1 L_chs_25
    buffer_store_dwordx4 v[32:35], v14, s[8:11], s43 offen
L_chs_26:
    s_mov_b64 exec, -1
    v_xor_b32 v76, 1, v92
    v_mov_b32 v77, v76
    v_mov_b32 v78, v76
    v_mov_b32 v79, v76
    v_mov_b32 v80, v76
    v_mov_b32 v81, v76
    v_mov_b32 v82, v76
    v_mov_b32 v83, v76
    s_add_u32 s17, s17, 1
    s_cmp_ge_u32 s17, 62
    s_cbranch_scc1 L_ch_ql0
L_ch_qld:
    s_and_b32 s18, s17, 3
    s_mul_i32 s51, s18, 10240
    s_add_u32 s51, s51, s41
    s_add_u32 s56, s51, 4096
    s_lshl_b32 s18, s18, 16
    s_add_u32 s42, s45, s18
    v_mov_b32 v60, -1
    v_mov_b32 v61, -1
    v_mov_b32 v62, -1
    v_mov_b32 v63, -1
    v_mov_b32 v64, -1
    v_mov_b32 v65, -1
    v_mov_b32 v66, -1
    v_mov_b32 v67, -1
    v_cndmask_b32 v68, 0, -1, s[24:25]
    v_cndmask_b32 v69, 0, -1, s[24:25]
    v_cndmask_b32 v70, 0, -1, s[24:25]
    v_cndmask_b32 v71, 0, -1, s[24:25]
    v_mov_b32 v50, 0x44444444
    v_mov_b32 v51, 0xeeeeeeee
    v_cndmask_b32 v95, v51, v50, s[20:21]
    v_mov_b32 v49, 0
    v_mov_b32 v50, 0
    v_mov_b32 v51, 0
    v_mov_b32 v52, 0
    v_mov_b32 v53, 0
    v_mov_b32 v54, 0
    v_mov_b32 v55, 0
    v_mov_b32 v56, 0
    v_mov_b32 v57, 0
    v_mov_b32 v58, 0
    v_mov_b32 v59, 0
    ds_read_b128 v[86:89], v8 offset:10368
    ds_read_b128 v[72:75], v15
    ds_read_b64 v[84:85], v15 offset:1024
    s_lshr_b32 s60, s17, 1
    s_and_b32 s60, s60, 1
    s_add_u32 s18, s17, 3
    s_and_b32 s18, s18, 3
    s_lshl_b32 s28, s18, 16
    s_add_u32 s28, s28, s45
    s_mul_i32 s29, s18, 10240
    s_add_u32 s29, s29, s41
    s_and_b32 s18, s17, 1
    s_mul_i32 s19, s18, 12288
    s_add_u32 s19, s19, s62
    v_add_u32 v94, s19, v8
    s_cmp_lg_u32 s16, 0
    s_cbranch_scc1 L_ch_rB
    s_sleep 1
L_ch_rpA:
    buffer_load_dwordx4 v[76:79], v16, s[8:11], s46 offen sc1
    buffer_load_dwordx4 v[80:83], v17, s[8:11], s46 offen sc1
    v_bitop3_b32 v36, v76, v77, v92 bitop3:0x7e
    v_bitop3_b32 v37, v78, v79, v92 bitop3:0x7e
    v_bitop3_b32 v38, v80, v81, v92 bitop3:0x7e
    v_bitop3_b32 v39, v82, v83, v92 bitop3:0x7e
    v_or3_b32 v36, v36, v38, v39
    v_bitop3_b32 v36, v36, v37, 1 bitop3:0xa8
    v_cmp_ne_u32 vcc, 0, v36
    s_cbranch_vccz L_ch_rdA
    v_bitop3_b32 v36, v76, v77, v92 bitop3:0x7e
    v_bitop3_b32 v37, v78, v79, v92 bitop3:0x7e
    v_bitop3_b32 v38, v80, v81, v92 bitop3:0x7e
    v_bitop3_b32 v39, v82, v83, v92 bitop3:0x7e
    v_or3_b32 v36, v36, v38, v39
    v_bitop3_b32 v36, v36, v37, 1 bitop3:0xa8
    v_cmp_ne_u32 vcc, 0, v36
    s_cbranch_vccz L_ch_rdA
    v_bitop3_b32 v36, v76, v77, v92 bitop3:0x7e
    v_bitop3_b32 v37, v78, v79, v92 bitop3:0x7e
    v_bitop3_b32 v38, v80, v81, v92 bitop3:0x7e
    v_bitop3_b32 v39, v82, v83, v92 bitop3:0x7e
    v_or3_b32 v36, v36, v38, v39
    v_bitop3_b32 v36, v36, v37, 1 bitop3:0xa8
    v_cmp_ne_u32 vcc, 0, v36
    s_cbranch_vccz L_ch_rdA
    s_branch L_ch_rpA
L_ch_rdA:
    v_add_f32 v40, v76, v76 row_ror:8
    v_add_f32 v41, v77, v77 row_ror:8
    v_add_f32 v42, v78, v78 row_ror:8
    v_add_f32 v43, v79, v79 row_ror:8
    v_add_f32 v44, v80, v80 row_ror:8
    v_add_f32 v45, v81, v81 row_ror:8
    v_add_f32 v46, v82, v82 row_ror:8
    v_add_f32 v47, v83, v83 row_ror:8
    s_nop 1
    v_permlane32_swap_b32 v40, v42
    v_permlane32_swap_b32 v41, v43
    v_permlane32_swap_b32 v44, v46
    v_permlane32_swap_b32 v45, v47
    v_pk_add_f32 v[36:37], v[40:41], v[42:43]
    v_pk_add_f32 v[38:39], v[44:45], v[46:47]
    s_nop 1
    v_permlane16_swap_b32 v36, v38
    v_permlane16_swap_b32 v37, v39
    v_pk_add_f32 v[36:37], v[36:37], v[38:39]
    v_cvt_pk_bf16_f32 v48, v36, v37
    v_min_u32 v48, -2, v48
    s_mov_b64 exec, s[22:23]
    s_cmp_lg_u32 s63, 0
    s_cbranch_scc1 L_chs_27
    buffer_store_dword v48, v18, s[8:11], s51 offen
L_chs_28:
    s_mov_b64 exec, -1
    s_branch L_ch_step
L_ch_rB:
    s_sleep 1
L_ch_rpB:
    buffer_load_dwordx4 v[76:79], v16, s[8:11], s46 offen sc1
    v_bitop3_b32 v36, v76, v77, v92 bitop3:0x7e
    v_bitop3_b32 v37, v78, v79, v92 bitop3:0x7e
    v_bitop3_b32 v36, v36, v37, 1 bitop3:0xa8
    v_cmp_ne_u32 vcc, 0, v36
    s_cbranch_vccz L_ch_rdB
    v_bitop3_b32 v36, v76, v77, v92 bitop3:0x7e
    v_bitop3_b32 v37, v78, v79, v92 bitop3:0x7e
    v_bitop3_b32 v36, v36, v37, 1 bitop3:0xa8
    v_cmp_ne_u32 vcc, 0, v36
    s_cbranch_vccz L_ch_rdB
    v_bitop3_b32 v36, v76, v77, v92 bitop3:0x7e
    v_bitop3_b32 v37, v78, v79, v92 bitop3:0x7e
    v_bitop3_b32 v36, v36, v37, 1 bitop3:0xa8
    v_cmp_ne_u32 vcc, 0, v36
    s_cbranch_vccz L_ch_rdB
    v_bitop3_b32 v36, v76, v77, v92 bitop3:0x7e
    v_bitop3_b32 v37, v78, v79, v92 bitop3:0x7e
    v_bitop3_b32 v36, v36, v37, 1 bitop3:0xa8
    v_cmp_ne_u32 vcc, 0, v36
    s_cbranch_vccz L_ch_rdB
    s_branch L_ch_rpB
L_ch_rdB:
    v_add_f32 v40, v76, v76 row_ror:8
    v_add_f32 v41, v77, v77 row_ror:8
    v_add_f32 v42, v78, v78 row_ror:8
    v_add_f32 v43, v79, v79 row_ror:8
    s_nop 1
    v_permlane32_swap_b32 v40, v42
    v_permlane32_swap_b32 v41, v43
    v_pk_add_f32 v[36:37], v[40:41], v[42:43]
    v_pk_add_f32 v[38:39], v[40:41], v[42:43]
    s_nop 1
    v_permlane16_swap_b32 v36, v38
    v_permlane16_swap_b32 v37, v39
    v_pk_add_f32 v[36:37], v[36:37], v[38:39]
    v_cvt_pk_bf16_f32 v48, v36, v37
    v_min_u32 v48, -2, v48
    s_mov_b64 exec, s[22:23]
    s_cmp_lg_u32 s63, 0
    s_cbranch_scc1 L_chs_29
    buffer_store_dword v48, v18, s[8:11], s51 offen
L_chs_30:
    s_mov_b64 exec, -1
    s_branch L_ch_step
L_chs_3:
    buffer_store_dword v36, v18, s[8:11], s41 offen sc1
    s_branch L_chs_4
L_ch_q0:
    s_and_b32 s98, s36, 28
    s_add_u32 s98, s98, 120596192
    s_branch L_ch_q0d
L_ch_kvo:
    v_readlane_b32 s32, v7, 0
    v_readlane_b32 s31, v7, 8
    s_min_i32 s32, s32, s31
    v_readlane_b32 s31, v7, 16
    s_min_i32 s32, s32, s31
    v_readlane_b32 s31, v7, 24
    s_min_i32 s32, s32, s31
    s_cmp_gt_i32 s32, s19
    s_cbranch_scc1 L_ch_flok1
    s_mov_b64 exec, s[24:25]
    buffer_load_dword v7, v8, s[8:11], s98 offen sc1
    s_mov_b64 exec, -1
    s_waitcnt vmcnt(0)
    s_branch L_ch_kvo
L_chs_7:
    buffer_store_dwordx2 v[78:79], v11, s[8:11], s28 offen sc1
    s_branch L_chs_8
L_chs_9:
    buffer_store_dword v78, v18, s[8:11], s29 offen sc1
    s_branch L_chs_10
L_chs_11:
    buffer_store_dwordx2 v[78:79], v11, s[8:11], s28 offen sc1
    s_branch L_chs_12
L_chs_13:
    buffer_store_dword v78, v18, s[8:11], s29 offen sc1
    s_branch L_chs_14
L_chs_15:
    buffer_store_dwordx2 v[78:79], v11, s[8:11], s28 offen sc1
    s_branch L_chs_16
L_chs_17:
    buffer_store_dword v78, v18, s[8:11], s29 offen sc1
    s_branch L_chs_18
L_chs_19:
    buffer_store_dwordx2 v[78:79], v11, s[8:11], s28 offen sc1
    s_branch L_chs_20
L_chs_21:
    buffer_store_dword v78, v18, s[8:11], s29 offen sc1
    s_branch L_chs_22
L_ch_e0:
    v_xor_b32 v56, 128, v22
    s_mov_b64 exec, s[4:5]
    buffer_store_dwordx4 v[44:47], v56, s[8:11], s49 offen sc1
    s_mov_b64 exec, -1
    buffer_store_dwordx2 v[80:81], v23, s[8:11], s50 offen sc1
    s_branch L_ch_e0d
L_ch_mx:
    v_max3_f32 v37, v28, v29, v24
    v_max3_f32 v38, v25, v26, v27
    v_max_f32 v37, v37, v38
    s_nop 1
    v_max_f32 v37, v37, v37 row_ror:8
    v_mov_b32 v38, v37
    s_nop 1
    v_permlane16_swap_b32 v37, v38
    v_max_f32 v37, v37, v38
    v_mov_b32 v38, v37
    s_nop 1
    v_permlane32_swap_b32 v37, v38
    v_max_f32 v37, v37, v38
    v_mul_f32 v37, v37, v39
    v_fma_f32 v24, v24, v39, -v37
    v_fma_f32 v25, v25, v39, -v37
    v_fma_f32 v26, v26, v39, -v37
    v_fma_f32 v27, v27, v39, -v37
    v_fma_f32 v28, v28, v39, -v37
    v_fma_f32 v29, v29, v39, -v37
    s_branch L_ch_mxd
L_chs_23:
    buffer_store_dwordx2 v[40:41], v11, s[8:11], s42 offen sc1
    s_branch L_chs_24
L_chs_25:
    buffer_store_dwordx4 v[32:35], v14, s[8:11], s43 offen sc1
    s_branch L_chs_26
L_ch_ql0:
    v_mov_b32 v40, 0
    v_mov_b32 v41, s17
    s_waitcnt vmcnt(6)
    s_mov_b64 exec, 1
    buffer_store_dword v41, v40, s[8:11], s33 offen sc1
    s_mov_b64 exec, -1
    s_cmp_lg_u32 s17, 63
    s_cbranch_scc1 L_ch_qld
L_ch_ql:
    v_readlane_b32 s18, v7, 0
    s_cmp_eq_u32 s18, 0
    s_cbranch_scc1 L_ch_ql2
    s_mov_b64 exec, s[24:25]
    buffer_load_dword v7, v8, s[8:11], s98 offen sc1
    s_mov_b64 exec, -1
    s_waitcnt vmcnt(0)
    s_branch L_ch_ql
L_ch_ql2:
    s_lshl_b32 s18, s16, 12
    s_cmp_lt_u32 s16, 2
    s_cselect_b32 s19, 0, 24576
    s_add_u32 s18, s18, s19
    s_add_u32 s18, s18, 12416
    s_mov_b32 m0, s18
    s_lshl_b32 s18, s36, 13
    s_lshr_b32 s19, s16, 1
    s_lshl_b32 s19, s19, 12
    s_add_u32 s18, s18, s19
    s_add_u32 s18, s18, 44122112
    buffer_load_dwordx4 v8, s[8:11], s18 offen offset:0 sc1 lds
    buffer_load_dwordx4 v8, s[8:11], s18 offen offset:1024 sc1 lds
    buffer_load_dwordx4 v8, s[8:11], s18 offen offset:2048 sc1 lds
    buffer_load_dwordx4 v8, s[8:11], s18 offen offset:3072 sc1 lds
    s_branch L_ch_qld
L_chs_27:
    buffer_store_dword v48, v18, s[8:11], s51 offen sc1
    s_branch L_chs_28
L_chs_29:
    buffer_store_dword v48, v18, s[8:11], s51 offen sc1
    s_branch L_chs_30
L_ch_last:
    v_smfmac_f32_16x16x64_bf16 v[56:59], v[28:31], v[168:175], v95
    ds_write_b128 v15, v[44:47]
    s_lshl_b32 s18, s16, 12
    s_cmp_lt_u32 s16, 2
    s_cselect_b32 s19, 0, 24576
    s_add_u32 s18, s18, s19
    s_add_u32 s18, s18, 12416
    v_add_u32 v148, s18, v8
    v_add_u32 v149, 57472, v8
    ds_read_b128 v[176:179], v148 offset:0
    ds_read_b128 v[192:195], v149 offset:0
    ds_read_b128 v[180:183], v148 offset:1024
    ds_read_b128 v[196:199], v149 offset:3072
    ds_read_b128 v[184:187], v148 offset:2048
    ds_read_b128 v[200:203], v149 offset:6144
    ds_read_b128 v[188:191], v148 offset:3072
    ds_read_b128 v[204:207], v149 offset:9216
    ds_read_b128 v[208:211], v149 offset:1024
    ds_read_b128 v[212:215], v149 offset:4096
    ds_read_b128 v[216:219], v149 offset:7168
    ds_read_b128 v[220:223], v149 offset:10240
    s_and_b32 s19, s16, 1
    s_mul_i32 s18, s19, 6144
    v_add_u32 v148, s18, v149
    ds_read_b128 v[226:229], v148 offset:2048
    ds_read_b128 v[232:235], v148 offset:5120
    v_add_u32 v152, 70272, v8
    s_lshl_b32 s18, s19, 12
    v_add_u32 v153, s18, v152
    v_mov_b32 v40, v56
    v_mov_b32 v41, v57
    v_mov_b32 v42, v58
    v_mov_b32 v43, v59
    s_nop 1
    v_permlane32_swap_b32 v56, v40
    v_permlane32_swap_b32 v57, v41
    v_permlane32_swap_b32 v58, v42
    v_permlane32_swap_b32 v59, v43
    v_pk_add_f32 v[40:41], v[40:41], v[56:57]
    v_pk_add_f32 v[42:43], v[42:43], v[58:59]
    v_cvt_pk_bf16_f32 v80, v40, v41
    v_cvt_pk_bf16_f32 v81, v42, v43
    ds_write_b64 v15, v[80:81] offset:1024
    v_bfe_u32 v151, v8, 4, 4
    s_lshr_b32 s18, s16, 1
    s_lshl_b32 s28, s18, 4
    v_add_u32 v151, s28, v151
    v_lshrrev_b32 v150, 8, v8
    v_lshlrev_b32 v150, 2, v150
    v_add_u32 v146, 0, v150
    v_cmp_le_u32 s[64:65], v146, v151
    v_add_u32 v146, 1, v150
    v_cmp_le_u32 s[66:67], v146, v151
    v_add_u32 v146, 2, v150
    v_cmp_le_u32 s[68:69], v146, v151
    v_add_u32 v146, 3, v150
    v_cmp_le_u32 s[70:71], v146, v151
    v_add_u32 v146, 16, v150
    v_cmp_le_u32 s[72:73], v146, v151
    v_add_u32 v146, 17, v150
    v_cmp_le_u32 s[74:75], v146, v151
    v_add_u32 v146, 18, v150
    v_cmp_le_u32 s[76:77], v146, v151
    v_add_u32 v146, 19, v150
    v_cmp_le_u32 s[78:79], v146, v151
    v_mov_b32 v144, 0xff800000
    v_mov_b32 v145, 0x3e0293ee
    v_mov_b32 v236, 0
    v_mov_b32 v237, 0
    v_mov_b32 v130, 0
    v_mov_b32 v131, 0
    s_lshl_b32 s29, s37, 1
    s_add_u32 s29, s29, s19
    s_lshl_b32 s28, s36, 2
    s_add_u32 s42, s28, s29
    s_lshl_b32 s42, s42, 10
    s_lshl_b32 s43, s18, 17
    s_add_u32 s42, s42, s43
    s_add_u32 s42, s42, 111230976
    s_lshl_b32 s43, s18, 2
    s_add_u32 s43, s43, s29
    s_lshl_b32 s43, s43, 7
    s_add_u32 s43, s43, s28
    s_add_u32 s43, s43, 120601088
    s_waitcnt lgkmcnt(0)
    s_barrier
    ds_read_b128 v[96:99], v152 offset:0
    ds_read_b128 v[100:103], v152 offset:2048
    ds_read_b128 v[104:107], v152 offset:4096
    ds_read_b128 v[108:111], v152 offset:6144
    ds_read_b64 v[224:225], v153 offset:1024
    ds_read_b64 v[230:231], v153 offset:3072
    v_mfma_f32_16x16x32_bf16 v[116:119], v[192:195], v[176:179], 0
    v_mfma_f32_16x16x32_bf16 v[120:123], v[208:211], v[176:179], 0
    v_mfma_f32_16x16x32_bf16 v[116:119], v[196:199], v[180:183], v[116:119]
    v_mfma_f32_16x16x32_bf16 v[120:123], v[212:215], v[180:183], v[120:123]
    v_mfma_f32_16x16x32_bf16 v[116:119], v[200:203], v[184:187], v[116:119]
    v_mfma_f32_16x16x32_bf16 v[120:123], v[216:219], v[184:187], v[120:123]
    v_mfma_f32_16x16x32_bf16 v[116:119], v[204:207], v[188:191], v[116:119]
    v_mfma_f32_16x16x32_bf16 v[120:123], v[220:223], v[188:191], v[120:123]
    s_waitcnt lgkmcnt(5)
    v_mfma_f32_16x16x32_bf16 v[112:115], v[96:99], v[176:179], 0
    s_waitcnt lgkmcnt(4)
    v_mfma_f32_16x16x32_bf16 v[112:115], v[100:103], v[180:183], v[112:115]
    s_waitcnt lgkmcnt(3)
    v_mfma_f32_16x16x32_bf16 v[112:115], v[104:107], v[184:187], v[112:115]
    s_waitcnt lgkmcnt(2)
    v_mfma_f32_16x16x32_bf16 v[112:115], v[108:111], v[188:191], v[112:115]
    v_cndmask_b32 v116, v144, v116, s[64:65]
    v_cndmask_b32 v117, v144, v117, s[66:67]
    v_cndmask_b32 v118, v144, v118, s[68:69]
    v_cndmask_b32 v119, v144, v119, s[70:71]
    v_cndmask_b32 v120, v144, v120, s[72:73]
    v_cndmask_b32 v121, v144, v121, s[74:75]
    v_cndmask_b32 v122, v144, v122, s[76:77]
    v_cndmask_b32 v123, v144, v123, s[78:79]
    s_nop 4
    v_cndmask_b32 v112, v112, v144, s[24:25]
    v_cndmask_b32 v113, v113, v144, s[24:25]
    v_cndmask_b32 v114, v114, v144, s[24:25]
    v_cndmask_b32 v115, v115, v144, s[24:25]
    v_max_f32 v146, v112, v113
    v_max3_f32 v146, v146, v114, v115
    v_max3_f32 v146, v146, v116, v117
    v_max3_f32 v146, v146, v118, v119
    v_max3_f32 v146, v146, v120, v121
    v_max3_f32 v146, v146, v122, v123
    v_mov_b32 v147, v146
    s_nop 1
    v_permlane16_swap_b32 v146, v147
    v_max_f32 v146, v146, v147
    v_mov_b32 v147, v146
    s_nop 1
    v_permlane32_swap_b32 v146, v147
    v_max_f32 v146, v146, v147
    v_mul_f32 v146, v146, v145
    v_fma_f32 v112, v112, v145, -v146
    v_fma_f32 v113, v113, v145, -v146
    v_fma_f32 v114, v114, v145, -v146
    v_fma_f32 v115, v115, v145, -v146
    v_fma_f32 v116, v116, v145, -v146
    v_fma_f32 v117, v117, v145, -v146
    v_fma_f32 v118, v118, v145, -v146
    v_fma_f32 v119, v119, v145, -v146
    v_fma_f32 v120, v120, v145, -v146
    v_fma_f32 v121, v121, v145, -v146
    v_fma_f32 v122, v122, v145, -v146
    v_fma_f32 v123, v123, v145, -v146
    v_exp_f32 v112, v112
    v_exp_f32 v113, v113
    v_exp_f32 v114, v114
    v_exp_f32 v115, v115
    v_exp_f32 v116, v116
    v_exp_f32 v117, v117
    v_exp_f32 v118, v118
    v_exp_f32 v119, v119
    v_exp_f32 v120, v120
    v_exp_f32 v121, v121
    v_exp_f32 v122, v122
    v_exp_f32 v123, v123
    s_nop 0
    v_add_f32 v146, v112, v113
    v_add_f32 v146, v146, v114
    v_add_f32 v146, v146, v115
    v_add_f32 v146, v146, v116
    v_add_f32 v146, v146, v117
    v_add_f32 v146, v146, v118
    v_add_f32 v146, v146, v119
    v_add_f32 v146, v146, v120
    v_add_f32 v146, v146, v121
    v_add_f32 v146, v146, v122
    v_add_f32 v146, v146, v123
    v_mov_b32 v147, v146
    s_nop 1
    v_permlane16_swap_b32 v146, v147
    v_add_f32 v146, v146, v147
    v_mov_b32 v147, v146
    s_nop 1
    v_permlane32_swap_b32 v146, v147
    v_add_f32 v146, v146, v147
    v_rcp_f32 v146, v146
    s_nop 0
    v_mul_f32 v112, v112, v146
    v_mul_f32 v113, v113, v146
    v_mul_f32 v114, v114, v146
    v_mul_f32 v115, v115, v146
    v_mul_f32 v116, v116, v146
    v_mul_f32 v117, v117, v146
    v_mul_f32 v118, v118, v146
    v_mul_f32 v119, v119, v146
    v_mul_f32 v120, v120, v146
    v_mul_f32 v121, v121, v146
    v_mul_f32 v122, v122, v146
    v_mul_f32 v123, v123, v146
    v_cvt_pk_bf16_f32 v124, v112, v113
    v_cvt_pk_bf16_f32 v125, v114, v115
    v_cvt_pk_bf16_f32 v126, v116, v117
    v_cvt_pk_bf16_f32 v127, v118, v119
    v_cvt_pk_bf16_f32 v128, v120, v121
    v_cvt_pk_bf16_f32 v129, v122, v123
    s_waitcnt lgkmcnt(0)
    s_nop 1
    v_mfma_f32_16x16x32_bf16 v[132:135], v[224:227], v[124:127], 0
    v_mfma_f32_16x16x32_bf16 v[136:139], v[230:233], v[124:127], 0
    v_mfma_f32_16x16x32_bf16 v[132:135], v[228:231], v[128:131], v[132:135]
    v_mfma_f32_16x16x32_bf16 v[136:139], v[234:237], v[128:131], v[136:139]
    s_nop 7
    s_nop 4
    v_cvt_pk_bf16_f32 v140, v132, v133
    v_cvt_pk_bf16_f32 v141, v134, v135
    v_cvt_pk_bf16_f32 v142, v136, v137
    v_cvt_pk_bf16_f32 v143, v138, v139
    buffer_store_dwordx4 v[140:143], v8, s[8:11], s42 offen sc1
    s_waitcnt vmcnt(0)
    s_mov_b64 exec, 1
    v_mov_b32 v36, 0
    buffer_store_dword v36, v36, s[8:11], s43 offen sc1
    s_mov_b64 exec, -1
    s_branch L_ch_done
L_ch_helper:
    s_load_dwordx2 s[6:7], s[0:1], 104
    s_waitcnt lgkmcnt(0)
    s_mov_b32 s12, s6
    s_mov_b32 s13, s7
    s_mov_b32 s14, 256
    s_mov_b32 s15, 0x00020000
    s_cmp_lg_u32 s99, 0
    s_cbranch_scc1 L_ch_hA
    s_cmp_eq_u32 s92, 0
    s_cbranch_scc1 L_ch_censusB
    s_cmp_eq_u32 s92, 1
    s_cbranch_scc1 L_ch_helper1
L_ch_rescue:
    s_cmp_lg_u32 s16, 0
    s_cbranch_scc1 L_ch_rtk
    s_mov_b64 exec, 1
    v_mov_b32 v3, 152
    v_mov_b32 v4, 1
    buffer_atomic_add v4, v3, s[12:15], 0 offen sc0 sc1
    s_waitcnt vmcnt(0)
    v_mov_b32 v3, 69760
    ds_write_b32 v3, v4
    s_waitcnt lgkmcnt(0)
    s_mov_b64 exec, -1
L_ch_rtk:
    s_barrier
    v_mov_b32 v3, 69760
    ds_read_b32 v4, v3
    s_waitcnt lgkmcnt(0)
    v_readfirstlane_b32 s17, v4
    s_barrier
    s_cmp_lt_u32 s17, 128
    s_cbranch_scc1 L_ch_rs1
    s_mov_b32 s92, 1
    s_branch L_ch_helper1
L_ch_rs1:
    s_mov_b32 s18, 120599552
    v_lshlrev_b32 v24, 4, v0
    buffer_load_dwordx4 v[28:31], v24, s[8:11], s18 offen sc1
    s_mul_hi_u32 s19, s17, 0x2aaaaaab
    s_mul_i32 s18, s19, 6
    s_sub_u32 s18, s17, s18
    s_add_u32 s18, s18, 2
    s_mov_b32 s20, 0
    s_waitcnt vmcnt(0)
    v_cmp_eq_u32 vcc, s18, v28
    s_nop 3
    s_bcnt1_i32_b64 s28, vcc
    s_add_u32 s20, s20, s28
    v_cmp_eq_u32 vcc, s18, v29
    s_nop 3
    s_bcnt1_i32_b64 s28, vcc
    s_add_u32 s20, s20, s28
    v_cmp_eq_u32 vcc, s18, v30
    s_nop 3
    s_bcnt1_i32_b64 s28, vcc
    s_add_u32 s20, s20, s28
    v_cmp_eq_u32 vcc, s18, v31
    s_nop 3
    s_bcnt1_i32_b64 s28, vcc
    s_add_u32 s20, s20, s28
    s_cmp_lt_u32 s19, s20
    s_cbranch_scc1 L_ch_rescue
L_ch_hkv:
    s_add_u32 s17, s17, 20
    s_branch L_ch_hgot
L_ch_helper1:
    s_cmp_lg_u32 s16, 0
    s_cbranch_scc1 L_ch_htk
    s_mov_b64 exec, 1
    v_mov_b32 v3, 192
    v_mov_b32 v4, 1
    buffer_atomic_add v4, v3, s[12:15], 0 offen sc0 sc1
    s_waitcnt vmcnt(0)
    v_mov_b32 v3, 69760
    ds_write_b32 v3, v4
    s_waitcnt lgkmcnt(0)
    s_mov_b64 exec, -1
L_ch_htk:
    s_barrier
    v_mov_b32 v3, 69760
    ds_read_b32 v4, v3
    s_waitcnt lgkmcnt(0)
    v_readfirstlane_b32 s17, v4
    s_barrier
    s_mov_b32 s20, s17
    s_add_u32 s17, s17, 148
    s_cmp_ge_u32 s20, 52
    s_cbranch_scc1 L_ch_hgot
    s_mul_i32 s18, s20, 20480
    s_add_u32 s18, s18, 119537664
    s_lshl_b32 s19, s16, 10
    s_add_u32 s18, s18, s19
    v_lshlrev_b32 v1, 4, v0
    v_mov_b32 v4, -1
    v_mov_b32 v5, -1
    v_mov_b32 v6, -1
    v_mov_b32 v7, -1
    s_add_u32 s19, s18, 0
    buffer_store_dwordx4 v[4:7], v1, s[8:11], s19 offen offset:0 sc1
    s_add_u32 s19, s18, 4096
    buffer_store_dwordx4 v[4:7], v1, s[8:11], s19 offen offset:0 sc1
    s_add_u32 s19, s18, 8192
    buffer_store_dwordx4 v[4:7], v1, s[8:11], s19 offen offset:0 sc1
    s_add_u32 s19, s18, 12288
    buffer_store_dwordx4 v[4:7], v1, s[8:11], s19 offen offset:0 sc1
    s_add_u32 s19, s18, 16384
    buffer_store_dwordx4 v[4:7], v1, s[8:11], s19 offen offset:0 sc1
    s_waitcnt vmcnt(0)
    s_barrier
    s_cmp_lg_u32 s16, 0
    s_cbranch_scc1 L_ch_hgot
    s_mov_b64 exec, 1
    v_mov_b32 v3, 0
    v_mov_b32 v4, 1
    buffer_atomic_add v4, v3, s[12:15], 0 offen offset:136 sc1
    s_mov_b64 exec, -1
L_ch_hgot:
    s_mov_b32 s73, s17
    s_cmp_ge_u32 s17, 399
    s_cbranch_scc1 L_ch_h2
    s_mov_b32 s55, 0
    s_cmp_ge_u32 s17, 148
    s_cbranch_scc1 L_ch_hq
    s_sub_u32 s17, s17, 20
    s_lshr_b32 s19, s17, 6
    s_add_u32 s19, s19, 1
    s_and_b32 s29, s17, 63
    s_lshl_b32 s29, s29, 1
    s_lshl_b32 s54, s29, 7
    s_andn2_b32 s54, s54, 256
    s_and_b32 s18, s17, 1
    s_lshl_b32 s18, s18, 7
    s_add_u32 s54, s54, s18
    s_lshl_b32 s18, s19, 8
    s_add_u32 s54, s54, s18
    s_add_u32 s54, s54, 120569600
    s_load_dwordx2 s[6:7], s[0:1], 0
    s_load_dwordx2 s[56:57], s[0:1], 24
    s_load_dwordx2 s[48:49], s[0:1], 32
    v_and_b32 v1, 15, v0
    v_lshrrev_b32 v2, 4, v0
    v_lshlrev_b32 v8, 4, v0
    s_mul_i32 s30, s16, 10240
    s_mul_i32 s31, s16, 160
    v_lshrrev_b32 v4, 2, v0
    v_add_u32 v4, s31, v4
    v_lshlrev_b32 v9, 13, v4
    v_lshrrev_b32 v4, 5, v0
    v_lshlrev_b32 v4, 1, v4
    v_and_b32 v5, 3, v0
    v_xor_b32 v4, v4, v5
    v_lshl_add_u32 v9, v4, 4, v9
    v_lshlrev_b32 v4, 3, v2
    v_lshrrev_b32 v5, 2, v1
    v_add_u32 v4, v4, v5
    v_lshlrev_b32 v4, 6, v4
    v_and_b32 v5, 3, v1
    v_lshl_add_u32 v4, v5, 3, v4
    v_and_b32 v5, 1, v2
    v_lshl_add_u32 v5, v5, 5, v4
    v_xor_b32 v6, 32, v5
    v_mul_u32_u24 v3, 1280, v1
    v_lshl_add_u32 v3, v2, 4, v3
    s_mul_i32 s22, s16, 40960
    s_waitcnt lgkmcnt(0)
    s_mov_b32 s12, s6
    s_mov_b32 s13, s7
    s_mov_b32 s14, 2621440
    s_mov_b32 s15, 0x00020000
    s_cmp_eq_u32 s19, 2
    s_cselect_b64 s[56:57], s[48:49], s[56:57]
    s_mov_b32 s58, 5242880
    s_mov_b32 s59, 0x00020000
    s_add_u32 s31, s30, 0
    s_mov_b32 m0, s31
    s_lshl_b32 s33, s29, 6
    s_add_u32 s33, s33, 0
    buffer_load_dwordx4 v9, s[56:59], s33 offen offset:0 lds
    s_add_u32 s33, s33, 130048
    buffer_load_dwordx4 v9, s[56:59], s33 offen offset:1024 lds
    s_add_u32 s33, s33, 130048
    buffer_load_dwordx4 v9, s[56:59], s33 offen offset:2048 lds
    s_add_u32 s33, s33, 130048
    buffer_load_dwordx4 v9, s[56:59], s33 offen offset:3072 lds
    s_add_u32 s31, s31, 4096
    s_mov_b32 m0, s31
    s_add_u32 s33, s33, 134144
    buffer_load_dwordx4 v9, s[56:59], s33 offen offset:0 lds
    s_add_u32 s33, s33, 130048
    buffer_load_dwordx4 v9, s[56:59], s33 offen offset:1024 lds
    s_add_u32 s33, s33, 130048
    buffer_load_dwordx4 v9, s[56:59], s33 offen offset:2048 lds
    s_add_u32 s33, s33, 130048
    buffer_load_dwordx4 v9, s[56:59], s33 offen offset:3072 lds
    s_add_u32 s31, s31, 4096
    s_mov_b32 m0, s31
    s_add_u32 s33, s33, 134144
    buffer_load_dwordx4 v9, s[56:59], s33 offen offset:0 lds
    s_add_u32 s33, s33, 130048
    buffer_load_dwordx4 v9, s[56:59], s33 offen offset:1024 lds
    s_add_u32 s31, s30, 40960
    s_mov_b32 m0, s31
    s_lshl_b32 s33, s29, 6
    s_add_u32 s33, s33, 64
    buffer_load_dwordx4 v9, s[56:59], s33 offen offset:0 lds
    s_add_u32 s33, s33, 130048
    buffer_load_dwordx4 v9, s[56:59], s33 offen offset:1024 lds
    s_add_u32 s33, s33, 130048
    buffer_load_dwordx4 v9, s[56:59], s33 offen offset:2048 lds
    s_add_u32 s33, s33, 130048
    buffer_load_dwordx4 v9, s[56:59], s33 offen offset:3072 lds
    s_add_u32 s31, s31, 4096
    s_mov_b32 m0, s31
    s_add_u32 s33, s33, 134144
    buffer_load_dwordx4 v9, s[56:59], s33 offen offset:0 lds
    s_add_u32 s33, s33, 130048
    buffer_load_dwordx4 v9, s[56:59], s33 offen offset:1024 lds
    s_add_u32 s33, s33, 130048
    buffer_load_dwordx4 v9, s[56:59], s33 offen offset:2048 lds
    s_add_u32 s33, s33, 130048
    buffer_load_dwordx4 v9, s[56:59], s33 offen offset:3072 lds
    s_add_u32 s31, s31, 4096
    s_mov_b32 m0, s31
    s_add_u32 s33, s33, 134144
    buffer_load_dwordx4 v9, s[56:59], s33 offen offset:0 lds
    s_add_u32 s33, s33, 130048
    buffer_load_dwordx4 v9, s[56:59], s33 offen offset:1024 lds
    s_add_u32 s23, s22, 0
    buffer_load_dwordx4 a[0:3], v3, s[12:15], s23 offen offset:0
    buffer_load_dwordx4 a[4:7], v3, s[12:15], s23 offen offset:64
    buffer_load_dwordx4 a[8:11], v3, s[12:15], s23 offen offset:128
    buffer_load_dwordx4 a[12:15], v3, s[12:15], s23 offen offset:192
    buffer_load_dwordx4 a[16:19], v3, s[12:15], s23 offen offset:256
    buffer_load_dwordx4 a[20:23], v3, s[12:15], s23 offen offset:320
    buffer_load_dwordx4 a[24:27], v3, s[12:15], s23 offen offset:384
    buffer_load_dwordx4 a[28:31], v3, s[12:15], s23 offen offset:448
    buffer_load_dwordx4 a[32:35], v3, s[12:15], s23 offen offset:512
    buffer_load_dwordx4 a[36:39], v3, s[12:15], s23 offen offset:576
    buffer_load_dwordx4 a[40:43], v3, s[12:15], s23 offen offset:640
    buffer_load_dwordx4 a[44:47], v3, s[12:15], s23 offen offset:704
    buffer_load_dwordx4 a[48:51], v3, s[12:15], s23 offen offset:768
    buffer_load_dwordx4 a[52:55], v3, s[12:15], s23 offen offset:832
    buffer_load_dwordx4 a[56:59], v3, s[12:15], s23 offen offset:896
    buffer_load_dwordx4 a[60:63], v3, s[12:15], s23 offen offset:960
    buffer_load_dwordx4 a[64:67], v3, s[12:15], s23 offen offset:1024
    buffer_load_dwordx4 a[68:71], v3, s[12:15], s23 offen offset:1088
    buffer_load_dwordx4 a[72:75], v3, s[12:15], s23 offen offset:1152
    buffer_load_dwordx4 a[76:79], v3, s[12:15], s23 offen offset:1216
    s_add_u32 s23, s22, 20480
    buffer_load_dwordx4 a[80:83], v3, s[12:15], s23 offen offset:0
    buffer_load_dwordx4 a[84:87], v3, s[12:15], s23 offen offset:64
    buffer_load_dwordx4 a[88:91], v3, s[12:15], s23 offen offset:128
    buffer_load_dwordx4 a[92:95], v3, s[12:15], s23 offen offset:192
    buffer_load_dwordx4 a[96:99], v3, s[12:15], s23 offen offset:256
    buffer_load_dwordx4 a[100:103], v3, s[12:15], s23 offen offset:320
    buffer_load_dwordx4 a[104:107], v3, s[12:15], s23 offen offset:384
    buffer_load_dwordx4 a[108:111], v3, s[12:15], s23 offen offset:448
    buffer_load_dwordx4 a[112:115], v3, s[12:15], s23 offen offset:512
    buffer_load_dwordx4 a[116:119], v3, s[12:15], s23 offen offset:576
    buffer_load_dwordx4 a[120:123], v3, s[12:15], s23 offen offset:640
    buffer_load_dwordx4 a[124:127], v3, s[12:15], s23 offen offset:704
    buffer_load_dwordx4 a[128:131], v3, s[12:15], s23 offen offset:768
    buffer_load_dwordx4 a[132:135], v3, s[12:15], s23 offen offset:832
    buffer_load_dwordx4 a[136:139], v3, s[12:15], s23 offen offset:896
    buffer_load_dwordx4 a[140:143], v3, s[12:15], s23 offen offset:960
    buffer_load_dwordx4 a[144:147], v3, s[12:15], s23 offen offset:1024
    buffer_load_dwordx4 a[148:151], v3, s[12:15], s23 offen offset:1088
    buffer_load_dwordx4 a[152:155], v3, s[12:15], s23 offen offset:1152
    buffer_load_dwordx4 a[156:159], v3, s[12:15], s23 offen offset:1216
    s_add_u32 s22, s22, 163840
    s_mul_i32 s38, s16, 262144
    s_mul_i32 s39, s19, 16777216
    s_add_u32 s39, s39, 27607040
    s_add_u32 s38, s38, s39
    s_mov_b32 s18, 0
    s_waitcnt vmcnt(0)
    s_barrier
L_che_grp:
    s_cmp_eq_u32 s18, 0
    s_cbranch_scc1 L_che_n0
    s_cmp_lg_u32 s18, 2
    s_cbranch_scc1 L_che_n2
    s_add_u32 s23, s22, 0
    buffer_load_dwordx4 a[0:3], v3, s[12:15], s23 offen offset:0
    buffer_load_dwordx4 a[4:7], v3, s[12:15], s23 offen offset:64
    buffer_load_dwordx4 a[8:11], v3, s[12:15], s23 offen offset:128
    buffer_load_dwordx4 a[12:15], v3, s[12:15], s23 offen offset:192
    buffer_load_dwordx4 a[16:19], v3, s[12:15], s23 offen offset:256
    buffer_load_dwordx4 a[20:23], v3, s[12:15], s23 offen offset:320
    buffer_load_dwordx4 a[24:27], v3, s[12:15], s23 offen offset:384
    buffer_load_dwordx4 a[28:31], v3, s[12:15], s23 offen offset:448
    buffer_load_dwordx4 a[32:35], v3, s[12:15], s23 offen offset:512
    buffer_load_dwordx4 a[36:39], v3, s[12:15], s23 offen offset:576
    buffer_load_dwordx4 a[40:43], v3, s[12:15], s23 offen offset:640
    buffer_load_dwordx4 a[44:47], v3, s[12:15], s23 offen offset:704
    buffer_load_dwordx4 a[48:51], v3, s[12:15], s23 offen offset:768
    buffer_load_dwordx4 a[52:55], v3, s[12:15], s23 offen offset:832
    buffer_load_dwordx4 a[56:59], v3, s[12:15], s23 offen offset:896
    buffer_load_dwordx4 a[60:63], v3, s[12:15], s23 offen offset:960
    buffer_load_dwordx4 a[64:67], v3, s[12:15], s23 offen offset:1024
    buffer_load_dwordx4 a[68:71], v3, s[12:15], s23 offen offset:1088
    buffer_load_dwordx4 a[72:75], v3, s[12:15], s23 offen offset:1152
    buffer_load_dwordx4 a[76:79], v3, s[12:15], s23 offen offset:1216
    s_add_u32 s23, s22, 20480
    buffer_load_dwordx4 a[80:83], v3, s[12:15], s23 offen offset:0
    buffer_load_dwordx4 a[84:87], v3, s[12:15], s23 offen offset:64
    buffer_load_dwordx4 a[88:91], v3, s[12:15], s23 offen offset:128
    buffer_load_dwordx4 a[92:95], v3, s[12:15], s23 offen offset:192
    buffer_load_dwordx4 a[96:99], v3, s[12:15], s23 offen offset:256
    buffer_load_dwordx4 a[100:103], v3, s[12:15], s23 offen offset:320
    buffer_load_dwordx4 a[104:107], v3, s[12:15], s23 offen offset:384
    buffer_load_dwordx4 a[108:111], v3, s[12:15], s23 offen offset:448
    buffer_load_dwordx4 a[112:115], v3, s[12:15], s23 offen offset:512
    buffer_load_dwordx4 a[116:119], v3, s[12:15], s23 offen offset:576
    buffer_load_dwordx4 a[120:123], v3, s[12:15], s23 offen offset:640
    buffer_load_dwordx4 a[124:127], v3, s[12:15], s23 offen offset:704
    buffer_load_dwordx4 a[128:131], v3, s[12:15], s23 offen offset:768
    buffer_load_dwordx4 a[132:135], v3, s[12:15], s23 offen offset:832
    buffer_load_dwordx4 a[136:139], v3, s[12:15], s23 offen offset:896
    buffer_load_dwordx4 a[140:143], v3, s[12:15], s23 offen offset:960
    buffer_load_dwordx4 a[144:147], v3, s[12:15], s23 offen offset:1024
    buffer_load_dwordx4 a[148:151], v3, s[12:15], s23 offen offset:1088
    buffer_load_dwordx4 a[152:155], v3, s[12:15], s23 offen offset:1152
    buffer_load_dwordx4 a[156:159], v3, s[12:15], s23 offen offset:1216
    s_add_u32 s22, s22, 163840
L_che_n2:
    s_add_u32 s23, s22, 0
    buffer_load_dwordx4 a[160:163], v3, s[12:15], s23 offen offset:0
    buffer_load_dwordx4 a[164:167], v3, s[12:15], s23 offen offset:64
    buffer_load_dwordx4 a[168:171], v3, s[12:15], s23 offen offset:128
    buffer_load_dwordx4 a[172:175], v3, s[12:15], s23 offen offset:192
    buffer_load_dwordx4 a[176:179], v3, s[12:15], s23 offen offset:256
    buffer_load_dwordx4 a[180:183], v3, s[12:15], s23 offen offset:320
    buffer_load_dwordx4 a[184:187], v3, s[12:15], s23 offen offset:384
    buffer_load_dwordx4 a[188:191], v3, s[12:15], s23 offen offset:448
    buffer_load_dwordx4 a[192:195], v3, s[12:15], s23 offen offset:512
    buffer_load_dwordx4 a[196:199], v3, s[12:15], s23 offen offset:576
    buffer_load_dwordx4 a[200:203], v3, s[12:15], s23 offen offset:640
    buffer_load_dwordx4 a[204:207], v3, s[12:15], s23 offen offset:704
    buffer_load_dwordx4 a[208:211], v3, s[12:15], s23 offen offset:768
    buffer_load_dwordx4 a[212:215], v3, s[12:15], s23 offen offset:832
    buffer_load_dwordx4 a[216:219], v3, s[12:15], s23 offen offset:896
    buffer_load_dwordx4 a[220:223], v3, s[12:15], s23 offen offset:960
    buffer_load_dwordx4 a[224:227], v3, s[12:15], s23 offen offset:1024
    buffer_load_dwordx4 a[228:231], v3, s[12:15], s23 offen offset:1088
    buffer_load_dwordx4 a[232:235], v3, s[12:15], s23 offen offset:1152
    buffer_load_dwordx4 a[236:239], v3, s[12:15], s23 offen offset:1216
    s_add_u32 s23, s22, 20480
    buffer_load_dwordx4 a[240:243], v3, s[12:15], s23 offen offset:0
    buffer_load_dwordx4 a[244:247], v3, s[12:15], s23 offen offset:64
    buffer_load_dwordx4 a[248:251], v3, s[12:15], s23 offen offset:128
    buffer_load_dwordx4 a[252:255], v3, s[12:15], s23 offen offset:192
    buffer_load_dwordx4 v[192:195], v3, s[12:15], s23 offen offset:256
    buffer_load_dwordx4 v[196:199], v3, s[12:15], s23 offen offset:320
    buffer_load_dwordx4 v[200:203], v3, s[12:15], s23 offen offset:384
    buffer_load_dwordx4 v[204:207], v3, s[12:15], s23 offen offset:448
    buffer_load_dwordx4 v[208:211], v3, s[12:15], s23 offen offset:512
    buffer_load_dwordx4 v[212:215], v3, s[12:15], s23 offen offset:576
    buffer_load_dwordx4 v[216:219], v3, s[12:15], s23 offen offset:640
    buffer_load_dwordx4 v[220:223], v3, s[12:15], s23 offen offset:704
    buffer_load_dwordx4 v[224:227], v3, s[12:15], s23 offen offset:768
    buffer_load_dwordx4 v[228:231], v3, s[12:15], s23 offen offset:832
    buffer_load_dwordx4 v[232:235], v3, s[12:15], s23 offen offset:896
    buffer_load_dwordx4 v[236:239], v3, s[12:15], s23 offen offset:960
    buffer_load_dwordx4 v[240:243], v3, s[12:15], s23 offen offset:1024
    buffer_load_dwordx4 v[244:247], v3, s[12:15], s23 offen offset:1088
    buffer_load_dwordx4 v[248:251], v3, s[12:15], s23 offen offset:1152
    buffer_load_dwordx4 v[252:255], v3, s[12:15], s23 offen offset:1216
    s_add_u32 s22, s22, 163840
    s_waitcnt vmcnt(40)
L_che_n0:
    s_mov_b32 s37, 0
    v_mov_b32 v10, v5
    v_mov_b32 v11, v6
L_che_u0:
    s_cmp_eq_u32 s19, 2
    s_cbranch_scc1 L_che_v0
    ds_read_b64_tr_b16 v[96:97], v10 offset:0
    ds_read_b64_tr_b16 v[98:99], v10 offset:256
    ds_read_b64_tr_b16 v[100:101], v11 offset:0
    ds_read_b64_tr_b16 v[102:103], v11 offset:256
    ds_read_b64_tr_b16 v[104:105], v10 offset:2048
    ds_read_b64_tr_b16 v[106:107], v10 offset:2304
    ds_read_b64_tr_b16 v[108:109], v11 offset:2048
    ds_read_b64_tr_b16 v[110:111], v11 offset:2304
    ds_read_b64_tr_b16 v[112:113], v10 offset:4096
    ds_read_b64_tr_b16 v[114:115], v10 offset:4352
    ds_read_b64_tr_b16 v[116:117], v11 offset:4096
    ds_read_b64_tr_b16 v[118:119], v11 offset:4352
    ds_read_b64_tr_b16 v[120:121], v10 offset:6144
    ds_read_b64_tr_b16 v[122:123], v10 offset:6400
    ds_read_b64_tr_b16 v[124:125], v11 offset:6144
    ds_read_b64_tr_b16 v[126:127], v11 offset:6400
    s_waitcnt lgkmcnt(12)
    v_mfma_f32_16x16x32_bf16 v[64:67], v[96:99], a[0:3], 0
    v_mfma_f32_16x16x32_bf16 v[68:71], v[96:99], a[80:83], 0
    v_mfma_f32_16x16x32_bf16 v[80:83], v[100:103], a[0:3], 0
    v_mfma_f32_16x16x32_bf16 v[84:87], v[100:103], a[80:83], 0
    ds_read_b64_tr_b16 v[96:97], v10 offset:8192
    ds_read_b64_tr_b16 v[98:99], v10 offset:8448
    ds_read_b64_tr_b16 v[100:101], v11 offset:8192
    ds_read_b64_tr_b16 v[102:103], v11 offset:8448
    s_waitcnt lgkmcnt(12)
    v_mfma_f32_16x16x32_bf16 v[64:67], v[104:107], a[4:7], v[64:67]
    v_mfma_f32_16x16x32_bf16 v[68:71], v[104:107], a[84:87], v[68:71]
    v_mfma_f32_16x16x32_bf16 v[80:83], v[108:111], a[4:7], v[80:83]
    v_mfma_f32_16x16x32_bf16 v[84:87], v[108:111], a[84:87], v[84:87]
    ds_read_b64_tr_b16 v[104:105], v10 offset:10240
    ds_read_b64_tr_b16 v[106:107], v10 offset:10496
    ds_read_b64_tr_b16 v[108:109], v11 offset:10240
    ds_read_b64_tr_b16 v[110:111], v11 offset:10496
    s_waitcnt lgkmcnt(12)
    v_mfma_f32_16x16x32_bf16 v[64:67], v[112:115], a[8:11], v[64:67]
    v_mfma_f32_16x16x32_bf16 v[68:71], v[112:115], a[88:91], v[68:71]
    v_mfma_f32_16x16x32_bf16 v[80:83], v[116:119], a[8:11], v[80:83]
    v_mfma_f32_16x16x32_bf16 v[84:87], v[116:119], a[88:91], v[84:87]
    ds_read_b64_tr_b16 v[112:113], v10 offset:12288
    ds_read_b64_tr_b16 v[114:115], v10 offset:12544
    ds_read_b64_tr_b16 v[116:117], v11 offset:12288
    ds_read_b64_tr_b16 v[118:119], v11 offset:12544
    s_waitcnt lgkmcnt(12)
    v_mfma_f32_16x16x32_bf16 v[64:67], v[120:123], a[12:15], v[64:67]
    v_mfma_f32_16x16x32_bf16 v[68:71], v[120:123], a[92:95], v[68:71]
    v_mfma_f32_16x16x32_bf16 v[80:83], v[124:127], a[12:15], v[80:83]
    v_mfma_f32_16x16x32_bf16 v[84:87], v[124:127], a[92:95], v[84:87]
    ds_read_b64_tr_b16 v[120:121], v10 offset:14336
    ds_read_b64_tr_b16 v[122:123], v10 offset:14592
    ds_read_b64_tr_b16 v[124:125], v11 offset:14336
    ds_read_b64_tr_b16 v[126:127], v11 offset:14592
    s_waitcnt lgkmcnt(12)
    v_mfma_f32_16x16x32_bf16 v[64:67], v[96:99], a[16:19], v[64:67]
    v_mfma_f32_16x16x32_bf16 v[68:71], v[96:99], a[96:99], v[68:71]
    v_mfma_f32_16x16x32_bf16 v[80:83], v[100:103], a[16:19], v[80:83]
    v_mfma_f32_16x16x32_bf16 v[84:87], v[100:103], a[96:99], v[84:87]
    ds_read_b64_tr_b16 v[96:97], v10 offset:16384
    ds_read_b64_tr_b16 v[98:99], v10 offset:16640
    ds_read_b64_tr_b16 v[100:101], v11 offset:16384
    ds_read_b64_tr_b16 v[102:103], v11 offset:16640
    s_waitcnt lgkmcnt(12)
    v_mfma_f32_16x16x32_bf16 v[64:67], v[104:107], a[20:23], v[64:67]
    v_mfma_f32_16x16x32_bf16 v[68:71], v[104:107], a[100:103], v[68:71]
    v_mfma_f32_16x16x32_bf16 v[80:83], v[108:111], a[20:23], v[80:83]
    v_mfma_f32_16x16x32_bf16 v[84:87], v[108:111], a[100:103], v[84:87]
    ds_read_b64_tr_b16 v[104:105], v10 offset:18432
    ds_read_b64_tr_b16 v[106:107], v10 offset:18688
    ds_read_b64_tr_b16 v[108:109], v11 offset:18432
    ds_read_b64_tr_b16 v[110:111], v11 offset:18688
    s_waitcnt lgkmcnt(12)
    v_mfma_f32_16x16x32_bf16 v[64:67], v[112:115], a[24:27], v[64:67]
    v_mfma_f32_16x16x32_bf16 v[68:71], v[112:115], a[104:107], v[68:71]
    v_mfma_f32_16x16x32_bf16 v[80:83], v[116:119], a[24:27], v[80:83]
    v_mfma_f32_16x16x32_bf16 v[84:87], v[116:119], a[104:107], v[84:87]
    ds_read_b64_tr_b16 v[112:113], v10 offset:20480
    ds_read_b64_tr_b16 v[114:115], v10 offset:20736
    ds_read_b64_tr_b16 v[116:117], v11 offset:20480
    ds_read_b64_tr_b16 v[118:119], v11 offset:20736
    s_waitcnt lgkmcnt(12)
    v_mfma_f32_16x16x32_bf16 v[64:67], v[120:123], a[28:31], v[64:67]
    v_mfma_f32_16x16x32_bf16 v[68:71], v[120:123], a[108:111], v[68:71]
    v_mfma_f32_16x16x32_bf16 v[80:83], v[124:127], a[28:31], v[80:83]
    v_mfma_f32_16x16x32_bf16 v[84:87], v[124:127], a[108:111], v[84:87]
    ds_read_b64_tr_b16 v[120:121], v10 offset:22528
    ds_read_b64_tr_b16 v[122:123], v10 offset:22784
    ds_read_b64_tr_b16 v[124:125], v11 offset:22528
    ds_read_b64_tr_b16 v[126:127], v11 offset:22784
    s_waitcnt lgkmcnt(12)
    v_mfma_f32_16x16x32_bf16 v[64:67], v[96:99], a[32:35], v[64:67]
    v_mfma_f32_16x16x32_bf16 v[68:71], v[96:99], a[112:115], v[68:71]
    v_mfma_f32_16x16x32_bf16 v[80:83], v[100:103], a[32:35], v[80:83]
    v_mfma_f32_16x16x32_bf16 v[84:87], v[100:103], a[112:115], v[84:87]
    ds_read_b64_tr_b16 v[96:97], v10 offset:24576
    ds_read_b64_tr_b16 v[98:99], v10 offset:24832
    ds_read_b64_tr_b16 v[100:101], v11 offset:24576
    ds_read_b64_tr_b16 v[102:103], v11 offset:24832
    s_waitcnt lgkmcnt(12)
    v_mfma_f32_16x16x32_bf16 v[64:67], v[104:107], a[36:39], v[64:67]
    v_mfma_f32_16x16x32_bf16 v[68:71], v[104:107], a[116:119], v[68:71]
    v_mfma_f32_16x16x32_bf16 v[80:83], v[108:111], a[36:39], v[80:83]
    v_mfma_f32_16x16x32_bf16 v[84:87], v[108:111], a[116:119], v[84:87]
    ds_read_b64_tr_b16 v[104:105], v10 offset:26624
    ds_read_b64_tr_b16 v[106:107], v10 offset:26880
    ds_read_b64_tr_b16 v[108:109], v11 offset:26624
    ds_read_b64_tr_b16 v[110:111], v11 offset:26880
    s_waitcnt lgkmcnt(12)
    v_mfma_f32_16x16x32_bf16 v[64:67], v[112:115], a[40:43], v[64:67]
    v_mfma_f32_16x16x32_bf16 v[68:71], v[112:115], a[120:123], v[68:71]
    v_mfma_f32_16x16x32_bf16 v[80:83], v[116:119], a[40:43], v[80:83]
    v_mfma_f32_16x16x32_bf16 v[84:87], v[116:119], a[120:123], v[84:87]
    ds_read_b64_tr_b16 v[112:113], v10 offset:28672
    ds_read_b64_tr_b16 v[114:115], v10 offset:28928
    ds_read_b64_tr_b16 v[116:117], v11 offset:28672
    ds_read_b64_tr_b16 v[118:119], v11 offset:28928
    s_waitcnt lgkmcnt(12)
    v_mfma_f32_16x16x32_bf16 v[64:67], v[120:123], a[44:47], v[64:67]
    v_mfma_f32_16x16x32_bf16 v[68:71], v[120:123], a[124:127], v[68:71]
    v_mfma_f32_16x16x32_bf16 v[80:83], v[124:127], a[44:47], v[80:83]
    v_mfma_f32_16x16x32_bf16 v[84:87], v[124:127], a[124:127], v[84:87]
    ds_read_b64_tr_b16 v[120:121], v10 offset:30720
    ds_read_b64_tr_b16 v[122:123], v10 offset:30976
    ds_read_b64_tr_b16 v[124:125], v11 offset:30720
    ds_read_b64_tr_b16 v[126:127], v11 offset:30976
    s_waitcnt lgkmcnt(12)
    v_mfma_f32_16x16x32_bf16 v[64:67], v[96:99], a[48:51], v[64:67]
    v_mfma_f32_16x16x32_bf16 v[68:71], v[96:99], a[128:131], v[68:71]
    v_mfma_f32_16x16x32_bf16 v[80:83], v[100:103], a[48:51], v[80:83]
    v_mfma_f32_16x16x32_bf16 v[84:87], v[100:103], a[128:131], v[84:87]
    ds_read_b64_tr_b16 v[96:97], v10 offset:32768
    ds_read_b64_tr_b16 v[98:99], v10 offset:33024
    ds_read_b64_tr_b16 v[100:101], v11 offset:32768
    ds_read_b64_tr_b16 v[102:103], v11 offset:33024
    s_waitcnt lgkmcnt(12)
    v_mfma_f32_16x16x32_bf16 v[64:67], v[104:107], a[52:55], v[64:67]
    v_mfma_f32_16x16x32_bf16 v[68:71], v[104:107], a[132:135], v[68:71]
    v_mfma_f32_16x16x32_bf16 v[80:83], v[108:111], a[52:55], v[80:83]
    v_mfma_f32_16x16x32_bf16 v[84:87], v[108:111], a[132:135], v[84:87]
    ds_read_b64_tr_b16 v[104:105], v10 offset:34816
    ds_read_b64_tr_b16 v[106:107], v10 offset:35072
    ds_read_b64_tr_b16 v[108:109], v11 offset:34816
    ds_read_b64_tr_b16 v[110:111], v11 offset:35072
    s_waitcnt lgkmcnt(12)
    v_mfma_f32_16x16x32_bf16 v[64:67], v[112:115], a[56:59], v[64:67]
    v_mfma_f32_16x16x32_bf16 v[68:71], v[112:115], a[136:139], v[68:71]
    v_mfma_f32_16x16x32_bf16 v[80:83], v[116:119], a[56:59], v[80:83]
    v_mfma_f32_16x16x32_bf16 v[84:87], v[116:119], a[136:139], v[84:87]
    ds_read_b64_tr_b16 v[112:113], v10 offset:36864
    ds_read_b64_tr_b16 v[114:115], v10 offset:37120
    ds_read_b64_tr_b16 v[116:117], v11 offset:36864
    ds_read_b64_tr_b16 v[118:119], v11 offset:37120
    s_waitcnt lgkmcnt(12)
    v_mfma_f32_16x16x32_bf16 v[64:67], v[120:123], a[60:63], v[64:67]
    v_mfma_f32_16x16x32_bf16 v[68:71], v[120:123], a[140:143], v[68:71]
    v_mfma_f32_16x16x32_bf16 v[80:83], v[124:127], a[60:63], v[80:83]
    v_mfma_f32_16x16x32_bf16 v[84:87], v[124:127], a[140:143], v[84:87]
    ds_read_b64_tr_b16 v[120:121], v10 offset:38912
    ds_read_b64_tr_b16 v[122:123], v10 offset:39168
    ds_read_b64_tr_b16 v[124:125], v11 offset:38912
    ds_read_b64_tr_b16 v[126:127], v11 offset:39168
    s_waitcnt lgkmcnt(12)
    v_mfma_f32_16x16x32_bf16 v[64:67], v[96:99], a[64:67], v[64:67]
    v_mfma_f32_16x16x32_bf16 v[68:71], v[96:99], a[144:147], v[68:71]
    v_mfma_f32_16x16x32_bf16 v[80:83], v[100:103], a[64:67], v[80:83]
    v_mfma_f32_16x16x32_bf16 v[84:87], v[100:103], a[144:147], v[84:87]
    s_waitcnt lgkmcnt(8)
    v_mfma_f32_16x16x32_bf16 v[64:67], v[104:107], a[68:71], v[64:67]
    v_mfma_f32_16x16x32_bf16 v[68:71], v[104:107], a[148:151], v[68:71]
    v_mfma_f32_16x16x32_bf16 v[80:83], v[108:111], a[68:71], v[80:83]
    v_mfma_f32_16x16x32_bf16 v[84:87], v[108:111], a[148:151], v[84:87]
    s_waitcnt lgkmcnt(4)
    v_mfma_f32_16x16x32_bf16 v[64:67], v[112:115], a[72:75], v[64:67]
    v_mfma_f32_16x16x32_bf16 v[68:71], v[112:115], a[152:155], v[68:71]
    v_mfma_f32_16x16x32_bf16 v[80:83], v[116:119], a[72:75], v[80:83]
    v_mfma_f32_16x16x32_bf16 v[84:87], v[116:119], a[152:155], v[84:87]
    s_waitcnt lgkmcnt(0)
    v_mfma_f32_16x16x32_bf16 v[64:67], v[120:123], a[76:79], v[64:67]
    v_mfma_f32_16x16x32_bf16 v[68:71], v[120:123], a[156:159], v[68:71]
    v_mfma_f32_16x16x32_bf16 v[80:83], v[124:127], a[76:79], v[80:83]
    v_mfma_f32_16x16x32_bf16 v[84:87], v[124:127], a[156:159], v[84:87]
    s_add_u32 s41, s29, s37
    s_lshr_b32 s42, s41, 2
    s_lshl_b32 s42, s42, 13
    s_and_b32 s41, s41, 3
    s_lshl_b32 s41, s41, 10
    s_add_u32 s41, s41, s42
    s_add_u32 s41, s41, s38
    s_nop 7
    v_cvt_pk_bf16_f32 v144, v64, v65
    v_cvt_pk_bf16_f32 v145, v66, v67
    v_cvt_pk_bf16_f32 v146, v80, v81
    v_cvt_pk_bf16_f32 v147, v82, v83
    s_add_u32 s42, s41, 0
    buffer_store_dwordx4 v[144:147], v8, s[8:11], s42 offen sc1
    v_cvt_pk_bf16_f32 v148, v68, v69
    v_cvt_pk_bf16_f32 v149, v70, v71
    v_cvt_pk_bf16_f32 v150, v84, v85
    v_cvt_pk_bf16_f32 v151, v86, v87
    s_add_u32 s42, s41, 4096
    buffer_store_dwordx4 v[148:151], v8, s[8:11], s42 offen sc1
    s_branch L_che_e0
L_che_v0:
    ds_read_b64_tr_b16 v[96:97], v10 offset:0
    ds_read_b64_tr_b16 v[98:99], v10 offset:256
    ds_read_b64_tr_b16 v[100:101], v11 offset:0
    ds_read_b64_tr_b16 v[102:103], v11 offset:256
    ds_read_b64_tr_b16 v[104:105], v10 offset:2048
    ds_read_b64_tr_b16 v[106:107], v10 offset:2304
    ds_read_b64_tr_b16 v[108:109], v11 offset:2048
    ds_read_b64_tr_b16 v[110:111], v11 offset:2304
    ds_read_b64_tr_b16 v[112:113], v10 offset:4096
    ds_read_b64_tr_b16 v[114:115], v10 offset:4352
    ds_read_b64_tr_b16 v[116:117], v11 offset:4096
    ds_read_b64_tr_b16 v[118:119], v11 offset:4352
    ds_read_b64_tr_b16 v[120:121], v10 offset:6144
    ds_read_b64_tr_b16 v[122:123], v10 offset:6400
    ds_read_b64_tr_b16 v[124:125], v11 offset:6144
    ds_read_b64_tr_b16 v[126:127], v11 offset:6400
    s_waitcnt lgkmcnt(12)
    v_mfma_f32_16x16x32_bf16 v[64:67], a[0:3], v[96:99], 0
    v_mfma_f32_16x16x32_bf16 v[68:71], a[80:83], v[96:99], 0
    v_mfma_f32_16x16x32_bf16 v[80:83], a[0:3], v[100:103], 0
    v_mfma_f32_16x16x32_bf16 v[84:87], a[80:83], v[100:103], 0
    ds_read_b64_tr_b16 v[96:97], v10 offset:8192
    ds_read_b64_tr_b16 v[98:99], v10 offset:8448
    ds_read_b64_tr_b16 v[100:101], v11 offset:8192
    ds_read_b64_tr_b16 v[102:103], v11 offset:8448
    s_waitcnt lgkmcnt(12)
    v_mfma_f32_16x16x32_bf16 v[64:67], a[4:7], v[104:107], v[64:67]
    v_mfma_f32_16x16x32_bf16 v[68:71], a[84:87], v[104:107], v[68:71]
    v_mfma_f32_16x16x32_bf16 v[80:83], a[4:7], v[108:111], v[80:83]
    v_mfma_f32_16x16x32_bf16 v[84:87], a[84:87], v[108:111], v[84:87]
    ds_read_b64_tr_b16 v[104:105], v10 offset:10240
    ds_read_b64_tr_b16 v[106:107], v10 offset:10496
    ds_read_b64_tr_b16 v[108:109], v11 offset:10240
    ds_read_b64_tr_b16 v[110:111], v11 offset:10496
    s_waitcnt lgkmcnt(12)
    v_mfma_f32_16x16x32_bf16 v[64:67], a[8:11], v[112:115], v[64:67]
    v_mfma_f32_16x16x32_bf16 v[68:71], a[88:91], v[112:115], v[68:71]
    v_mfma_f32_16x16x32_bf16 v[80:83], a[8:11], v[116:119], v[80:83]
    v_mfma_f32_16x16x32_bf16 v[84:87], a[88:91], v[116:119], v[84:87]
    ds_read_b64_tr_b16 v[112:113], v10 offset:12288
    ds_read_b64_tr_b16 v[114:115], v10 offset:12544
    ds_read_b64_tr_b16 v[116:117], v11 offset:12288
    ds_read_b64_tr_b16 v[118:119], v11 offset:12544
    s_waitcnt lgkmcnt(12)
    v_mfma_f32_16x16x32_bf16 v[64:67], a[12:15], v[120:123], v[64:67]
    v_mfma_f32_16x16x32_bf16 v[68:71], a[92:95], v[120:123], v[68:71]
    v_mfma_f32_16x16x32_bf16 v[80:83], a[12:15], v[124:127], v[80:83]
    v_mfma_f32_16x16x32_bf16 v[84:87], a[92:95], v[124:127], v[84:87]
    ds_read_b64_tr_b16 v[120:121], v10 offset:14336
    ds_read_b64_tr_b16 v[122:123], v10 offset:14592
    ds_read_b64_tr_b16 v[124:125], v11 offset:14336
    ds_read_b64_tr_b16 v[126:127], v11 offset:14592
    s_waitcnt lgkmcnt(12)
    v_mfma_f32_16x16x32_bf16 v[64:67], a[16:19], v[96:99], v[64:67]
    v_mfma_f32_16x16x32_bf16 v[68:71], a[96:99], v[96:99], v[68:71]
    v_mfma_f32_16x16x32_bf16 v[80:83], a[16:19], v[100:103], v[80:83]
    v_mfma_f32_16x16x32_bf16 v[84:87], a[96:99], v[100:103], v[84:87]
    ds_read_b64_tr_b16 v[96:97], v10 offset:16384
    ds_read_b64_tr_b16 v[98:99], v10 offset:16640
    ds_read_b64_tr_b16 v[100:101], v11 offset:16384
    ds_read_b64_tr_b16 v[102:103], v11 offset:16640
    s_waitcnt lgkmcnt(12)
    v_mfma_f32_16x16x32_bf16 v[64:67], a[20:23], v[104:107], v[64:67]
    v_mfma_f32_16x16x32_bf16 v[68:71], a[100:103], v[104:107], v[68:71]
    v_mfma_f32_16x16x32_bf16 v[80:83], a[20:23], v[108:111], v[80:83]
    v_mfma_f32_16x16x32_bf16 v[84:87], a[100:103], v[108:111], v[84:87]
    ds_read_b64_tr_b16 v[104:105], v10 offset:18432
    ds_read_b64_tr_b16 v[106:107], v10 offset:18688
    ds_read_b64_tr_b16 v[108:109], v11 offset:18432
    ds_read_b64_tr_b16 v[110:111], v11 offset:18688
    s_waitcnt lgkmcnt(12)
    v_mfma_f32_16x16x32_bf16 v[64:67], a[24:27], v[112:115], v[64:67]
    v_mfma_f32_16x16x32_bf16 v[68:71], a[104:107], v[112:115], v[68:71]
    v_mfma_f32_16x16x32_bf16 v[80:83], a[24:27], v[116:119], v[80:83]
    v_mfma_f32_16x16x32_bf16 v[84:87], a[104:107], v[116:119], v[84:87]
    ds_read_b64_tr_b16 v[112:113], v10 offset:20480
    ds_read_b64_tr_b16 v[114:115], v10 offset:20736
    ds_read_b64_tr_b16 v[116:117], v11 offset:20480
    ds_read_b64_tr_b16 v[118:119], v11 offset:20736
    s_waitcnt lgkmcnt(12)
    v_mfma_f32_16x16x32_bf16 v[64:67], a[28:31], v[120:123], v[64:67]
    v_mfma_f32_16x16x32_bf16 v[68:71], a[108:111], v[120:123], v[68:71]
    v_mfma_f32_16x16x32_bf16 v[80:83], a[28:31], v[124:127], v[80:83]
    v_mfma_f32_16x16x32_bf16 v[84:87], a[108:111], v[124:127], v[84:87]
    ds_read_b64_tr_b16 v[120:121], v10 offset:22528
    ds_read_b64_tr_b16 v[122:123], v10 offset:22784
    ds_read_b64_tr_b16 v[124:125], v11 offset:22528
    ds_read_b64_tr_b16 v[126:127], v11 offset:22784
    s_waitcnt lgkmcnt(12)
    v_mfma_f32_16x16x32_bf16 v[64:67], a[32:35], v[96:99], v[64:67]
    v_mfma_f32_16x16x32_bf16 v[68:71], a[112:115], v[96:99], v[68:71]
    v_mfma_f32_16x16x32_bf16 v[80:83], a[32:35], v[100:103], v[80:83]
    v_mfma_f32_16x16x32_bf16 v[84:87], a[112:115], v[100:103], v[84:87]
    ds_read_b64_tr_b16 v[96:97], v10 offset:24576
    ds_read_b64_tr_b16 v[98:99], v10 offset:24832
    ds_read_b64_tr_b16 v[100:101], v11 offset:24576
    ds_read_b64_tr_b16 v[102:103], v11 offset:24832
    s_waitcnt lgkmcnt(12)
    v_mfma_f32_16x16x32_bf16 v[64:67], a[36:39], v[104:107], v[64:67]
    v_mfma_f32_16x16x32_bf16 v[68:71], a[116:119], v[104:107], v[68:71]
    v_mfma_f32_16x16x32_bf16 v[80:83], a[36:39], v[108:111], v[80:83]
    v_mfma_f32_16x16x32_bf16 v[84:87], a[116:119], v[108:111], v[84:87]
    ds_read_b64_tr_b16 v[104:105], v10 offset:26624
    ds_read_b64_tr_b16 v[106:107], v10 offset:26880
    ds_read_b64_tr_b16 v[108:109], v11 offset:26624
    ds_read_b64_tr_b16 v[110:111], v11 offset:26880
    s_waitcnt lgkmcnt(12)
    v_mfma_f32_16x16x32_bf16 v[64:67], a[40:43], v[112:115], v[64:67]
    v_mfma_f32_16x16x32_bf16 v[68:71], a[120:123], v[112:115], v[68:71]
    v_mfma_f32_16x16x32_bf16 v[80:83], a[40:43], v[116:119], v[80:83]
    v_mfma_f32_16x16x32_bf16 v[84:87], a[120:123], v[116:119], v[84:87]
    ds_read_b64_tr_b16 v[112:113], v10 offset:28672
    ds_read_b64_tr_b16 v[114:115], v10 offset:28928
    ds_read_b64_tr_b16 v[116:117], v11 offset:28672
    ds_read_b64_tr_b16 v[118:119], v11 offset:28928
    s_waitcnt lgkmcnt(12)
    v_mfma_f32_16x16x32_bf16 v[64:67], a[44:47], v[120:123], v[64:67]
    v_mfma_f32_16x16x32_bf16 v[68:71], a[124:127], v[120:123], v[68:71]
    v_mfma_f32_16x16x32_bf16 v[80:83], a[44:47], v[124:127], v[80:83]
    v_mfma_f32_16x16x32_bf16 v[84:87], a[124:127], v[124:127], v[84:87]
    ds_read_b64_tr_b16 v[120:121], v10 offset:30720
    ds_read_b64_tr_b16 v[122:123], v10 offset:30976
    ds_read_b64_tr_b16 v[124:125], v11 offset:30720
    ds_read_b64_tr_b16 v[126:127], v11 offset:30976
    s_waitcnt lgkmcnt(12)
    v_mfma_f32_16x16x32_bf16 v[64:67], a[48:51], v[96:99], v[64:67]
    v_mfma_f32_16x16x32_bf16 v[68:71], a[128:131], v[96:99], v[68:71]
    v_mfma_f32_16x16x32_bf16 v[80:83], a[48:51], v[100:103], v[80:83]
    v_mfma_f32_16x16x32_bf16 v[84:87], a[128:131], v[100:103], v[84:87]
    ds_read_b64_tr_b16 v[96:97], v10 offset:32768
    ds_read_b64_tr_b16 v[98:99], v10 offset:33024
    ds_read_b64_tr_b16 v[100:101], v11 offset:32768
    ds_read_b64_tr_b16 v[102:103], v11 offset:33024
    s_waitcnt lgkmcnt(12)
    v_mfma_f32_16x16x32_bf16 v[64:67], a[52:55], v[104:107], v[64:67]
    v_mfma_f32_16x16x32_bf16 v[68:71], a[132:135], v[104:107], v[68:71]
    v_mfma_f32_16x16x32_bf16 v[80:83], a[52:55], v[108:111], v[80:83]
    v_mfma_f32_16x16x32_bf16 v[84:87], a[132:135], v[108:111], v[84:87]
    ds_read_b64_tr_b16 v[104:105], v10 offset:34816
    ds_read_b64_tr_b16 v[106:107], v10 offset:35072
    ds_read_b64_tr_b16 v[108:109], v11 offset:34816
    ds_read_b64_tr_b16 v[110:111], v11 offset:35072
    s_waitcnt lgkmcnt(12)
    v_mfma_f32_16x16x32_bf16 v[64:67], a[56:59], v[112:115], v[64:67]
    v_mfma_f32_16x16x32_bf16 v[68:71], a[136:139], v[112:115], v[68:71]
    v_mfma_f32_16x16x32_bf16 v[80:83], a[56:59], v[116:119], v[80:83]
    v_mfma_f32_16x16x32_bf16 v[84:87], a[136:139], v[116:119], v[84:87]
    ds_read_b64_tr_b16 v[112:113], v10 offset:36864
    ds_read_b64_tr_b16 v[114:115], v10 offset:37120
    ds_read_b64_tr_b16 v[116:117], v11 offset:36864
    ds_read_b64_tr_b16 v[118:119], v11 offset:37120
    s_waitcnt lgkmcnt(12)
    v_mfma_f32_16x16x32_bf16 v[64:67], a[60:63], v[120:123], v[64:67]
    v_mfma_f32_16x16x32_bf16 v[68:71], a[140:143], v[120:123], v[68:71]
    v_mfma_f32_16x16x32_bf16 v[80:83], a[60:63], v[124:127], v[80:83]
    v_mfma_f32_16x16x32_bf16 v[84:87], a[140:143], v[124:127], v[84:87]
    ds_read_b64_tr_b16 v[120:121], v10 offset:38912
    ds_read_b64_tr_b16 v[122:123], v10 offset:39168
    ds_read_b64_tr_b16 v[124:125], v11 offset:38912
    ds_read_b64_tr_b16 v[126:127], v11 offset:39168
    s_waitcnt lgkmcnt(12)
    v_mfma_f32_16x16x32_bf16 v[64:67], a[64:67], v[96:99], v[64:67]
    v_mfma_f32_16x16x32_bf16 v[68:71], a[144:147], v[96:99], v[68:71]
    v_mfma_f32_16x16x32_bf16 v[80:83], a[64:67], v[100:103], v[80:83]
    v_mfma_f32_16x16x32_bf16 v[84:87], a[144:147], v[100:103], v[84:87]
    s_waitcnt lgkmcnt(8)
    v_mfma_f32_16x16x32_bf16 v[64:67], a[68:71], v[104:107], v[64:67]
    v_mfma_f32_16x16x32_bf16 v[68:71], a[148:151], v[104:107], v[68:71]
    v_mfma_f32_16x16x32_bf16 v[80:83], a[68:71], v[108:111], v[80:83]
    v_mfma_f32_16x16x32_bf16 v[84:87], a[148:151], v[108:111], v[84:87]
    s_waitcnt lgkmcnt(4)
    v_mfma_f32_16x16x32_bf16 v[64:67], a[72:75], v[112:115], v[64:67]
    v_mfma_f32_16x16x32_bf16 v[68:71], a[152:155], v[112:115], v[68:71]
    v_mfma_f32_16x16x32_bf16 v[80:83], a[72:75], v[116:119], v[80:83]
    v_mfma_f32_16x16x32_bf16 v[84:87], a[152:155], v[116:119], v[84:87]
    s_waitcnt lgkmcnt(0)
    v_mfma_f32_16x16x32_bf16 v[64:67], a[76:79], v[120:123], v[64:67]
    v_mfma_f32_16x16x32_bf16 v[68:71], a[156:159], v[120:123], v[68:71]
    v_mfma_f32_16x16x32_bf16 v[80:83], a[76:79], v[124:127], v[80:83]
    v_mfma_f32_16x16x32_bf16 v[84:87], a[156:159], v[124:127], v[84:87]
    s_add_u32 s41, s29, s37
    s_lshl_b32 s41, s41, 11
    s_add_u32 s41, s41, s38
    s_nop 7
    v_cvt_pk_bf16_f32 v144, v64, v65
    v_cvt_pk_bf16_f32 v145, v66, v67
    v_cvt_pk_bf16_f32 v146, v68, v69
    v_cvt_pk_bf16_f32 v147, v70, v71
    buffer_store_dwordx4 v[144:147], v8, s[8:11], s41 offen offset:0 sc1
    v_cvt_pk_bf16_f32 v148, v80, v81
    v_cvt_pk_bf16_f32 v149, v82, v83
    v_cvt_pk_bf16_f32 v150, v84, v85
    v_cvt_pk_bf16_f32 v151, v86, v87
    buffer_store_dwordx4 v[148:151], v8, s[8:11], s41 offen offset:1024 sc1
L_che_e0:
    v_add_u32 v10, 40960, v10
    v_add_u32 v11, 40960, v11
    s_add_u32 s37, s37, 1
    s_cmp_lt_u32 s37, 2
    s_cbranch_scc1 L_che_u0
    s_add_u32 s38, s38, 1048576
    s_add_u32 s18, s18, 1
    s_cmp_lg_u32 s16, 0
    s_cbranch_scc1 L_chp_31_a
    s_cmp_lg_u32 s94, 0
    s_cbranch_scc1 L_chd_32_d
    s_load_dwordx2 s[6:7], s[0:1], 104
    s_waitcnt lgkmcnt(0)
    s_mov_b32 s84, s6
    s_mov_b32 s85, s7
    s_mov_b32 s86, 256
    s_mov_b32 s87, 0x00020000
L_chd_32:
    v_mov_b32 v12, 0
    buffer_load_dword v13, v12, s[84:87], 0 offen offset:136 sc1
    s_waitcnt vmcnt(0)
    v_readfirstlane_b32 s7, v13
    s_cmp_ge_u32 s7, 52
    s_cbranch_scc1 L_chd_32_s
    s_sleep 8
    s_branch L_chd_32
L_chd_32_s:
    s_mov_b32 s94, 1
    s_lshl_b32 s7, s2, 2
    s_add_u32 s7, s7, 120599552
    v_mov_b32 v13, s93
    buffer_store_dword v13, v12, s[8:11], s7 offen sc1
L_chd_32_d:
L_chp_31_a:
    s_waitcnt vmcnt(0)
    s_barrier
    s_cmp_lg_u32 s16, 0
    s_cbranch_scc1 L_chp_31
    s_mov_b64 exec, 1
    v_mov_b32 v12, 0
    v_mov_b32 v13, s18
    buffer_store_dword v13, v12, s[8:11], s54 offen sc1
    s_mov_b64 exec, -1
L_chp_31:
    s_cmp_lg_u32 s18, 1
    s_cbranch_scc1 L_che_n1
    s_add_u32 s23, s22, 0
    buffer_load_dwordx4 a[160:163], v3, s[12:15], s23 offen offset:0
    buffer_load_dwordx4 a[164:167], v3, s[12:15], s23 offen offset:64
    buffer_load_dwordx4 a[168:171], v3, s[12:15], s23 offen offset:128
    buffer_load_dwordx4 a[172:175], v3, s[12:15], s23 offen offset:192
    buffer_load_dwordx4 a[176:179], v3, s[12:15], s23 offen offset:256
    buffer_load_dwordx4 a[180:183], v3, s[12:15], s23 offen offset:320
    buffer_load_dwordx4 a[184:187], v3, s[12:15], s23 offen offset:384
    buffer_load_dwordx4 a[188:191], v3, s[12:15], s23 offen offset:448
    buffer_load_dwordx4 a[192:195], v3, s[12:15], s23 offen offset:512
    buffer_load_dwordx4 a[196:199], v3, s[12:15], s23 offen offset:576
    buffer_load_dwordx4 a[200:203], v3, s[12:15], s23 offen offset:640
    buffer_load_dwordx4 a[204:207], v3, s[12:15], s23 offen offset:704
    buffer_load_dwordx4 a[208:211], v3, s[12:15], s23 offen offset:768
    buffer_load_dwordx4 a[212:215], v3, s[12:15], s23 offen offset:832
    buffer_load_dwordx4 a[216:219], v3, s[12:15], s23 offen offset:896
    buffer_load_dwordx4 a[220:223], v3, s[12:15], s23 offen offset:960
    buffer_load_dwordx4 a[224:227], v3, s[12:15], s23 offen offset:1024
    buffer_load_dwordx4 a[228:231], v3, s[12:15], s23 offen offset:1088
    buffer_load_dwordx4 a[232:235], v3, s[12:15], s23 offen offset:1152
    buffer_load_dwordx4 a[236:239], v3, s[12:15], s23 offen offset:1216
    s_add_u32 s23, s22, 20480
    buffer_load_dwordx4 a[240:243], v3, s[12:15], s23 offen offset:0
    buffer_load_dwordx4 a[244:247], v3, s[12:15], s23 offen offset:64
    buffer_load_dwordx4 a[248:251], v3, s[12:15], s23 offen offset:128
    buffer_load_dwordx4 a[252:255], v3, s[12:15], s23 offen offset:192
    buffer_load_dwordx4 v[192:195], v3, s[12:15], s23 offen offset:256
    buffer_load_dwordx4 v[196:199], v3, s[12:15], s23 offen offset:320
    buffer_load_dwordx4 v[200:203], v3, s[12:15], s23 offen offset:384
    buffer_load_dwordx4 v[204:207], v3, s[12:15], s23 offen offset:448
    buffer_load_dwordx4 v[208:211], v3, s[12:15], s23 offen offset:512
    buffer_load_dwordx4 v[212:215], v3, s[12:15], s23 offen offset:576
    buffer_load_dwordx4 v[216:219], v3, s[12:15], s23 offen offset:640
    buffer_load_dwordx4 v[220:223], v3, s[12:15], s23 offen offset:704
    buffer_load_dwordx4 v[224:227], v3, s[12:15], s23 offen offset:768
    buffer_load_dwordx4 v[228:231], v3, s[12:15], s23 offen offset:832
    buffer_load_dwordx4 v[232:235], v3, s[12:15], s23 offen offset:896
    buffer_load_dwordx4 v[236:239], v3, s[12:15], s23 offen offset:960
    buffer_load_dwordx4 v[240:243], v3, s[12:15], s23 offen offset:1024
    buffer_load_dwordx4 v[244:247], v3, s[12:15], s23 offen offset:1088
    buffer_load_dwordx4 v[248:251], v3, s[12:15], s23 offen offset:1152
    buffer_load_dwordx4 v[252:255], v3, s[12:15], s23 offen offset:1216
    s_add_u32 s22, s22, 163840
    s_waitcnt vmcnt(0)
    s_branch L_che_nx
L_che_n1:
    s_cmp_ge_u32 s18, 15
    s_cbranch_scc1 L_che_nx
    s_add_u32 s23, s22, 0
    buffer_load_dwordx4 a[0:3], v3, s[12:15], s23 offen offset:0
    buffer_load_dwordx4 a[4:7], v3, s[12:15], s23 offen offset:64
    buffer_load_dwordx4 a[8:11], v3, s[12:15], s23 offen offset:128
    buffer_load_dwordx4 a[12:15], v3, s[12:15], s23 offen offset:192
    buffer_load_dwordx4 a[16:19], v3, s[12:15], s23 offen offset:256
    buffer_load_dwordx4 a[20:23], v3, s[12:15], s23 offen offset:320
    buffer_load_dwordx4 a[24:27], v3, s[12:15], s23 offen offset:384
    buffer_load_dwordx4 a[28:31], v3, s[12:15], s23 offen offset:448
    buffer_load_dwordx4 a[32:35], v3, s[12:15], s23 offen offset:512
    buffer_load_dwordx4 a[36:39], v3, s[12:15], s23 offen offset:576
    buffer_load_dwordx4 a[40:43], v3, s[12:15], s23 offen offset:640
    buffer_load_dwordx4 a[44:47], v3, s[12:15], s23 offen offset:704
    buffer_load_dwordx4 a[48:51], v3, s[12:15], s23 offen offset:768
    buffer_load_dwordx4 a[52:55], v3, s[12:15], s23 offen offset:832
    buffer_load_dwordx4 a[56:59], v3, s[12:15], s23 offen offset:896
    buffer_load_dwordx4 a[60:63], v3, s[12:15], s23 offen offset:960
    buffer_load_dwordx4 a[64:67], v3, s[12:15], s23 offen offset:1024
    buffer_load_dwordx4 a[68:71], v3, s[12:15], s23 offen offset:1088
    buffer_load_dwordx4 a[72:75], v3, s[12:15], s23 offen offset:1152
    buffer_load_dwordx4 a[76:79], v3, s[12:15], s23 offen offset:1216
    s_add_u32 s23, s22, 20480
    buffer_load_dwordx4 a[80:83], v3, s[12:15], s23 offen offset:0
    buffer_load_dwordx4 a[84:87], v3, s[12:15], s23 offen offset:64
    buffer_load_dwordx4 a[88:91], v3, s[12:15], s23 offen offset:128
    buffer_load_dwordx4 a[92:95], v3, s[12:15], s23 offen offset:192
    buffer_load_dwordx4 a[96:99], v3, s[12:15], s23 offen offset:256
    buffer_load_dwordx4 a[100:103], v3, s[12:15], s23 offen offset:320
    buffer_load_dwordx4 a[104:107], v3, s[12:15], s23 offen offset:384
    buffer_load_dwordx4 a[108:111], v3, s[12:15], s23 offen offset:448
    buffer_load_dwordx4 a[112:115], v3, s[12:15], s23 offen offset:512
    buffer_load_dwordx4 a[116:119], v3, s[12:15], s23 offen offset:576
    buffer_load_dwordx4 a[120:123], v3, s[12:15], s23 offen offset:640
    buffer_load_dwordx4 a[124:127], v3, s[12:15], s23 offen offset:704
    buffer_load_dwordx4 a[128:131], v3, s[12:15], s23 offen offset:768
    buffer_load_dwordx4 a[132:135], v3, s[12:15], s23 offen offset:832
    buffer_load_dwordx4 a[136:139], v3, s[12:15], s23 offen offset:896
    buffer_load_dwordx4 a[140:143], v3, s[12:15], s23 offen offset:960
    buffer_load_dwordx4 a[144:147], v3, s[12:15], s23 offen offset:1024
    buffer_load_dwordx4 a[148:151], v3, s[12:15], s23 offen offset:1088
    buffer_load_dwordx4 a[152:155], v3, s[12:15], s23 offen offset:1152
    buffer_load_dwordx4 a[156:159], v3, s[12:15], s23 offen offset:1216
    s_add_u32 s22, s22, 163840
L_che_nx:
    s_mov_b32 s37, 0
    v_mov_b32 v10, v5
    v_mov_b32 v11, v6
L_che_u1:
    s_cmp_eq_u32 s19, 2
    s_cbranch_scc1 L_che_v1
    ds_read_b64_tr_b16 v[96:97], v10 offset:0
    ds_read_b64_tr_b16 v[98:99], v10 offset:256
    ds_read_b64_tr_b16 v[100:101], v11 offset:0
    ds_read_b64_tr_b16 v[102:103], v11 offset:256
    ds_read_b64_tr_b16 v[104:105], v10 offset:2048
    ds_read_b64_tr_b16 v[106:107], v10 offset:2304
    ds_read_b64_tr_b16 v[108:109], v11 offset:2048
    ds_read_b64_tr_b16 v[110:111], v11 offset:2304
    ds_read_b64_tr_b16 v[112:113], v10 offset:4096
    ds_read_b64_tr_b16 v[114:115], v10 offset:4352
    ds_read_b64_tr_b16 v[116:117], v11 offset:4096
    ds_read_b64_tr_b16 v[118:119], v11 offset:4352
    ds_read_b64_tr_b16 v[120:121], v10 offset:6144
    ds_read_b64_tr_b16 v[122:123], v10 offset:6400
    ds_read_b64_tr_b16 v[124:125], v11 offset:6144
    ds_read_b64_tr_b16 v[126:127], v11 offset:6400
    s_waitcnt lgkmcnt(12)
    v_mfma_f32_16x16x32_bf16 v[64:67], v[96:99], a[160:163], 0
    v_mfma_f32_16x16x32_bf16 v[68:71], v[96:99], a[240:243], 0
    v_mfma_f32_16x16x32_bf16 v[80:83], v[100:103], a[160:163], 0
    v_mfma_f32_16x16x32_bf16 v[84:87], v[100:103], a[240:243], 0
    ds_read_b64_tr_b16 v[96:97], v10 offset:8192
    ds_read_b64_tr_b16 v[98:99], v10 offset:8448
    ds_read_b64_tr_b16 v[100:101], v11 offset:8192
    ds_read_b64_tr_b16 v[102:103], v11 offset:8448
    s_waitcnt lgkmcnt(12)
    v_mfma_f32_16x16x32_bf16 v[64:67], v[104:107], a[164:167], v[64:67]
    v_mfma_f32_16x16x32_bf16 v[68:71], v[104:107], a[244:247], v[68:71]
    v_mfma_f32_16x16x32_bf16 v[80:83], v[108:111], a[164:167], v[80:83]
    v_mfma_f32_16x16x32_bf16 v[84:87], v[108:111], a[244:247], v[84:87]
    ds_read_b64_tr_b16 v[104:105], v10 offset:10240
    ds_read_b64_tr_b16 v[106:107], v10 offset:10496
    ds_read_b64_tr_b16 v[108:109], v11 offset:10240
    ds_read_b64_tr_b16 v[110:111], v11 offset:10496
    s_waitcnt lgkmcnt(12)
    v_mfma_f32_16x16x32_bf16 v[64:67], v[112:115], a[168:171], v[64:67]
    v_mfma_f32_16x16x32_bf16 v[68:71], v[112:115], a[248:251], v[68:71]
    v_mfma_f32_16x16x32_bf16 v[80:83], v[116:119], a[168:171], v[80:83]
    v_mfma_f32_16x16x32_bf16 v[84:87], v[116:119], a[248:251], v[84:87]
    ds_read_b64_tr_b16 v[112:113], v10 offset:12288
    ds_read_b64_tr_b16 v[114:115], v10 offset:12544
    ds_read_b64_tr_b16 v[116:117], v11 offset:12288
    ds_read_b64_tr_b16 v[118:119], v11 offset:12544
    s_waitcnt lgkmcnt(12)
    v_mfma_f32_16x16x32_bf16 v[64:67], v[120:123], a[172:175], v[64:67]
    v_mfma_f32_16x16x32_bf16 v[68:71], v[120:123], a[252:255], v[68:71]
    v_mfma_f32_16x16x32_bf16 v[80:83], v[124:127], a[172:175], v[80:83]
    v_mfma_f32_16x16x32_bf16 v[84:87], v[124:127], a[252:255], v[84:87]
    ds_read_b64_tr_b16 v[120:121], v10 offset:14336
    ds_read_b64_tr_b16 v[122:123], v10 offset:14592
    ds_read_b64_tr_b16 v[124:125], v11 offset:14336
    ds_read_b64_tr_b16 v[126:127], v11 offset:14592
    s_waitcnt lgkmcnt(12)
    v_mfma_f32_16x16x32_bf16 v[64:67], v[96:99], a[176:179], v[64:67]
    v_mfma_f32_16x16x32_bf16 v[68:71], v[96:99], v[192:195], v[68:71]
    v_mfma_f32_16x16x32_bf16 v[80:83], v[100:103], a[176:179], v[80:83]
    v_mfma_f32_16x16x32_bf16 v[84:87], v[100:103], v[192:195], v[84:87]
    ds_read_b64_tr_b16 v[96:97], v10 offset:16384
    ds_read_b64_tr_b16 v[98:99], v10 offset:16640
    ds_read_b64_tr_b16 v[100:101], v11 offset:16384
    ds_read_b64_tr_b16 v[102:103], v11 offset:16640
    s_waitcnt lgkmcnt(12)
    v_mfma_f32_16x16x32_bf16 v[64:67], v[104:107], a[180:183], v[64:67]
    v_mfma_f32_16x16x32_bf16 v[68:71], v[104:107], v[196:199], v[68:71]
    v_mfma_f32_16x16x32_bf16 v[80:83], v[108:111], a[180:183], v[80:83]
    v_mfma_f32_16x16x32_bf16 v[84:87], v[108:111], v[196:199], v[84:87]
    ds_read_b64_tr_b16 v[104:105], v10 offset:18432
    ds_read_b64_tr_b16 v[106:107], v10 offset:18688
    ds_read_b64_tr_b16 v[108:109], v11 offset:18432
    ds_read_b64_tr_b16 v[110:111], v11 offset:18688
    s_waitcnt lgkmcnt(12)
    v_mfma_f32_16x16x32_bf16 v[64:67], v[112:115], a[184:187], v[64:67]
    v_mfma_f32_16x16x32_bf16 v[68:71], v[112:115], v[200:203], v[68:71]
    v_mfma_f32_16x16x32_bf16 v[80:83], v[116:119], a[184:187], v[80:83]
    v_mfma_f32_16x16x32_bf16 v[84:87], v[116:119], v[200:203], v[84:87]
    ds_read_b64_tr_b16 v[112:113], v10 offset:20480
    ds_read_b64_tr_b16 v[114:115], v10 offset:20736
    ds_read_b64_tr_b16 v[116:117], v11 offset:20480
    ds_read_b64_tr_b16 v[118:119], v11 offset:20736
    s_waitcnt lgkmcnt(12)
    v_mfma_f32_16x16x32_bf16 v[64:67], v[120:123], a[188:191], v[64:67]
    v_mfma_f32_16x16x32_bf16 v[68:71], v[120:123], v[204:207], v[68:71]
    v_mfma_f32_16x16x32_bf16 v[80:83], v[124:127], a[188:191], v[80:83]
    v_mfma_f32_16x16x32_bf16 v[84:87], v[124:127], v[204:207], v[84:87]
    ds_read_b64_tr_b16 v[120:121], v10 offset:22528
    ds_read_b64_tr_b16 v[122:123], v10 offset:22784
    ds_read_b64_tr_b16 v[124:125], v11 offset:22528
    ds_read_b64_tr_b16 v[126:127], v11 offset:22784
    s_waitcnt lgkmcnt(12)
    v_mfma_f32_16x16x32_bf16 v[64:67], v[96:99], a[192:195], v[64:67]
    v_mfma_f32_16x16x32_bf16 v[68:71], v[96:99], v[208:211], v[68:71]
    v_mfma_f32_16x16x32_bf16 v[80:83], v[100:103], a[192:195], v[80:83]
    v_mfma_f32_16x16x32_bf16 v[84:87], v[100:103], v[208:211], v[84:87]
    ds_read_b64_tr_b16 v[96:97], v10 offset:24576
    ds_read_b64_tr_b16 v[98:99], v10 offset:24832
    ds_read_b64_tr_b16 v[100:101], v11 offset:24576
    ds_read_b64_tr_b16 v[102:103], v11 offset:24832
    s_waitcnt lgkmcnt(12)
    v_mfma_f32_16x16x32_bf16 v[64:67], v[104:107], a[196:199], v[64:67]
    v_mfma_f32_16x16x32_bf16 v[68:71], v[104:107], v[212:215], v[68:71]
    v_mfma_f32_16x16x32_bf16 v[80:83], v[108:111], a[196:199], v[80:83]
    v_mfma_f32_16x16x32_bf16 v[84:87], v[108:111], v[212:215], v[84:87]
    ds_read_b64_tr_b16 v[104:105], v10 offset:26624
    ds_read_b64_tr_b16 v[106:107], v10 offset:26880
    ds_read_b64_tr_b16 v[108:109], v11 offset:26624
    ds_read_b64_tr_b16 v[110:111], v11 offset:26880
    s_waitcnt lgkmcnt(12)
    v_mfma_f32_16x16x32_bf16 v[64:67], v[112:115], a[200:203], v[64:67]
    v_mfma_f32_16x16x32_bf16 v[68:71], v[112:115], v[216:219], v[68:71]
    v_mfma_f32_16x16x32_bf16 v[80:83], v[116:119], a[200:203], v[80:83]
    v_mfma_f32_16x16x32_bf16 v[84:87], v[116:119], v[216:219], v[84:87]
    ds_read_b64_tr_b16 v[112:113], v10 offset:28672
    ds_read_b64_tr_b16 v[114:115], v10 offset:28928
    ds_read_b64_tr_b16 v[116:117], v11 offset:28672
    ds_read_b64_tr_b16 v[118:119], v11 offset:28928
    s_waitcnt lgkmcnt(12)
    v_mfma_f32_16x16x32_bf16 v[64:67], v[120:123], a[204:207], v[64:67]
    v_mfma_f32_16x16x32_bf16 v[68:71], v[120:123], v[220:223], v[68:71]
    v_mfma_f32_16x16x32_bf16 v[80:83], v[124:127], a[204:207], v[80:83]
    v_mfma_f32_16x16x32_bf16 v[84:87], v[124:127], v[220:223], v[84:87]
    ds_read_b64_tr_b16 v[120:121], v10 offset:30720
    ds_read_b64_tr_b16 v[122:123], v10 offset:30976
    ds_read_b64_tr_b16 v[124:125], v11 offset:30720
    ds_read_b64_tr_b16 v[126:127], v11 offset:30976
    s_waitcnt lgkmcnt(12)
    v_mfma_f32_16x16x32_bf16 v[64:67], v[96:99], a[208:211], v[64:67]
    v_mfma_f32_16x16x32_bf16 v[68:71], v[96:99], v[224:227], v[68:71]
    v_mfma_f32_16x16x32_bf16 v[80:83], v[100:103], a[208:211], v[80:83]
    v_mfma_f32_16x16x32_bf16 v[84:87], v[100:103], v[224:227], v[84:87]
    ds_read_b64_tr_b16 v[96:97], v10 offset:32768
    ds_read_b64_tr_b16 v[98:99], v10 offset:33024
    ds_read_b64_tr_b16 v[100:101], v11 offset:32768
    ds_read_b64_tr_b16 v[102:103], v11 offset:33024
    s_waitcnt lgkmcnt(12)
    v_mfma_f32_16x16x32_bf16 v[64:67], v[104:107], a[212:215], v[64:67]
    v_mfma_f32_16x16x32_bf16 v[68:71], v[104:107], v[228:231], v[68:71]
    v_mfma_f32_16x16x32_bf16 v[80:83], v[108:111], a[212:215], v[80:83]
    v_mfma_f32_16x16x32_bf16 v[84:87], v[108:111], v[228:231], v[84:87]
    ds_read_b64_tr_b16 v[104:105], v10 offset:34816
    ds_read_b64_tr_b16 v[106:107], v10 offset:35072
    ds_read_b64_tr_b16 v[108:109], v11 offset:34816
    ds_read_b64_tr_b16 v[110:111], v11 offset:35072
    s_waitcnt lgkmcnt(12)
    v_mfma_f32_16x16x32_bf16 v[64:67], v[112:115], a[216:219], v[64:67]
    v_mfma_f32_16x16x32_bf16 v[68:71], v[112:115], v[232:235], v[68:71]
    v_mfma_f32_16x16x32_bf16 v[80:83], v[116:119], a[216:219], v[80:83]
    v_mfma_f32_16x16x32_bf16 v[84:87], v[116:119], v[232:235], v[84:87]
    ds_read_b64_tr_b16 v[112:113], v10 offset:36864
    ds_read_b64_tr_b16 v[114:115], v10 offset:37120
    ds_read_b64_tr_b16 v[116:117], v11 offset:36864
    ds_read_b64_tr_b16 v[118:119], v11 offset:37120
    s_waitcnt lgkmcnt(12)
    v_mfma_f32_16x16x32_bf16 v[64:67], v[120:123], a[220:223], v[64:67]
    v_mfma_f32_16x16x32_bf16 v[68:71], v[120:123], v[236:239], v[68:71]
    v_mfma_f32_16x16x32_bf16 v[80:83], v[124:127], a[220:223], v[80:83]
    v_mfma_f32_16x16x32_bf16 v[84:87], v[124:127], v[236:239], v[84:87]
    ds_read_b64_tr_b16 v[120:121], v10 offset:38912
    ds_read_b64_tr_b16 v[122:123], v10 offset:39168
    ds_read_b64_tr_b16 v[124:125], v11 offset:38912
    ds_read_b64_tr_b16 v[126:127], v11 offset:39168
    s_waitcnt lgkmcnt(12)
    v_mfma_f32_16x16x32_bf16 v[64:67], v[96:99], a[224:227], v[64:67]
    v_mfma_f32_16x16x32_bf16 v[68:71], v[96:99], v[240:243], v[68:71]
    v_mfma_f32_16x16x32_bf16 v[80:83], v[100:103], a[224:227], v[80:83]
    v_mfma_f32_16x16x32_bf16 v[84:87], v[100:103], v[240:243], v[84:87]
    s_waitcnt lgkmcnt(8)
    v_mfma_f32_16x16x32_bf16 v[64:67], v[104:107], a[228:231], v[64:67]
    v_mfma_f32_16x16x32_bf16 v[68:71], v[104:107], v[244:247], v[68:71]
    v_mfma_f32_16x16x32_bf16 v[80:83], v[108:111], a[228:231], v[80:83]
    v_mfma_f32_16x16x32_bf16 v[84:87], v[108:111], v[244:247], v[84:87]
    s_waitcnt lgkmcnt(4)
    v_mfma_f32_16x16x32_bf16 v[64:67], v[112:115], a[232:235], v[64:67]
    v_mfma_f32_16x16x32_bf16 v[68:71], v[112:115], v[248:251], v[68:71]
    v_mfma_f32_16x16x32_bf16 v[80:83], v[116:119], a[232:235], v[80:83]
    v_mfma_f32_16x16x32_bf16 v[84:87], v[116:119], v[248:251], v[84:87]
    s_waitcnt lgkmcnt(0)
    v_mfma_f32_16x16x32_bf16 v[64:67], v[120:123], a[236:239], v[64:67]
    v_mfma_f32_16x16x32_bf16 v[68:71], v[120:123], v[252:255], v[68:71]
    v_mfma_f32_16x16x32_bf16 v[80:83], v[124:127], a[236:239], v[80:83]
    v_mfma_f32_16x16x32_bf16 v[84:87], v[124:127], v[252:255], v[84:87]
    s_add_u32 s41, s29, s37
    s_lshr_b32 s42, s41, 2
    s_lshl_b32 s42, s42, 13
    s_and_b32 s41, s41, 3
    s_lshl_b32 s41, s41, 10
    s_add_u32 s41, s41, s42
    s_add_u32 s41, s41, s38
    s_nop 7
    v_cvt_pk_bf16_f32 v144, v64, v65
    v_cvt_pk_bf16_f32 v145, v66, v67
    v_cvt_pk_bf16_f32 v146, v80, v81
    v_cvt_pk_bf16_f32 v147, v82, v83
    s_add_u32 s42, s41, 0
    buffer_store_dwordx4 v[144:147], v8, s[8:11], s42 offen sc1
    v_cvt_pk_bf16_f32 v148, v68, v69
    v_cvt_pk_bf16_f32 v149, v70, v71
    v_cvt_pk_bf16_f32 v150, v84, v85
    v_cvt_pk_bf16_f32 v151, v86, v87
    s_add_u32 s42, s41, 4096
    buffer_store_dwordx4 v[148:151], v8, s[8:11], s42 offen sc1
    s_branch L_che_e1
L_che_v1:
    ds_read_b64_tr_b16 v[96:97], v10 offset:0
    ds_read_b64_tr_b16 v[98:99], v10 offset:256
    ds_read_b64_tr_b16 v[100:101], v11 offset:0
    ds_read_b64_tr_b16 v[102:103], v11 offset:256
    ds_read_b64_tr_b16 v[104:105], v10 offset:2048
    ds_read_b64_tr_b16 v[106:107], v10 offset:2304
    ds_read_b64_tr_b16 v[108:109], v11 offset:2048
    ds_read_b64_tr_b16 v[110:111], v11 offset:2304
    ds_read_b64_tr_b16 v[112:113], v10 offset:4096
    ds_read_b64_tr_b16 v[114:115], v10 offset:4352
    ds_read_b64_tr_b16 v[116:117], v11 offset:4096
    ds_read_b64_tr_b16 v[118:119], v11 offset:4352
    ds_read_b64_tr_b16 v[120:121], v10 offset:6144
    ds_read_b64_tr_b16 v[122:123], v10 offset:6400
    ds_read_b64_tr_b16 v[124:125], v11 offset:6144
    ds_read_b64_tr_b16 v[126:127], v11 offset:6400
    s_waitcnt lgkmcnt(12)
    v_mfma_f32_16x16x32_bf16 v[64:67], a[160:163], v[96:99], 0
    v_mfma_f32_16x16x32_bf16 v[68:71], a[240:243], v[96:99], 0
    v_mfma_f32_16x16x32_bf16 v[80:83], a[160:163], v[100:103], 0
    v_mfma_f32_16x16x32_bf16 v[84:87], a[240:243], v[100:103], 0
    ds_read_b64_tr_b16 v[96:97], v10 offset:8192
    ds_read_b64_tr_b16 v[98:99], v10 offset:8448
    ds_read_b64_tr_b16 v[100:101], v11 offset:8192
    ds_read_b64_tr_b16 v[102:103], v11 offset:8448
    s_waitcnt lgkmcnt(12)
    v_mfma_f32_16x16x32_bf16 v[64:67], a[164:167], v[104:107], v[64:67]
    v_mfma_f32_16x16x32_bf16 v[68:71], a[244:247], v[104:107], v[68:71]
    v_mfma_f32_16x16x32_bf16 v[80:83], a[164:167], v[108:111], v[80:83]
    v_mfma_f32_16x16x32_bf16 v[84:87], a[244:247], v[108:111], v[84:87]
    ds_read_b64_tr_b16 v[104:105], v10 offset:10240
    ds_read_b64_tr_b16 v[106:107], v10 offset:10496
    ds_read_b64_tr_b16 v[108:109], v11 offset:10240
    ds_read_b64_tr_b16 v[110:111], v11 offset:10496
    s_waitcnt lgkmcnt(12)
    v_mfma_f32_16x16x32_bf16 v[64:67], a[168:171], v[112:115], v[64:67]
    v_mfma_f32_16x16x32_bf16 v[68:71], a[248:251], v[112:115], v[68:71]
    v_mfma_f32_16x16x32_bf16 v[80:83], a[168:171], v[116:119], v[80:83]
    v_mfma_f32_16x16x32_bf16 v[84:87], a[248:251], v[116:119], v[84:87]
    ds_read_b64_tr_b16 v[112:113], v10 offset:12288
    ds_read_b64_tr_b16 v[114:115], v10 offset:12544
    ds_read_b64_tr_b16 v[116:117], v11 offset:12288
    ds_read_b64_tr_b16 v[118:119], v11 offset:12544
    s_waitcnt lgkmcnt(12)
    v_mfma_f32_16x16x32_bf16 v[64:67], a[172:175], v[120:123], v[64:67]
    v_mfma_f32_16x16x32_bf16 v[68:71], a[252:255], v[120:123], v[68:71]
    v_mfma_f32_16x16x32_bf16 v[80:83], a[172:175], v[124:127], v[80:83]
    v_mfma_f32_16x16x32_bf16 v[84:87], a[252:255], v[124:127], v[84:87]
    ds_read_b64_tr_b16 v[120:121], v10 offset:14336
    ds_read_b64_tr_b16 v[122:123], v10 offset:14592
    ds_read_b64_tr_b16 v[124:125], v11 offset:14336
    ds_read_b64_tr_b16 v[126:127], v11 offset:14592
    s_waitcnt lgkmcnt(12)
    v_mfma_f32_16x16x32_bf16 v[64:67], a[176:179], v[96:99], v[64:67]
    v_mfma_f32_16x16x32_bf16 v[68:71], v[192:195], v[96:99], v[68:71]
    v_mfma_f32_16x16x32_bf16 v[80:83], a[176:179], v[100:103], v[80:83]
    v_mfma_f32_16x16x32_bf16 v[84:87], v[192:195], v[100:103], v[84:87]
    ds_read_b64_tr_b16 v[96:97], v10 offset:16384
    ds_read_b64_tr_b16 v[98:99], v10 offset:16640
    ds_read_b64_tr_b16 v[100:101], v11 offset:16384
    ds_read_b64_tr_b16 v[102:103], v11 offset:16640
    s_waitcnt lgkmcnt(12)
    v_mfma_f32_16x16x32_bf16 v[64:67], a[180:183], v[104:107], v[64:67]
    v_mfma_f32_16x16x32_bf16 v[68:71], v[196:199], v[104:107], v[68:71]
    v_mfma_f32_16x16x32_bf16 v[80:83], a[180:183], v[108:111], v[80:83]
    v_mfma_f32_16x16x32_bf16 v[84:87], v[196:199], v[108:111], v[84:87]
    ds_read_b64_tr_b16 v[104:105], v10 offset:18432
    ds_read_b64_tr_b16 v[106:107], v10 offset:18688
    ds_read_b64_tr_b16 v[108:109], v11 offset:18432
    ds_read_b64_tr_b16 v[110:111], v11 offset:18688
    s_waitcnt lgkmcnt(12)
    v_mfma_f32_16x16x32_bf16 v[64:67], a[184:187], v[112:115], v[64:67]
    v_mfma_f32_16x16x32_bf16 v[68:71], v[200:203], v[112:115], v[68:71]
    v_mfma_f32_16x16x32_bf16 v[80:83], a[184:187], v[116:119], v[80:83]
    v_mfma_f32_16x16x32_bf16 v[84:87], v[200:203], v[116:119], v[84:87]
    ds_read_b64_tr_b16 v[112:113], v10 offset:20480
    ds_read_b64_tr_b16 v[114:115], v10 offset:20736
    ds_read_b64_tr_b16 v[116:117], v11 offset:20480
    ds_read_b64_tr_b16 v[118:119], v11 offset:20736
    s_waitcnt lgkmcnt(12)
    v_mfma_f32_16x16x32_bf16 v[64:67], a[188:191], v[120:123], v[64:67]
    v_mfma_f32_16x16x32_bf16 v[68:71], v[204:207], v[120:123], v[68:71]
    v_mfma_f32_16x16x32_bf16 v[80:83], a[188:191], v[124:127], v[80:83]
    v_mfma_f32_16x16x32_bf16 v[84:87], v[204:207], v[124:127], v[84:87]
    ds_read_b64_tr_b16 v[120:121], v10 offset:22528
    ds_read_b64_tr_b16 v[122:123], v10 offset:22784
    ds_read_b64_tr_b16 v[124:125], v11 offset:22528
    ds_read_b64_tr_b16 v[126:127], v11 offset:22784
    s_waitcnt lgkmcnt(12)
    v_mfma_f32_16x16x32_bf16 v[64:67], a[192:195], v[96:99], v[64:67]
    v_mfma_f32_16x16x32_bf16 v[68:71], v[208:211], v[96:99], v[68:71]
    v_mfma_f32_16x16x32_bf16 v[80:83], a[192:195], v[100:103], v[80:83]
    v_mfma_f32_16x16x32_bf16 v[84:87], v[208:211], v[100:103], v[84:87]
    ds_read_b64_tr_b16 v[96:97], v10 offset:24576
    ds_read_b64_tr_b16 v[98:99], v10 offset:24832
    ds_read_b64_tr_b16 v[100:101], v11 offset:24576
    ds_read_b64_tr_b16 v[102:103], v11 offset:24832
    s_waitcnt lgkmcnt(12)
    v_mfma_f32_16x16x32_bf16 v[64:67], a[196:199], v[104:107], v[64:67]
    v_mfma_f32_16x16x32_bf16 v[68:71], v[212:215], v[104:107], v[68:71]
    v_mfma_f32_16x16x32_bf16 v[80:83], a[196:199], v[108:111], v[80:83]
    v_mfma_f32_16x16x32_bf16 v[84:87], v[212:215], v[108:111], v[84:87]
    ds_read_b64_tr_b16 v[104:105], v10 offset:26624
    ds_read_b64_tr_b16 v[106:107], v10 offset:26880
    ds_read_b64_tr_b16 v[108:109], v11 offset:26624
    ds_read_b64_tr_b16 v[110:111], v11 offset:26880
    s_waitcnt lgkmcnt(12)
    v_mfma_f32_16x16x32_bf16 v[64:67], a[200:203], v[112:115], v[64:67]
    v_mfma_f32_16x16x32_bf16 v[68:71], v[216:219], v[112:115], v[68:71]
    v_mfma_f32_16x16x32_bf16 v[80:83], a[200:203], v[116:119], v[80:83]
    v_mfma_f32_16x16x32_bf16 v[84:87], v[216:219], v[116:119], v[84:87]
    ds_read_b64_tr_b16 v[112:113], v10 offset:28672
    ds_read_b64_tr_b16 v[114:115], v10 offset:28928
    ds_read_b64_tr_b16 v[116:117], v11 offset:28672
    ds_read_b64_tr_b16 v[118:119], v11 offset:28928
    s_waitcnt lgkmcnt(12)
    v_mfma_f32_16x16x32_bf16 v[64:67], a[204:207], v[120:123], v[64:67]
    v_mfma_f32_16x16x32_bf16 v[68:71], v[220:223], v[120:123], v[68:71]
    v_mfma_f32_16x16x32_bf16 v[80:83], a[204:207], v[124:127], v[80:83]
    v_mfma_f32_16x16x32_bf16 v[84:87], v[220:223], v[124:127], v[84:87]
    ds_read_b64_tr_b16 v[120:121], v10 offset:30720
    ds_read_b64_tr_b16 v[122:123], v10 offset:30976
    ds_read_b64_tr_b16 v[124:125], v11 offset:30720
    ds_read_b64_tr_b16 v[126:127], v11 offset:30976
    s_waitcnt lgkmcnt(12)
    v_mfma_f32_16x16x32_bf16 v[64:67], a[208:211], v[96:99], v[64:67]
    v_mfma_f32_16x16x32_bf16 v[68:71], v[224:227], v[96:99], v[68:71]
    v_mfma_f32_16x16x32_bf16 v[80:83], a[208:211], v[100:103], v[80:83]
    v_mfma_f32_16x16x32_bf16 v[84:87], v[224:227], v[100:103], v[84:87]
    ds_read_b64_tr_b16 v[96:97], v10 offset:32768
    ds_read_b64_tr_b16 v[98:99], v10 offset:33024
    ds_read_b64_tr_b16 v[100:101], v11 offset:32768
    ds_read_b64_tr_b16 v[102:103], v11 offset:33024
    s_waitcnt lgkmcnt(12)
    v_mfma_f32_16x16x32_bf16 v[64:67], a[212:215], v[104:107], v[64:67]
    v_mfma_f32_16x16x32_bf16 v[68:71], v[228:231], v[104:107], v[68:71]
    v_mfma_f32_16x16x32_bf16 v[80:83], a[212:215], v[108:111], v[80:83]
    v_mfma_f32_16x16x32_bf16 v[84:87], v[228:231], v[108:111], v[84:87]
    ds_read_b64_tr_b16 v[104:105], v10 offset:34816
    ds_read_b64_tr_b16 v[106:107], v10 offset:35072
    ds_read_b64_tr_b16 v[108:109], v11 offset:34816
    ds_read_b64_tr_b16 v[110:111], v11 offset:35072
    s_waitcnt lgkmcnt(12)
    v_mfma_f32_16x16x32_bf16 v[64:67], a[216:219], v[112:115], v[64:67]
    v_mfma_f32_16x16x32_bf16 v[68:71], v[232:235], v[112:115], v[68:71]
    v_mfma_f32_16x16x32_bf16 v[80:83], a[216:219], v[116:119], v[80:83]
    v_mfma_f32_16x16x32_bf16 v[84:87], v[232:235], v[116:119], v[84:87]
    ds_read_b64_tr_b16 v[112:113], v10 offset:36864
    ds_read_b64_tr_b16 v[114:115], v10 offset:37120
    ds_read_b64_tr_b16 v[116:117], v11 offset:36864
    ds_read_b64_tr_b16 v[118:119], v11 offset:37120
    s_waitcnt lgkmcnt(12)
    v_mfma_f32_16x16x32_bf16 v[64:67], a[220:223], v[120:123], v[64:67]
    v_mfma_f32_16x16x32_bf16 v[68:71], v[236:239], v[120:123], v[68:71]
    v_mfma_f32_16x16x32_bf16 v[80:83], a[220:223], v[124:127], v[80:83]
    v_mfma_f32_16x16x32_bf16 v[84:87], v[236:239], v[124:127], v[84:87]
    ds_read_b64_tr_b16 v[120:121], v10 offset:38912
    ds_read_b64_tr_b16 v[122:123], v10 offset:39168
    ds_read_b64_tr_b16 v[124:125], v11 offset:38912
    ds_read_b64_tr_b16 v[126:127], v11 offset:39168
    s_waitcnt lgkmcnt(12)
    v_mfma_f32_16x16x32_bf16 v[64:67], a[224:227], v[96:99], v[64:67]
    v_mfma_f32_16x16x32_bf16 v[68:71], v[240:243], v[96:99], v[68:71]
    v_mfma_f32_16x16x32_bf16 v[80:83], a[224:227], v[100:103], v[80:83]
    v_mfma_f32_16x16x32_bf16 v[84:87], v[240:243], v[100:103], v[84:87]
    s_waitcnt lgkmcnt(8)
    v_mfma_f32_16x16x32_bf16 v[64:67], a[228:231], v[104:107], v[64:67]
    v_mfma_f32_16x16x32_bf16 v[68:71], v[244:247], v[104:107], v[68:71]
    v_mfma_f32_16x16x32_bf16 v[80:83], a[228:231], v[108:111], v[80:83]
    v_mfma_f32_16x16x32_bf16 v[84:87], v[244:247], v[108:111], v[84:87]
    s_waitcnt lgkmcnt(4)
    v_mfma_f32_16x16x32_bf16 v[64:67], a[232:235], v[112:115], v[64:67]
    v_mfma_f32_16x16x32_bf16 v[68:71], v[248:251], v[112:115], v[68:71]
    v_mfma_f32_16x16x32_bf16 v[80:83], a[232:235], v[116:119], v[80:83]
    v_mfma_f32_16x16x32_bf16 v[84:87], v[248:251], v[116:119], v[84:87]
    s_waitcnt lgkmcnt(0)
    v_mfma_f32_16x16x32_bf16 v[64:67], a[236:239], v[120:123], v[64:67]
    v_mfma_f32_16x16x32_bf16 v[68:71], v[252:255], v[120:123], v[68:71]
    v_mfma_f32_16x16x32_bf16 v[80:83], a[236:239], v[124:127], v[80:83]
    v_mfma_f32_16x16x32_bf16 v[84:87], v[252:255], v[124:127], v[84:87]
    s_add_u32 s41, s29, s37
    s_lshl_b32 s41, s41, 11
    s_add_u32 s41, s41, s38
    s_nop 7
    v_cvt_pk_bf16_f32 v144, v64, v65
    v_cvt_pk_bf16_f32 v145, v66, v67
    v_cvt_pk_bf16_f32 v146, v68, v69
    v_cvt_pk_bf16_f32 v147, v70, v71
    buffer_store_dwordx4 v[144:147], v8, s[8:11], s41 offen offset:0 sc1
    v_cvt_pk_bf16_f32 v148, v80, v81
    v_cvt_pk_bf16_f32 v149, v82, v83
    v_cvt_pk_bf16_f32 v150, v84, v85
    v_cvt_pk_bf16_f32 v151, v86, v87
    buffer_store_dwordx4 v[148:151], v8, s[8:11], s41 offen offset:1024 sc1
L_che_e1:
    v_add_u32 v10, 40960, v10
    v_add_u32 v11, 40960, v11
    s_add_u32 s37, s37, 1
    s_cmp_lt_u32 s37, 2
    s_cbranch_scc1 L_che_u1
    s_add_u32 s38, s38, 1048576
    s_add_u32 s18, s18, 1
    s_cmp_lg_u32 s16, 0
    s_cbranch_scc1 L_chp_33_a
    s_cmp_lg_u32 s94, 0
    s_cbranch_scc1 L_chd_34_d
    s_load_dwordx2 s[6:7], s[0:1], 104
    s_waitcnt lgkmcnt(0)
    s_mov_b32 s84, s6
    s_mov_b32 s85, s7
    s_mov_b32 s86, 256
    s_mov_b32 s87, 0x00020000
L_chd_34:
    v_mov_b32 v12, 0
    buffer_load_dword v13, v12, s[84:87], 0 offen offset:136 sc1
    s_waitcnt vmcnt(0)
    v_readfirstlane_b32 s7, v13
    s_cmp_ge_u32 s7, 52
    s_cbranch_scc1 L_chd_34_s
    s_sleep 8
    s_branch L_chd_34
L_chd_34_s:
    s_mov_b32 s94, 1
    s_lshl_b32 s7, s2, 2
    s_add_u32 s7, s7, 120599552
    v_mov_b32 v13, s93
    buffer_store_dword v13, v12, s[8:11], s7 offen sc1
L_chd_34_d:
L_chp_33_a:
    s_waitcnt vmcnt(0)
    s_barrier
    s_cmp_lg_u32 s16, 0
    s_cbranch_scc1 L_chp_33
    s_mov_b64 exec, 1
    v_mov_b32 v12, 0
    v_mov_b32 v13, s18
    buffer_store_dword v13, v12, s[8:11], s54 offen sc1
    s_mov_b64 exec, -1
L_chp_33:
    s_cmp_lt_u32 s18, 16
    s_cbranch_scc1 L_che_grp
    s_branch L_ch_hend
L_ch_hpr:
    s_sub_u32 s17, s17, 128
    s_mov_b32 s55, 2
    s_cmp_ge_u32 s17, 91
    s_cbranch_scc1 L_ch_hgt
    s_load_dwordx2 s[12:13], s[0:1], 40
    s_load_dwordx2 s[6:7], s[0:1], 80
    s_mov_b32 s14, 5242880
    s_mov_b32 s15, 0x00020000
    s_mov_b32 s20, 15728640
    s_mov_b32 s21, 131072
    s_waitcnt lgkmcnt(0)
    s_cmp_lt_u32 s17, 64
    s_cbranch_scc1 L_wp_35
    s_mov_b64 s[12:13], s[6:7]
    s_mov_b32 s14, 2211840
    s_mov_b32 s20, 25395200
    s_mov_b32 s21, 55296
    s_sub_u32 s17, s17, 64
L_wp_35:
    v_and_b32 v1, 15, v0
    v_lshrrev_b32 v2, 4, v0
    v_lshlrev_b32 v8, 4, v0
    v_add_u32 v31, 0, v0
    v_mul_u32_u24 v32, 6554, v31
    v_lshrrev_b32 v32, 16, v32
    v_mul_u32_u24 v33, 10, v32
    v_sub_u32 v31, v31, v33
    v_mul_u32_u24 v32, 1280, v32
    v_lshl_add_u32 v34, v31, 4, v32
    v_add_u32 v31, 64, v0
    v_mul_u32_u24 v32, 6554, v31
    v_lshrrev_b32 v32, 16, v32
    v_mul_u32_u24 v33, 10, v32
    v_sub_u32 v31, v31, v33
    v_mul_u32_u24 v32, 1280, v32
    v_lshl_add_u32 v35, v31, 4, v32
    v_subrev_u32 v35, 1024, v35
    v_add_u32 v31, 128, v0
    v_mul_u32_u24 v32, 6554, v31
    v_lshrrev_b32 v32, 16, v32
    v_mul_u32_u24 v33, 10, v32
    v_sub_u32 v31, v31, v33
    v_mul_u32_u24 v32, 1280, v32
    v_lshl_add_u32 v36, v31, 4, v32
    v_subrev_u32 v36, 2048, v36
    v_add_u32 v31, 192, v0
    v_mul_u32_u24 v32, 6554, v31
    v_lshrrev_b32 v32, 16, v32
    v_mul_u32_u24 v33, 10, v32
    v_sub_u32 v31, v31, v33
    v_mul_u32_u24 v32, 1280, v32
    v_lshl_add_u32 v37, v31, 4, v32
    v_subrev_u32 v37, 3072, v37
    v_add_u32 v31, 256, v0
    v_mul_u32_u24 v32, 6554, v31
    v_lshrrev_b32 v32, 16, v32
    v_mul_u32_u24 v33, 10, v32
    v_sub_u32 v31, v31, v33
    v_mul_u32_u24 v32, 1280, v32
    v_lshl_add_u32 v38, v31, 4, v32
    v_lshrrev_b32 v31, 2, v1
    v_lshl_add_u32 v39, v2, 2, v31
    v_mul_u32_u24 v39, 160, v39
    v_and_b32 v31, 3, v1
    v_lshl_add_u32 v39, v31, 3, v39
    s_mul_i32 s22, s16, 20480
    v_add_u32 v39, s22, v39
    s_mul_i32 s23, s17, 81920
    s_mul_i32 s18, s16, 320
    s_add_u32 s23, s23, s18
    s_add_u32 s18, s22, 0
    s_mov_b32 m0, s18
    s_add_u32 s19, s23, 0
    buffer_load_dwordx4 v34, s[12:15], s19 offen offset:0 lds
    buffer_load_dwordx4 v35, s[12:15], s19 offen offset:1024 lds
    buffer_load_dwordx4 v36, s[12:15], s19 offen offset:2048 lds
    buffer_load_dwordx4 v37, s[12:15], s19 offen offset:3072 lds
    s_add_u32 s18, s18, 4096
    s_mov_b32 m0, s18
    s_nop 0
    buffer_load_dwordx4 v38, s[12:15], s19 offen lds
    s_add_u32 s18, s22, 5120
    s_mov_b32 m0, s18
    s_add_u32 s19, s23, 40960
    buffer_load_dwordx4 v34, s[12:15], s19 offen offset:0 lds
    buffer_load_dwordx4 v35, s[12:15], s19 offen offset:1024 lds
    buffer_load_dwordx4 v36, s[12:15], s19 offen offset:2048 lds
    buffer_load_dwordx4 v37, s[12:15], s19 offen offset:3072 lds
    s_add_u32 s18, s18, 4096
    s_mov_b32 m0, s18
    s_nop 0
    buffer_load_dwordx4 v38, s[12:15], s19 offen lds
    s_add_u32 s18, s22, 10240
    s_mov_b32 m0, s18
    s_add_u32 s19, s23, 160
    buffer_load_dwordx4 v34, s[12:15], s19 offen offset:0 lds
    buffer_load_dwordx4 v35, s[12:15], s19 offen offset:1024 lds
    buffer_load_dwordx4 v36, s[12:15], s19 offen offset:2048 lds
    buffer_load_dwordx4 v37, s[12:15], s19 offen offset:3072 lds
    s_add_u32 s18, s18, 4096
    s_mov_b32 m0, s18
    s_nop 0
    buffer_load_dwordx4 v38, s[12:15], s19 offen lds
    s_add_u32 s18, s22, 15360
    s_mov_b32 m0, s18
    s_add_u32 s19, s23, 41120
    buffer_load_dwordx4 v34, s[12:15], s19 offen offset:0 lds
    buffer_load_dwordx4 v35, s[12:15], s19 offen offset:1024 lds
    buffer_load_dwordx4 v36, s[12:15], s19 offen offset:2048 lds
    buffer_load_dwordx4 v37, s[12:15], s19 offen offset:3072 lds
    s_add_u32 s18, s18, 4096
    s_mov_b32 m0, s18
    s_nop 0
    buffer_load_dwordx4 v38, s[12:15], s19 offen lds
    s_mul_i32 s18, s16, 10
    s_mul_i32 s18, s18, s21
    s_add_u32 s20, s20, s18
    s_lshl_b32 s18, s17, 11
    s_add_u32 s20, s20, s18
    s_waitcnt vmcnt(0)
    ds_read_b64_tr_b16 v[40:41], v39 offset:0
    ds_read_b64_tr_b16 v[42:43], v39 offset:2560
    ds_read_b64_tr_b16 v[44:45], v39 offset:5120
    ds_read_b64_tr_b16 v[46:47], v39 offset:7680
    ds_read_b64_tr_b16 v[48:49], v39 offset:32
    ds_read_b64_tr_b16 v[50:51], v39 offset:2592
    ds_read_b64_tr_b16 v[52:53], v39 offset:5152
    ds_read_b64_tr_b16 v[54:55], v39 offset:7712
    ds_read_b64_tr_b16 v[56:57], v39 offset:64
    ds_read_b64_tr_b16 v[58:59], v39 offset:2624
    ds_read_b64_tr_b16 v[60:61], v39 offset:5184
    ds_read_b64_tr_b16 v[62:63], v39 offset:7744
    ds_read_b64_tr_b16 v[64:65], v39 offset:96
    ds_read_b64_tr_b16 v[66:67], v39 offset:2656
    ds_read_b64_tr_b16 v[68:69], v39 offset:5216
    ds_read_b64_tr_b16 v[70:71], v39 offset:7776
    ds_read_b64_tr_b16 v[72:73], v39 offset:128
    ds_read_b64_tr_b16 v[74:75], v39 offset:2688
    ds_read_b64_tr_b16 v[76:77], v39 offset:5248
    ds_read_b64_tr_b16 v[78:79], v39 offset:7808
    ds_read_b64_tr_b16 v[80:81], v39 offset:10240
    ds_read_b64_tr_b16 v[82:83], v39 offset:12800
    ds_read_b64_tr_b16 v[84:85], v39 offset:15360
    ds_read_b64_tr_b16 v[86:87], v39 offset:17920
    ds_read_b64_tr_b16 v[88:89], v39 offset:10272
    ds_read_b64_tr_b16 v[90:91], v39 offset:12832
    ds_read_b64_tr_b16 v[92:93], v39 offset:15392
    ds_read_b64_tr_b16 v[94:95], v39 offset:17952
    ds_read_b64_tr_b16 v[96:97], v39 offset:10304
    ds_read_b64_tr_b16 v[98:99], v39 offset:12864
    ds_read_b64_tr_b16 v[100:101], v39 offset:15424
    ds_read_b64_tr_b16 v[102:103], v39 offset:17984
    ds_read_b64_tr_b16 v[104:105], v39 offset:10336
    ds_read_b64_tr_b16 v[106:107], v39 offset:12896
    ds_read_b64_tr_b16 v[108:109], v39 offset:15456
    ds_read_b64_tr_b16 v[110:111], v39 offset:18016
    ds_read_b64_tr_b16 v[112:113], v39 offset:10368
    ds_read_b64_tr_b16 v[114:115], v39 offset:12928
    ds_read_b64_tr_b16 v[116:117], v39 offset:15488
    ds_read_b64_tr_b16 v[118:119], v39 offset:18048
    s_waitcnt lgkmcnt(0)
    buffer_store_dwordx4 v[40:43], v8, s[8:11], s20 offen offset:0 sc1
    buffer_store_dwordx4 v[44:47], v8, s[8:11], s20 offen offset:1024 sc1
    s_add_u32 s20, s20, s21
    buffer_store_dwordx4 v[48:51], v8, s[8:11], s20 offen offset:0 sc1
    buffer_store_dwordx4 v[52:55], v8, s[8:11], s20 offen offset:1024 sc1
    s_add_u32 s20, s20, s21
    buffer_store_dwordx4 v[56:59], v8, s[8:11], s20 offen offset:0 sc1
    buffer_store_dwordx4 v[60:63], v8, s[8:11], s20 offen offset:1024 sc1
    s_add_u32 s20, s20, s21
    buffer_store_dwordx4 v[64:67], v8, s[8:11], s20 offen offset:0 sc1
    buffer_store_dwordx4 v[68:71], v8, s[8:11], s20 offen offset:1024 sc1
    s_add_u32 s20, s20, s21
    buffer_store_dwordx4 v[72:75], v8, s[8:11], s20 offen offset:0 sc1
    buffer_store_dwordx4 v[76:79], v8, s[8:11], s20 offen offset:1024 sc1
    s_add_u32 s20, s20, s21
    buffer_store_dwordx4 v[80:83], v8, s[8:11], s20 offen offset:0 sc1
    buffer_store_dwordx4 v[84:87], v8, s[8:11], s20 offen offset:1024 sc1
    s_add_u32 s20, s20, s21
    buffer_store_dwordx4 v[88:91], v8, s[8:11], s20 offen offset:0 sc1
    buffer_store_dwordx4 v[92:95], v8, s[8:11], s20 offen offset:1024 sc1
    s_add_u32 s20, s20, s21
    buffer_store_dwordx4 v[96:99], v8, s[8:11], s20 offen offset:0 sc1
    buffer_store_dwordx4 v[100:103], v8, s[8:11], s20 offen offset:1024 sc1
    s_add_u32 s20, s20, s21
    buffer_store_dwordx4 v[104:107], v8, s[8:11], s20 offen offset:0 sc1
    buffer_store_dwordx4 v[108:111], v8, s[8:11], s20 offen offset:1024 sc1
    s_add_u32 s20, s20, s21
    buffer_store_dwordx4 v[112:115], v8, s[8:11], s20 offen offset:0 sc1
    buffer_store_dwordx4 v[116:119], v8, s[8:11], s20 offen offset:1024 sc1
    s_add_u32 s20, s20, s21
    s_branch L_ch_hend
L_ch_hgt:
    s_sub_u32 s17, s17, 91
    s_load_dwordx2 s[6:7], s[0:1], 0
    s_load_dwordx2 s[18:19], s[0:1], 88
    s_waitcnt lgkmcnt(0)
    s_mov_b32 s12, s6
    s_mov_b32 s13, s7
    s_mov_b32 s14, 2621440
    s_mov_b32 s15, 0x00020000
    s_mov_b32 s20, s18
    s_mov_b32 s21, s19
    s_mov_b32 s22, 1280
    s_mov_b32 s23, 0x00020000
    v_mul_u32_u24 v3, 20, v0
    v_mov_b32 v9, 0xffff0000
    s_lshl_b32 s25, s17, 6
    s_lshl_b32 s24, s16, 4
    s_add_u32 s25, s25, s24
    s_mul_i32 s26, s25, 1280
    buffer_load_dwordx4 v[4:7], v3, s[20:23], 0 offen
    buffer_load_dword v8, v3, s[20:23], 0 offen offset:16
    s_add_u32 s27, s26, 0
    buffer_load_dwordx4 v[64:67], v3, s[12:15], s27 offen
    buffer_load_dword v68, v3, s[12:15], s27 offen offset:16
    s_add_u32 s27, s26, 1280
    buffer_load_dwordx4 v[70:73], v3, s[12:15], s27 offen
    buffer_load_dword v74, v3, s[12:15], s27 offen offset:16
    s_add_u32 s27, s26, 2560
    buffer_load_dwordx4 v[76:79], v3, s[12:15], s27 offen
    buffer_load_dword v80, v3, s[12:15], s27 offen offset:16
    s_add_u32 s27, s26, 3840
    buffer_load_dwordx4 v[82:85], v3, s[12:15], s27 offen
    buffer_load_dword v86, v3, s[12:15], s27 offen offset:16
    s_add_u32 s27, s26, 5120
    buffer_load_dwordx4 v[88:91], v3, s[12:15], s27 offen
    buffer_load_dword v92, v3, s[12:15], s27 offen offset:16
    s_add_u32 s27, s26, 6400
    buffer_load_dwordx4 v[94:97], v3, s[12:15], s27 offen
    buffer_load_dword v98, v3, s[12:15], s27 offen offset:16
    s_add_u32 s27, s26, 7680
    buffer_load_dwordx4 v[100:103], v3, s[12:15], s27 offen
    buffer_load_dword v104, v3, s[12:15], s27 offen offset:16
    s_add_u32 s27, s26, 8960
    buffer_load_dwordx4 v[106:109], v3, s[12:15], s27 offen
    buffer_load_dword v110, v3, s[12:15], s27 offen offset:16
    s_add_u32 s27, s26, 10240
    buffer_load_dwordx4 v[112:115], v3, s[12:15], s27 offen
    buffer_load_dword v116, v3, s[12:15], s27 offen offset:16
    s_add_u32 s27, s26, 11520
    buffer_load_dwordx4 v[118:121], v3, s[12:15], s27 offen
    buffer_load_dword v122, v3, s[12:15], s27 offen offset:16
    s_add_u32 s27, s26, 12800
    buffer_load_dwordx4 v[124:127], v3, s[12:15], s27 offen
    buffer_load_dword v128, v3, s[12:15], s27 offen offset:16
    s_add_u32 s27, s26, 14080
    buffer_load_dwordx4 v[130:133], v3, s[12:15], s27 offen
    buffer_load_dword v134, v3, s[12:15], s27 offen offset:16
    s_add_u32 s27, s26, 15360
    buffer_load_dwordx4 v[136:139], v3, s[12:15], s27 offen
    buffer_load_dword v140, v3, s[12:15], s27 offen offset:16
    s_add_u32 s27, s26, 16640
    buffer_load_dwordx4 v[142:145], v3, s[12:15], s27 offen
    buffer_load_dword v146, v3, s[12:15], s27 offen offset:16
    s_add_u32 s27, s26, 17920
    buffer_load_dwordx4 v[148:151], v3, s[12:15], s27 offen
    buffer_load_dword v152, v3, s[12:15], s27 offen offset:16
    s_add_u32 s27, s26, 19200
    buffer_load_dwordx4 v[154:157], v3, s[12:15], s27 offen
    buffer_load_dword v158, v3, s[12:15], s27 offen offset:16
    s_lshl_b32 s25, s25, 2
    s_add_u32 s25, s25, 118571008
    v_mov_b32 v2, 0
    s_waitcnt vmcnt(0)
    v_mov_b32 v40, 0
    v_lshlrev_b32 v32, 16, v64
    v_lshlrev_b32 v33, 16, v4
    v_and_b32 v34, v9, v64
    v_and_b32 v35, v9, v4
    v_mul_f32 v32, v32, v33
    v_mul_f32 v34, v34, v35
    v_cvt_pk_bf16_f32 v32, v32, v34
    v_lshlrev_b32 v33, 16, v32
    v_and_b32 v34, v9, v32
    v_add_f32 v40, v40, v33
    v_add_f32 v40, v40, v34
    v_lshlrev_b32 v32, 16, v65
    v_lshlrev_b32 v33, 16, v5
    v_and_b32 v34, v9, v65
    v_and_b32 v35, v9, v5
    v_mul_f32 v32, v32, v33
    v_mul_f32 v34, v34, v35
    v_cvt_pk_bf16_f32 v32, v32, v34
    v_lshlrev_b32 v33, 16, v32
    v_and_b32 v34, v9, v32
    v_add_f32 v40, v40, v33
    v_add_f32 v40, v40, v34
    v_lshlrev_b32 v32, 16, v66
    v_lshlrev_b32 v33, 16, v6
    v_and_b32 v34, v9, v66
    v_and_b32 v35, v9, v6
    v_mul_f32 v32, v32, v33
    v_mul_f32 v34, v34, v35
    v_cvt_pk_bf16_f32 v32, v32, v34
    v_lshlrev_b32 v33, 16, v32
    v_and_b32 v34, v9, v32
    v_add_f32 v40, v40, v33
    v_add_f32 v40, v40, v34
    v_lshlrev_b32 v32, 16, v67
    v_lshlrev_b32 v33, 16, v7
    v_and_b32 v34, v9, v67
    v_and_b32 v35, v9, v7
    v_mul_f32 v32, v32, v33
    v_mul_f32 v34, v34, v35
    v_cvt_pk_bf16_f32 v32, v32, v34
    v_lshlrev_b32 v33, 16, v32
    v_and_b32 v34, v9, v32
    v_add_f32 v40, v40, v33
    v_add_f32 v40, v40, v34
    v_lshlrev_b32 v32, 16, v68
    v_lshlrev_b32 v33, 16, v8
    v_and_b32 v34, v9, v68
    v_and_b32 v35, v9, v8
    v_mul_f32 v32, v32, v33
    v_mul_f32 v34, v34, v35
    v_cvt_pk_bf16_f32 v32, v32, v34
    v_lshlrev_b32 v33, 16, v32
    v_and_b32 v34, v9, v32
    v_add_f32 v40, v40, v33
    v_add_f32 v40, v40, v34
    v_mov_b32 v41, 0
    v_lshlrev_b32 v32, 16, v70
    v_lshlrev_b32 v33, 16, v4
    v_and_b32 v34, v9, v70
    v_and_b32 v35, v9, v4
    v_mul_f32 v32, v32, v33
    v_mul_f32 v34, v34, v35
    v_cvt_pk_bf16_f32 v32, v32, v34
    v_lshlrev_b32 v33, 16, v32
    v_and_b32 v34, v9, v32
    v_add_f32 v41, v41, v33
    v_add_f32 v41, v41, v34
    v_lshlrev_b32 v32, 16, v71
    v_lshlrev_b32 v33, 16, v5
    v_and_b32 v34, v9, v71
    v_and_b32 v35, v9, v5
    v_mul_f32 v32, v32, v33
    v_mul_f32 v34, v34, v35
    v_cvt_pk_bf16_f32 v32, v32, v34
    v_lshlrev_b32 v33, 16, v32
    v_and_b32 v34, v9, v32
    v_add_f32 v41, v41, v33
    v_add_f32 v41, v41, v34
    v_lshlrev_b32 v32, 16, v72
    v_lshlrev_b32 v33, 16, v6
    v_and_b32 v34, v9, v72
    v_and_b32 v35, v9, v6
    v_mul_f32 v32, v32, v33
    v_mul_f32 v34, v34, v35
    v_cvt_pk_bf16_f32 v32, v32, v34
    v_lshlrev_b32 v33, 16, v32
    v_and_b32 v34, v9, v32
    v_add_f32 v41, v41, v33
    v_add_f32 v41, v41, v34
    v_lshlrev_b32 v32, 16, v73
    v_lshlrev_b32 v33, 16, v7
    v_and_b32 v34, v9, v73
    v_and_b32 v35, v9, v7
    v_mul_f32 v32, v32, v33
    v_mul_f32 v34, v34, v35
    v_cvt_pk_bf16_f32 v32, v32, v34
    v_lshlrev_b32 v33, 16, v32
    v_and_b32 v34, v9, v32
    v_add_f32 v41, v41, v33
    v_add_f32 v41, v41, v34
    v_lshlrev_b32 v32, 16, v74
    v_lshlrev_b32 v33, 16, v8
    v_and_b32 v34, v9, v74
    v_and_b32 v35, v9, v8
    v_mul_f32 v32, v32, v33
    v_mul_f32 v34, v34, v35
    v_cvt_pk_bf16_f32 v32, v32, v34
    v_lshlrev_b32 v33, 16, v32
    v_and_b32 v34, v9, v32
    v_add_f32 v41, v41, v33
    v_add_f32 v41, v41, v34
    v_mov_b32 v42, 0
    v_lshlrev_b32 v32, 16, v76
    v_lshlrev_b32 v33, 16, v4
    v_and_b32 v34, v9, v76
    v_and_b32 v35, v9, v4
    v_mul_f32 v32, v32, v33
    v_mul_f32 v34, v34, v35
    v_cvt_pk_bf16_f32 v32, v32, v34
    v_lshlrev_b32 v33, 16, v32
    v_and_b32 v34, v9, v32
    v_add_f32 v42, v42, v33
    v_add_f32 v42, v42, v34
    v_lshlrev_b32 v32, 16, v77
    v_lshlrev_b32 v33, 16, v5
    v_and_b32 v34, v9, v77
    v_and_b32 v35, v9, v5
    v_mul_f32 v32, v32, v33
    v_mul_f32 v34, v34, v35
    v_cvt_pk_bf16_f32 v32, v32, v34
    v_lshlrev_b32 v33, 16, v32
    v_and_b32 v34, v9, v32
    v_add_f32 v42, v42, v33
    v_add_f32 v42, v42, v34
    v_lshlrev_b32 v32, 16, v78
    v_lshlrev_b32 v33, 16, v6
    v_and_b32 v34, v9, v78
    v_and_b32 v35, v9, v6
    v_mul_f32 v32, v32, v33
    v_mul_f32 v34, v34, v35
    v_cvt_pk_bf16_f32 v32, v32, v34
    v_lshlrev_b32 v33, 16, v32
    v_and_b32 v34, v9, v32
    v_add_f32 v42, v42, v33
    v_add_f32 v42, v42, v34
    v_lshlrev_b32 v32, 16, v79
    v_lshlrev_b32 v33, 16, v7
    v_and_b32 v34, v9, v79
    v_and_b32 v35, v9, v7
    v_mul_f32 v32, v32, v33
    v_mul_f32 v34, v34, v35
    v_cvt_pk_bf16_f32 v32, v32, v34
    v_lshlrev_b32 v33, 16, v32
    v_and_b32 v34, v9, v32
    v_add_f32 v42, v42, v33
    v_add_f32 v42, v42, v34
    v_lshlrev_b32 v32, 16, v80
    v_lshlrev_b32 v33, 16, v8
    v_and_b32 v34, v9, v80
    v_and_b32 v35, v9, v8
    v_mul_f32 v32, v32, v33
    v_mul_f32 v34, v34, v35
    v_cvt_pk_bf16_f32 v32, v32, v34
    v_lshlrev_b32 v33, 16, v32
    v_and_b32 v34, v9, v32
    v_add_f32 v42, v42, v33
    v_add_f32 v42, v42, v34
    v_mov_b32 v43, 0
    v_lshlrev_b32 v32, 16, v82
    v_lshlrev_b32 v33, 16, v4
    v_and_b32 v34, v9, v82
    v_and_b32 v35, v9, v4
    v_mul_f32 v32, v32, v33
    v_mul_f32 v34, v34, v35
    v_cvt_pk_bf16_f32 v32, v32, v34
    v_lshlrev_b32 v33, 16, v32
    v_and_b32 v34, v9, v32
    v_add_f32 v43, v43, v33
    v_add_f32 v43, v43, v34
    v_lshlrev_b32 v32, 16, v83
    v_lshlrev_b32 v33, 16, v5
    v_and_b32 v34, v9, v83
    v_and_b32 v35, v9, v5
    v_mul_f32 v32, v32, v33
    v_mul_f32 v34, v34, v35
    v_cvt_pk_bf16_f32 v32, v32, v34
    v_lshlrev_b32 v33, 16, v32
    v_and_b32 v34, v9, v32
    v_add_f32 v43, v43, v33
    v_add_f32 v43, v43, v34
    v_lshlrev_b32 v32, 16, v84
    v_lshlrev_b32 v33, 16, v6
    v_and_b32 v34, v9, v84
    v_and_b32 v35, v9, v6
    v_mul_f32 v32, v32, v33
    v_mul_f32 v34, v34, v35
    v_cvt_pk_bf16_f32 v32, v32, v34
    v_lshlrev_b32 v33, 16, v32
    v_and_b32 v34, v9, v32
    v_add_f32 v43, v43, v33
    v_add_f32 v43, v43, v34
    v_lshlrev_b32 v32, 16, v85
    v_lshlrev_b32 v33, 16, v7
    v_and_b32 v34, v9, v85
    v_and_b32 v35, v9, v7
    v_mul_f32 v32, v32, v33
    v_mul_f32 v34, v34, v35
    v_cvt_pk_bf16_f32 v32, v32, v34
    v_lshlrev_b32 v33, 16, v32
    v_and_b32 v34, v9, v32
    v_add_f32 v43, v43, v33
    v_add_f32 v43, v43, v34
    v_lshlrev_b32 v32, 16, v86
    v_lshlrev_b32 v33, 16, v8
    v_and_b32 v34, v9, v86
    v_and_b32 v35, v9, v8
    v_mul_f32 v32, v32, v33
    v_mul_f32 v34, v34, v35
    v_cvt_pk_bf16_f32 v32, v32, v34
    v_lshlrev_b32 v33, 16, v32
    v_and_b32 v34, v9, v32
    v_add_f32 v43, v43, v33
    v_add_f32 v43, v43, v34
    s_nop 1
    v_add_f32 v44, v40, v40 row_ror:1
    v_add_f32 v45, v41, v41 row_ror:1
    v_add_f32 v46, v42, v42 row_ror:1
    v_add_f32 v47, v43, v43 row_ror:1
    v_mov_b32 v40, v44
    v_mov_b32 v41, v45
    v_mov_b32 v42, v46
    v_mov_b32 v43, v47
    s_nop 1
    v_add_f32 v44, v40, v40 row_ror:2
    v_add_f32 v45, v41, v41 row_ror:2
    v_add_f32 v46, v42, v42 row_ror:2
    v_add_f32 v47, v43, v43 row_ror:2
    v_mov_b32 v40, v44
    v_mov_b32 v41, v45
    v_mov_b32 v42, v46
    v_mov_b32 v43, v47
    s_nop 1
    v_add_f32 v44, v40, v40 row_ror:4
    v_add_f32 v45, v41, v41 row_ror:4
    v_add_f32 v46, v42, v42 row_ror:4
    v_add_f32 v47, v43, v43 row_ror:4
    v_mov_b32 v40, v44
    v_mov_b32 v41, v45
    v_mov_b32 v42, v46
    v_mov_b32 v43, v47
    s_nop 1
    v_add_f32 v44, v40, v40 row_ror:8
    v_add_f32 v45, v41, v41 row_ror:8
    v_add_f32 v46, v42, v42 row_ror:8
    v_add_f32 v47, v43, v43 row_ror:8
    v_mov_b32 v40, v44
    v_mov_b32 v41, v45
    v_mov_b32 v42, v46
    v_mov_b32 v43, v47
    s_nop 1
    v_permlane16_swap_b32 v40, v44
    v_permlane16_swap_b32 v41, v45
    v_permlane16_swap_b32 v42, v46
    v_permlane16_swap_b32 v43, v47
    v_add_f32 v40, v40, v44
    v_add_f32 v41, v41, v45
    v_add_f32 v42, v42, v46
    v_add_f32 v43, v43, v47
    v_mov_b32 v44, v40
    v_mov_b32 v45, v41
    v_mov_b32 v46, v42
    v_mov_b32 v47, v43
    s_nop 1
    v_permlane32_swap_b32 v40, v44
    v_permlane32_swap_b32 v41, v45
    v_permlane32_swap_b32 v42, v46
    v_permlane32_swap_b32 v43, v47
    v_add_f32 v40, v40, v44
    v_add_f32 v41, v41, v45
    v_add_f32 v42, v42, v46
    v_add_f32 v43, v43, v47
    v_cvt_pk_bf16_f32 v40, v40, v40
    v_lshlrev_b32 v40, 16, v40
    v_mul_f32 v40, 0xbfb8aa3b, v40
    v_cvt_pk_bf16_f32 v41, v41, v41
    v_lshlrev_b32 v41, 16, v41
    v_mul_f32 v41, 0xbfb8aa3b, v41
    v_cvt_pk_bf16_f32 v42, v42, v42
    v_lshlrev_b32 v42, 16, v42
    v_mul_f32 v42, 0xbfb8aa3b, v42
    v_cvt_pk_bf16_f32 v43, v43, v43
    v_lshlrev_b32 v43, 16, v43
    v_mul_f32 v43, 0xbfb8aa3b, v43
    v_exp_f32 v40, v40
    v_exp_f32 v41, v41
    v_exp_f32 v42, v42
    v_exp_f32 v43, v43
    s_nop 0
    v_add_f32 v40, 1.0, v40
    v_add_f32 v41, 1.0, v41
    v_add_f32 v42, 1.0, v42
    v_add_f32 v43, 1.0, v43
    v_rcp_f32 v40, v40
    v_rcp_f32 v41, v41
    v_rcp_f32 v42, v42
    v_rcp_f32 v43, v43
    s_nop 0
    v_cvt_pk_bf16_f32 v48, v40, v40
    v_lshlrev_b32 v48, 16, v48
    v_cvt_pk_bf16_f32 v49, v41, v41
    v_lshlrev_b32 v49, 16, v49
    v_cvt_pk_bf16_f32 v50, v42, v42
    v_lshlrev_b32 v50, 16, v50
    v_cvt_pk_bf16_f32 v51, v43, v43
    v_lshlrev_b32 v51, 16, v51
    v_mov_b32 v40, 0
    v_lshlrev_b32 v32, 16, v88
    v_lshlrev_b32 v33, 16, v4
    v_and_b32 v34, v9, v88
    v_and_b32 v35, v9, v4
    v_mul_f32 v32, v32, v33
    v_mul_f32 v34, v34, v35
    v_cvt_pk_bf16_f32 v32, v32, v34
    v_lshlrev_b32 v33, 16, v32
    v_and_b32 v34, v9, v32
    v_add_f32 v40, v40, v33
    v_add_f32 v40, v40, v34
    v_lshlrev_b32 v32, 16, v89
    v_lshlrev_b32 v33, 16, v5
    v_and_b32 v34, v9, v89
    v_and_b32 v35, v9, v5
    v_mul_f32 v32, v32, v33
    v_mul_f32 v34, v34, v35
    v_cvt_pk_bf16_f32 v32, v32, v34
    v_lshlrev_b32 v33, 16, v32
    v_and_b32 v34, v9, v32
    v_add_f32 v40, v40, v33
    v_add_f32 v40, v40, v34
    v_lshlrev_b32 v32, 16, v90
    v_lshlrev_b32 v33, 16, v6
    v_and_b32 v34, v9, v90
    v_and_b32 v35, v9, v6
    v_mul_f32 v32, v32, v33
    v_mul_f32 v34, v34, v35
    v_cvt_pk_bf16_f32 v32, v32, v34
    v_lshlrev_b32 v33, 16, v32
    v_and_b32 v34, v9, v32
    v_add_f32 v40, v40, v33
    v_add_f32 v40, v40, v34
    v_lshlrev_b32 v32, 16, v91
    v_lshlrev_b32 v33, 16, v7
    v_and_b32 v34, v9, v91
    v_and_b32 v35, v9, v7
    v_mul_f32 v32, v32, v33
    v_mul_f32 v34, v34, v35
    v_cvt_pk_bf16_f32 v32, v32, v34
    v_lshlrev_b32 v33, 16, v32
    v_and_b32 v34, v9, v32
    v_add_f32 v40, v40, v33
    v_add_f32 v40, v40, v34
    v_lshlrev_b32 v32, 16, v92
    v_lshlrev_b32 v33, 16, v8
    v_and_b32 v34, v9, v92
    v_and_b32 v35, v9, v8
    v_mul_f32 v32, v32, v33
    v_mul_f32 v34, v34, v35
    v_cvt_pk_bf16_f32 v32, v32, v34
    v_lshlrev_b32 v33, 16, v32
    v_and_b32 v34, v9, v32
    v_add_f32 v40, v40, v33
    v_add_f32 v40, v40, v34
    v_mov_b32 v41, 0
    v_lshlrev_b32 v32, 16, v94
    v_lshlrev_b32 v33, 16, v4
    v_and_b32 v34, v9, v94
    v_and_b32 v35, v9, v4
    v_mul_f32 v32, v32, v33
    v_mul_f32 v34, v34, v35
    v_cvt_pk_bf16_f32 v32, v32, v34
    v_lshlrev_b32 v33, 16, v32
    v_and_b32 v34, v9, v32
    v_add_f32 v41, v41, v33
    v_add_f32 v41, v41, v34
    v_lshlrev_b32 v32, 16, v95
    v_lshlrev_b32 v33, 16, v5
    v_and_b32 v34, v9, v95
    v_and_b32 v35, v9, v5
    v_mul_f32 v32, v32, v33
    v_mul_f32 v34, v34, v35
    v_cvt_pk_bf16_f32 v32, v32, v34
    v_lshlrev_b32 v33, 16, v32
    v_and_b32 v34, v9, v32
    v_add_f32 v41, v41, v33
    v_add_f32 v41, v41, v34
    v_lshlrev_b32 v32, 16, v96
    v_lshlrev_b32 v33, 16, v6
    v_and_b32 v34, v9, v96
    v_and_b32 v35, v9, v6
    v_mul_f32 v32, v32, v33
    v_mul_f32 v34, v34, v35
    v_cvt_pk_bf16_f32 v32, v32, v34
    v_lshlrev_b32 v33, 16, v32
    v_and_b32 v34, v9, v32
    v_add_f32 v41, v41, v33
    v_add_f32 v41, v41, v34
    v_lshlrev_b32 v32, 16, v97
    v_lshlrev_b32 v33, 16, v7
    v_and_b32 v34, v9, v97
    v_and_b32 v35, v9, v7
    v_mul_f32 v32, v32, v33
    v_mul_f32 v34, v34, v35
    v_cvt_pk_bf16_f32 v32, v32, v34
    v_lshlrev_b32 v33, 16, v32
    v_and_b32 v34, v9, v32
    v_add_f32 v41, v41, v33
    v_add_f32 v41, v41, v34
    v_lshlrev_b32 v32, 16, v98
    v_lshlrev_b32 v33, 16, v8
    v_and_b32 v34, v9, v98
    v_and_b32 v35, v9, v8
    v_mul_f32 v32, v32, v33
    v_mul_f32 v34, v34, v35
    v_cvt_pk_bf16_f32 v32, v32, v34
    v_lshlrev_b32 v33, 16, v32
    v_and_b32 v34, v9, v32
    v_add_f32 v41, v41, v33
    v_add_f32 v41, v41, v34
    v_mov_b32 v42, 0
    v_lshlrev_b32 v32, 16, v100
    v_lshlrev_b32 v33, 16, v4
    v_and_b32 v34, v9, v100
    v_and_b32 v35, v9, v4
    v_mul_f32 v32, v32, v33
    v_mul_f32 v34, v34, v35
    v_cvt_pk_bf16_f32 v32, v32, v34
    v_lshlrev_b32 v33, 16, v32
    v_and_b32 v34, v9, v32
    v_add_f32 v42, v42, v33
    v_add_f32 v42, v42, v34
    v_lshlrev_b32 v32, 16, v101
    v_lshlrev_b32 v33, 16, v5
    v_and_b32 v34, v9, v101
    v_and_b32 v35, v9, v5
    v_mul_f32 v32, v32, v33
    v_mul_f32 v34, v34, v35
    v_cvt_pk_bf16_f32 v32, v32, v34
    v_lshlrev_b32 v33, 16, v32
    v_and_b32 v34, v9, v32
    v_add_f32 v42, v42, v33
    v_add_f32 v42, v42, v34
    v_lshlrev_b32 v32, 16, v102
    v_lshlrev_b32 v33, 16, v6
    v_and_b32 v34, v9, v102
    v_and_b32 v35, v9, v6
    v_mul_f32 v32, v32, v33
    v_mul_f32 v34, v34, v35
    v_cvt_pk_bf16_f32 v32, v32, v34
    v_lshlrev_b32 v33, 16, v32
    v_and_b32 v34, v9, v32
    v_add_f32 v42, v42, v33
    v_add_f32 v42, v42, v34
    v_lshlrev_b32 v32, 16, v103
    v_lshlrev_b32 v33, 16, v7
    v_and_b32 v34, v9, v103
    v_and_b32 v35, v9, v7
    v_mul_f32 v32, v32, v33
    v_mul_f32 v34, v34, v35
    v_cvt_pk_bf16_f32 v32, v32, v34
    v_lshlrev_b32 v33, 16, v32
    v_and_b32 v34, v9, v32
    v_add_f32 v42, v42, v33
    v_add_f32 v42, v42, v34
    v_lshlrev_b32 v32, 16, v104
    v_lshlrev_b32 v33, 16, v8
    v_and_b32 v34, v9, v104
    v_and_b32 v35, v9, v8
    v_mul_f32 v32, v32, v33
    v_mul_f32 v34, v34, v35
    v_cvt_pk_bf16_f32 v32, v32, v34
    v_lshlrev_b32 v33, 16, v32
    v_and_b32 v34, v9, v32
    v_add_f32 v42, v42, v33
    v_add_f32 v42, v42, v34
    v_mov_b32 v43, 0
    v_lshlrev_b32 v32, 16, v106
    v_lshlrev_b32 v33, 16, v4
    v_and_b32 v34, v9, v106
    v_and_b32 v35, v9, v4
    v_mul_f32 v32, v32, v33
    v_mul_f32 v34, v34, v35
    v_cvt_pk_bf16_f32 v32, v32, v34
    v_lshlrev_b32 v33, 16, v32
    v_and_b32 v34, v9, v32
    v_add_f32 v43, v43, v33
    v_add_f32 v43, v43, v34
    v_lshlrev_b32 v32, 16, v107
    v_lshlrev_b32 v33, 16, v5
    v_and_b32 v34, v9, v107
    v_and_b32 v35, v9, v5
    v_mul_f32 v32, v32, v33
    v_mul_f32 v34, v34, v35
    v_cvt_pk_bf16_f32 v32, v32, v34
    v_lshlrev_b32 v33, 16, v32
    v_and_b32 v34, v9, v32
    v_add_f32 v43, v43, v33
    v_add_f32 v43, v43, v34
    v_lshlrev_b32 v32, 16, v108
    v_lshlrev_b32 v33, 16, v6
    v_and_b32 v34, v9, v108
    v_and_b32 v35, v9, v6
    v_mul_f32 v32, v32, v33
    v_mul_f32 v34, v34, v35
    v_cvt_pk_bf16_f32 v32, v32, v34
    v_lshlrev_b32 v33, 16, v32
    v_and_b32 v34, v9, v32
    v_add_f32 v43, v43, v33
    v_add_f32 v43, v43, v34
    v_lshlrev_b32 v32, 16, v109
    v_lshlrev_b32 v33, 16, v7
    v_and_b32 v34, v9, v109
    v_and_b32 v35, v9, v7
    v_mul_f32 v32, v32, v33
    v_mul_f32 v34, v34, v35
    v_cvt_pk_bf16_f32 v32, v32, v34
    v_lshlrev_b32 v33, 16, v32
    v_and_b32 v34, v9, v32
    v_add_f32 v43, v43, v33
    v_add_f32 v43, v43, v34
    v_lshlrev_b32 v32, 16, v110
    v_lshlrev_b32 v33, 16, v8
    v_and_b32 v34, v9, v110
    v_and_b32 v35, v9, v8
    v_mul_f32 v32, v32, v33
    v_mul_f32 v34, v34, v35
    v_cvt_pk_bf16_f32 v32, v32, v34
    v_lshlrev_b32 v33, 16, v32
    v_and_b32 v34, v9, v32
    v_add_f32 v43, v43, v33
    v_add_f32 v43, v43, v34
    s_nop 1
    v_add_f32 v44, v40, v40 row_ror:1
    v_add_f32 v45, v41, v41 row_ror:1
    v_add_f32 v46, v42, v42 row_ror:1
    v_add_f32 v47, v43, v43 row_ror:1
    v_mov_b32 v40, v44
    v_mov_b32 v41, v45
    v_mov_b32 v42, v46
    v_mov_b32 v43, v47
    s_nop 1
    v_add_f32 v44, v40, v40 row_ror:2
    v_add_f32 v45, v41, v41 row_ror:2
    v_add_f32 v46, v42, v42 row_ror:2
    v_add_f32 v47, v43, v43 row_ror:2
    v_mov_b32 v40, v44
    v_mov_b32 v41, v45
    v_mov_b32 v42, v46
    v_mov_b32 v43, v47
    s_nop 1
    v_add_f32 v44, v40, v40 row_ror:4
    v_add_f32 v45, v41, v41 row_ror:4
    v_add_f32 v46, v42, v42 row_ror:4
    v_add_f32 v47, v43, v43 row_ror:4
    v_mov_b32 v40, v44
    v_mov_b32 v41, v45
    v_mov_b32 v42, v46
    v_mov_b32 v43, v47
    s_nop 1
    v_add_f32 v44, v40, v40 row_ror:8
    v_add_f32 v45, v41, v41 row_ror:8
    v_add_f32 v46, v42, v42 row_ror:8
    v_add_f32 v47, v43, v43 row_ror:8
    v_mov_b32 v40, v44
    v_mov_b32 v41, v45
    v_mov_b32 v42, v46
    v_mov_b32 v43, v47
    s_nop 1
    v_permlane16_swap_b32 v40, v44
    v_permlane16_swap_b32 v41, v45
    v_permlane16_swap_b32 v42, v46
    v_permlane16_swap_b32 v43, v47
    v_add_f32 v40, v40, v44
    v_add_f32 v41, v41, v45
    v_add_f32 v42, v42, v46
    v_add_f32 v43, v43, v47
    v_mov_b32 v44, v40
    v_mov_b32 v45, v41
    v_mov_b32 v46, v42
    v_mov_b32 v47, v43
    s_nop 1
    v_permlane32_swap_b32 v40, v44
    v_permlane32_swap_b32 v41, v45
    v_permlane32_swap_b32 v42, v46
    v_permlane32_swap_b32 v43, v47
    v_add_f32 v40, v40, v44
    v_add_f32 v41, v41, v45
    v_add_f32 v42, v42, v46
    v_add_f32 v43, v43, v47
    v_cvt_pk_bf16_f32 v40, v40, v40
    v_lshlrev_b32 v40, 16, v40
    v_mul_f32 v40, 0xbfb8aa3b, v40
    v_cvt_pk_bf16_f32 v41, v41, v41
    v_lshlrev_b32 v41, 16, v41
    v_mul_f32 v41, 0xbfb8aa3b, v41
    v_cvt_pk_bf16_f32 v42, v42, v42
    v_lshlrev_b32 v42, 16, v42
    v_mul_f32 v42, 0xbfb8aa3b, v42
    v_cvt_pk_bf16_f32 v43, v43, v43
    v_lshlrev_b32 v43, 16, v43
    v_mul_f32 v43, 0xbfb8aa3b, v43
    v_exp_f32 v40, v40
    v_exp_f32 v41, v41
    v_exp_f32 v42, v42
    v_exp_f32 v43, v43
    s_nop 0
    v_add_f32 v40, 1.0, v40
    v_add_f32 v41, 1.0, v41
    v_add_f32 v42, 1.0, v42
    v_add_f32 v43, 1.0, v43
    v_rcp_f32 v40, v40
    v_rcp_f32 v41, v41
    v_rcp_f32 v42, v42
    v_rcp_f32 v43, v43
    s_nop 0
    v_cvt_pk_bf16_f32 v52, v40, v40
    v_lshlrev_b32 v52, 16, v52
    v_cvt_pk_bf16_f32 v53, v41, v41
    v_lshlrev_b32 v53, 16, v53
    v_cvt_pk_bf16_f32 v54, v42, v42
    v_lshlrev_b32 v54, 16, v54
    v_cvt_pk_bf16_f32 v55, v43, v43
    v_lshlrev_b32 v55, 16, v55
    v_mov_b32 v40, 0
    v_lshlrev_b32 v32, 16, v112
    v_lshlrev_b32 v33, 16, v4
    v_and_b32 v34, v9, v112
    v_and_b32 v35, v9, v4
    v_mul_f32 v32, v32, v33
    v_mul_f32 v34, v34, v35
    v_cvt_pk_bf16_f32 v32, v32, v34
    v_lshlrev_b32 v33, 16, v32
    v_and_b32 v34, v9, v32
    v_add_f32 v40, v40, v33
    v_add_f32 v40, v40, v34
    v_lshlrev_b32 v32, 16, v113
    v_lshlrev_b32 v33, 16, v5
    v_and_b32 v34, v9, v113
    v_and_b32 v35, v9, v5
    v_mul_f32 v32, v32, v33
    v_mul_f32 v34, v34, v35
    v_cvt_pk_bf16_f32 v32, v32, v34
    v_lshlrev_b32 v33, 16, v32
    v_and_b32 v34, v9, v32
    v_add_f32 v40, v40, v33
    v_add_f32 v40, v40, v34
    v_lshlrev_b32 v32, 16, v114
    v_lshlrev_b32 v33, 16, v6
    v_and_b32 v34, v9, v114
    v_and_b32 v35, v9, v6
    v_mul_f32 v32, v32, v33
    v_mul_f32 v34, v34, v35
    v_cvt_pk_bf16_f32 v32, v32, v34
    v_lshlrev_b32 v33, 16, v32
    v_and_b32 v34, v9, v32
    v_add_f32 v40, v40, v33
    v_add_f32 v40, v40, v34
    v_lshlrev_b32 v32, 16, v115
    v_lshlrev_b32 v33, 16, v7
    v_and_b32 v34, v9, v115
    v_and_b32 v35, v9, v7
    v_mul_f32 v32, v32, v33
    v_mul_f32 v34, v34, v35
    v_cvt_pk_bf16_f32 v32, v32, v34
    v_lshlrev_b32 v33, 16, v32
    v_and_b32 v34, v9, v32
    v_add_f32 v40, v40, v33
    v_add_f32 v40, v40, v34
    v_lshlrev_b32 v32, 16, v116
    v_lshlrev_b32 v33, 16, v8
    v_and_b32 v34, v9, v116
    v_and_b32 v35, v9, v8
    v_mul_f32 v32, v32, v33
    v_mul_f32 v34, v34, v35
    v_cvt_pk_bf16_f32 v32, v32, v34
    v_lshlrev_b32 v33, 16, v32
    v_and_b32 v34, v9, v32
    v_add_f32 v40, v40, v33
    v_add_f32 v40, v40, v34
    v_mov_b32 v41, 0
    v_lshlrev_b32 v32, 16, v118
    v_lshlrev_b32 v33, 16, v4
    v_and_b32 v34, v9, v118
    v_and_b32 v35, v9, v4
    v_mul_f32 v32, v32, v33
    v_mul_f32 v34, v34, v35
    v_cvt_pk_bf16_f32 v32, v32, v34
    v_lshlrev_b32 v33, 16, v32
    v_and_b32 v34, v9, v32
    v_add_f32 v41, v41, v33
    v_add_f32 v41, v41, v34
    v_lshlrev_b32 v32, 16, v119
    v_lshlrev_b32 v33, 16, v5
    v_and_b32 v34, v9, v119
    v_and_b32 v35, v9, v5
    v_mul_f32 v32, v32, v33
    v_mul_f32 v34, v34, v35
    v_cvt_pk_bf16_f32 v32, v32, v34
    v_lshlrev_b32 v33, 16, v32
    v_and_b32 v34, v9, v32
    v_add_f32 v41, v41, v33
    v_add_f32 v41, v41, v34
    v_lshlrev_b32 v32, 16, v120
    v_lshlrev_b32 v33, 16, v6
    v_and_b32 v34, v9, v120
    v_and_b32 v35, v9, v6
    v_mul_f32 v32, v32, v33
    v_mul_f32 v34, v34, v35
    v_cvt_pk_bf16_f32 v32, v32, v34
    v_lshlrev_b32 v33, 16, v32
    v_and_b32 v34, v9, v32
    v_add_f32 v41, v41, v33
    v_add_f32 v41, v41, v34
    v_lshlrev_b32 v32, 16, v121
    v_lshlrev_b32 v33, 16, v7
    v_and_b32 v34, v9, v121
    v_and_b32 v35, v9, v7
    v_mul_f32 v32, v32, v33
    v_mul_f32 v34, v34, v35
    v_cvt_pk_bf16_f32 v32, v32, v34
    v_lshlrev_b32 v33, 16, v32
    v_and_b32 v34, v9, v32
    v_add_f32 v41, v41, v33
    v_add_f32 v41, v41, v34
    v_lshlrev_b32 v32, 16, v122
    v_lshlrev_b32 v33, 16, v8
    v_and_b32 v34, v9, v122
    v_and_b32 v35, v9, v8
    v_mul_f32 v32, v32, v33
    v_mul_f32 v34, v34, v35
    v_cvt_pk_bf16_f32 v32, v32, v34
    v_lshlrev_b32 v33, 16, v32
    v_and_b32 v34, v9, v32
    v_add_f32 v41, v41, v33
    v_add_f32 v41, v41, v34
    v_mov_b32 v42, 0
    v_lshlrev_b32 v32, 16, v124
    v_lshlrev_b32 v33, 16, v4
    v_and_b32 v34, v9, v124
    v_and_b32 v35, v9, v4
    v_mul_f32 v32, v32, v33
    v_mul_f32 v34, v34, v35
    v_cvt_pk_bf16_f32 v32, v32, v34
    v_lshlrev_b32 v33, 16, v32
    v_and_b32 v34, v9, v32
    v_add_f32 v42, v42, v33
    v_add_f32 v42, v42, v34
    v_lshlrev_b32 v32, 16, v125
    v_lshlrev_b32 v33, 16, v5
    v_and_b32 v34, v9, v125
    v_and_b32 v35, v9, v5
    v_mul_f32 v32, v32, v33
    v_mul_f32 v34, v34, v35
    v_cvt_pk_bf16_f32 v32, v32, v34
    v_lshlrev_b32 v33, 16, v32
    v_and_b32 v34, v9, v32
    v_add_f32 v42, v42, v33
    v_add_f32 v42, v42, v34
    v_lshlrev_b32 v32, 16, v126
    v_lshlrev_b32 v33, 16, v6
    v_and_b32 v34, v9, v126
    v_and_b32 v35, v9, v6
    v_mul_f32 v32, v32, v33
    v_mul_f32 v34, v34, v35
    v_cvt_pk_bf16_f32 v32, v32, v34
    v_lshlrev_b32 v33, 16, v32
    v_and_b32 v34, v9, v32
    v_add_f32 v42, v42, v33
    v_add_f32 v42, v42, v34
    v_lshlrev_b32 v32, 16, v127
    v_lshlrev_b32 v33, 16, v7
    v_and_b32 v34, v9, v127
    v_and_b32 v35, v9, v7
    v_mul_f32 v32, v32, v33
    v_mul_f32 v34, v34, v35
    v_cvt_pk_bf16_f32 v32, v32, v34
    v_lshlrev_b32 v33, 16, v32
    v_and_b32 v34, v9, v32
    v_add_f32 v42, v42, v33
    v_add_f32 v42, v42, v34
    v_lshlrev_b32 v32, 16, v128
    v_lshlrev_b32 v33, 16, v8
    v_and_b32 v34, v9, v128
    v_and_b32 v35, v9, v8
    v_mul_f32 v32, v32, v33
    v_mul_f32 v34, v34, v35
    v_cvt_pk_bf16_f32 v32, v32, v34
    v_lshlrev_b32 v33, 16, v32
    v_and_b32 v34, v9, v32
    v_add_f32 v42, v42, v33
    v_add_f32 v42, v42, v34
    v_mov_b32 v43, 0
    v_lshlrev_b32 v32, 16, v130
    v_lshlrev_b32 v33, 16, v4
    v_and_b32 v34, v9, v130
    v_and_b32 v35, v9, v4
    v_mul_f32 v32, v32, v33
    v_mul_f32 v34, v34, v35
    v_cvt_pk_bf16_f32 v32, v32, v34
    v_lshlrev_b32 v33, 16, v32
    v_and_b32 v34, v9, v32
    v_add_f32 v43, v43, v33
    v_add_f32 v43, v43, v34
    v_lshlrev_b32 v32, 16, v131
    v_lshlrev_b32 v33, 16, v5
    v_and_b32 v34, v9, v131
    v_and_b32 v35, v9, v5
    v_mul_f32 v32, v32, v33
    v_mul_f32 v34, v34, v35
    v_cvt_pk_bf16_f32 v32, v32, v34
    v_lshlrev_b32 v33, 16, v32
    v_and_b32 v34, v9, v32
    v_add_f32 v43, v43, v33
    v_add_f32 v43, v43, v34
    v_lshlrev_b32 v32, 16, v132
    v_lshlrev_b32 v33, 16, v6
    v_and_b32 v34, v9, v132
    v_and_b32 v35, v9, v6
    v_mul_f32 v32, v32, v33
    v_mul_f32 v34, v34, v35
    v_cvt_pk_bf16_f32 v32, v32, v34
    v_lshlrev_b32 v33, 16, v32
    v_and_b32 v34, v9, v32
    v_add_f32 v43, v43, v33
    v_add_f32 v43, v43, v34
    v_lshlrev_b32 v32, 16, v133
    v_lshlrev_b32 v33, 16, v7
    v_and_b32 v34, v9, v133
    v_and_b32 v35, v9, v7
    v_mul_f32 v32, v32, v33
    v_mul_f32 v34, v34, v35
    v_cvt_pk_bf16_f32 v32, v32, v34
    v_lshlrev_b32 v33, 16, v32
    v_and_b32 v34, v9, v32
    v_add_f32 v43, v43, v33
    v_add_f32 v43, v43, v34
    v_lshlrev_b32 v32, 16, v134
    v_lshlrev_b32 v33, 16, v8
    v_and_b32 v34, v9, v134
    v_and_b32 v35, v9, v8
    v_mul_f32 v32, v32, v33
    v_mul_f32 v34, v34, v35
    v_cvt_pk_bf16_f32 v32, v32, v34
    v_lshlrev_b32 v33, 16, v32
    v_and_b32 v34, v9, v32
    v_add_f32 v43, v43, v33
    v_add_f32 v43, v43, v34
    s_nop 1
    v_add_f32 v44, v40, v40 row_ror:1
    v_add_f32 v45, v41, v41 row_ror:1
    v_add_f32 v46, v42, v42 row_ror:1
    v_add_f32 v47, v43, v43 row_ror:1
    v_mov_b32 v40, v44
    v_mov_b32 v41, v45
    v_mov_b32 v42, v46
    v_mov_b32 v43, v47
    s_nop 1
    v_add_f32 v44, v40, v40 row_ror:2
    v_add_f32 v45, v41, v41 row_ror:2
    v_add_f32 v46, v42, v42 row_ror:2
    v_add_f32 v47, v43, v43 row_ror:2
    v_mov_b32 v40, v44
    v_mov_b32 v41, v45
    v_mov_b32 v42, v46
    v_mov_b32 v43, v47
    s_nop 1
    v_add_f32 v44, v40, v40 row_ror:4
    v_add_f32 v45, v41, v41 row_ror:4
    v_add_f32 v46, v42, v42 row_ror:4
    v_add_f32 v47, v43, v43 row_ror:4
    v_mov_b32 v40, v44
    v_mov_b32 v41, v45
    v_mov_b32 v42, v46
    v_mov_b32 v43, v47
    s_nop 1
    v_add_f32 v44, v40, v40 row_ror:8
    v_add_f32 v45, v41, v41 row_ror:8
    v_add_f32 v46, v42, v42 row_ror:8
    v_add_f32 v47, v43, v43 row_ror:8
    v_mov_b32 v40, v44
    v_mov_b32 v41, v45
    v_mov_b32 v42, v46
    v_mov_b32 v43, v47
    s_nop 1
    v_permlane16_swap_b32 v40, v44
    v_permlane16_swap_b32 v41, v45
    v_permlane16_swap_b32 v42, v46
    v_permlane16_swap_b32 v43, v47
    v_add_f32 v40, v40, v44
    v_add_f32 v41, v41, v45
    v_add_f32 v42, v42, v46
    v_add_f32 v43, v43, v47
    v_mov_b32 v44, v40
    v_mov_b32 v45, v41
    v_mov_b32 v46, v42
    v_mov_b32 v47, v43
    s_nop 1
    v_permlane32_swap_b32 v40, v44
    v_permlane32_swap_b32 v41, v45
    v_permlane32_swap_b32 v42, v46
    v_permlane32_swap_b32 v43, v47
    v_add_f32 v40, v40, v44
    v_add_f32 v41, v41, v45
    v_add_f32 v42, v42, v46
    v_add_f32 v43, v43, v47
    v_cvt_pk_bf16_f32 v40, v40, v40
    v_lshlrev_b32 v40, 16, v40
    v_mul_f32 v40, 0xbfb8aa3b, v40
    v_cvt_pk_bf16_f32 v41, v41, v41
    v_lshlrev_b32 v41, 16, v41
    v_mul_f32 v41, 0xbfb8aa3b, v41
    v_cvt_pk_bf16_f32 v42, v42, v42
    v_lshlrev_b32 v42, 16, v42
    v_mul_f32 v42, 0xbfb8aa3b, v42
    v_cvt_pk_bf16_f32 v43, v43, v43
    v_lshlrev_b32 v43, 16, v43
    v_mul_f32 v43, 0xbfb8aa3b, v43
    v_exp_f32 v40, v40
    v_exp_f32 v41, v41
    v_exp_f32 v42, v42
    v_exp_f32 v43, v43
    s_nop 0
    v_add_f32 v40, 1.0, v40
    v_add_f32 v41, 1.0, v41
    v_add_f32 v42, 1.0, v42
    v_add_f32 v43, 1.0, v43
    v_rcp_f32 v40, v40
    v_rcp_f32 v41, v41
    v_rcp_f32 v42, v42
    v_rcp_f32 v43, v43
    s_nop 0
    v_cvt_pk_bf16_f32 v56, v40, v40
    v_lshlrev_b32 v56, 16, v56
    v_cvt_pk_bf16_f32 v57, v41, v41
    v_lshlrev_b32 v57, 16, v57
    v_cvt_pk_bf16_f32 v58, v42, v42
    v_lshlrev_b32 v58, 16, v58
    v_cvt_pk_bf16_f32 v59, v43, v43
    v_lshlrev_b32 v59, 16, v59
    v_mov_b32 v40, 0
    v_lshlrev_b32 v32, 16, v136
    v_lshlrev_b32 v33, 16, v4
    v_and_b32 v34, v9, v136
    v_and_b32 v35, v9, v4
    v_mul_f32 v32, v32, v33
    v_mul_f32 v34, v34, v35
    v_cvt_pk_bf16_f32 v32, v32, v34
    v_lshlrev_b32 v33, 16, v32
    v_and_b32 v34, v9, v32
    v_add_f32 v40, v40, v33
    v_add_f32 v40, v40, v34
    v_lshlrev_b32 v32, 16, v137
    v_lshlrev_b32 v33, 16, v5
    v_and_b32 v34, v9, v137
    v_and_b32 v35, v9, v5
    v_mul_f32 v32, v32, v33
    v_mul_f32 v34, v34, v35
    v_cvt_pk_bf16_f32 v32, v32, v34
    v_lshlrev_b32 v33, 16, v32
    v_and_b32 v34, v9, v32
    v_add_f32 v40, v40, v33
    v_add_f32 v40, v40, v34
    v_lshlrev_b32 v32, 16, v138
    v_lshlrev_b32 v33, 16, v6
    v_and_b32 v34, v9, v138
    v_and_b32 v35, v9, v6
    v_mul_f32 v32, v32, v33
    v_mul_f32 v34, v34, v35
    v_cvt_pk_bf16_f32 v32, v32, v34
    v_lshlrev_b32 v33, 16, v32
    v_and_b32 v34, v9, v32
    v_add_f32 v40, v40, v33
    v_add_f32 v40, v40, v34
    v_lshlrev_b32 v32, 16, v139
    v_lshlrev_b32 v33, 16, v7
    v_and_b32 v34, v9, v139
    v_and_b32 v35, v9, v7
    v_mul_f32 v32, v32, v33
    v_mul_f32 v34, v34, v35
    v_cvt_pk_bf16_f32 v32, v32, v34
    v_lshlrev_b32 v33, 16, v32
    v_and_b32 v34, v9, v32
    v_add_f32 v40, v40, v33
    v_add_f32 v40, v40, v34
    v_lshlrev_b32 v32, 16, v140
    v_lshlrev_b32 v33, 16, v8
    v_and_b32 v34, v9, v140
    v_and_b32 v35, v9, v8
    v_mul_f32 v32, v32, v33
    v_mul_f32 v34, v34, v35
    v_cvt_pk_bf16_f32 v32, v32, v34
    v_lshlrev_b32 v33, 16, v32
    v_and_b32 v34, v9, v32
    v_add_f32 v40, v40, v33
    v_add_f32 v40, v40, v34
    v_mov_b32 v41, 0
    v_lshlrev_b32 v32, 16, v142
    v_lshlrev_b32 v33, 16, v4
    v_and_b32 v34, v9, v142
    v_and_b32 v35, v9, v4
    v_mul_f32 v32, v32, v33
    v_mul_f32 v34, v34, v35
    v_cvt_pk_bf16_f32 v32, v32, v34
    v_lshlrev_b32 v33, 16, v32
    v_and_b32 v34, v9, v32
    v_add_f32 v41, v41, v33
    v_add_f32 v41, v41, v34
    v_lshlrev_b32 v32, 16, v143
    v_lshlrev_b32 v33, 16, v5
    v_and_b32 v34, v9, v143
    v_and_b32 v35, v9, v5
    v_mul_f32 v32, v32, v33
    v_mul_f32 v34, v34, v35
    v_cvt_pk_bf16_f32 v32, v32, v34
    v_lshlrev_b32 v33, 16, v32
    v_and_b32 v34, v9, v32
    v_add_f32 v41, v41, v33
    v_add_f32 v41, v41, v34
    v_lshlrev_b32 v32, 16, v144
    v_lshlrev_b32 v33, 16, v6
    v_and_b32 v34, v9, v144
    v_and_b32 v35, v9, v6
    v_mul_f32 v32, v32, v33
    v_mul_f32 v34, v34, v35
    v_cvt_pk_bf16_f32 v32, v32, v34
    v_lshlrev_b32 v33, 16, v32
    v_and_b32 v34, v9, v32
    v_add_f32 v41, v41, v33
    v_add_f32 v41, v41, v34
    v_lshlrev_b32 v32, 16, v145
    v_lshlrev_b32 v33, 16, v7
    v_and_b32 v34, v9, v145
    v_and_b32 v35, v9, v7
    v_mul_f32 v32, v32, v33
    v_mul_f32 v34, v34, v35
    v_cvt_pk_bf16_f32 v32, v32, v34
    v_lshlrev_b32 v33, 16, v32
    v_and_b32 v34, v9, v32
    v_add_f32 v41, v41, v33
    v_add_f32 v41, v41, v34
    v_lshlrev_b32 v32, 16, v146
    v_lshlrev_b32 v33, 16, v8
    v_and_b32 v34, v9, v146
    v_and_b32 v35, v9, v8
    v_mul_f32 v32, v32, v33
    v_mul_f32 v34, v34, v35
    v_cvt_pk_bf16_f32 v32, v32, v34
    v_lshlrev_b32 v33, 16, v32
    v_and_b32 v34, v9, v32
    v_add_f32 v41, v41, v33
    v_add_f32 v41, v41, v34
    v_mov_b32 v42, 0
    v_lshlrev_b32 v32, 16, v148
    v_lshlrev_b32 v33, 16, v4
    v_and_b32 v34, v9, v148
    v_and_b32 v35, v9, v4
    v_mul_f32 v32, v32, v33
    v_mul_f32 v34, v34, v35
    v_cvt_pk_bf16_f32 v32, v32, v34
    v_lshlrev_b32 v33, 16, v32
    v_and_b32 v34, v9, v32
    v_add_f32 v42, v42, v33
    v_add_f32 v42, v42, v34
    v_lshlrev_b32 v32, 16, v149
    v_lshlrev_b32 v33, 16, v5
    v_and_b32 v34, v9, v149
    v_and_b32 v35, v9, v5
    v_mul_f32 v32, v32, v33
    v_mul_f32 v34, v34, v35
    v_cvt_pk_bf16_f32 v32, v32, v34
    v_lshlrev_b32 v33, 16, v32
    v_and_b32 v34, v9, v32
    v_add_f32 v42, v42, v33
    v_add_f32 v42, v42, v34
    v_lshlrev_b32 v32, 16, v150
    v_lshlrev_b32 v33, 16, v6
    v_and_b32 v34, v9, v150
    v_and_b32 v35, v9, v6
    v_mul_f32 v32, v32, v33
    v_mul_f32 v34, v34, v35
    v_cvt_pk_bf16_f32 v32, v32, v34
    v_lshlrev_b32 v33, 16, v32
    v_and_b32 v34, v9, v32
    v_add_f32 v42, v42, v33
    v_add_f32 v42, v42, v34
    v_lshlrev_b32 v32, 16, v151
    v_lshlrev_b32 v33, 16, v7
    v_and_b32 v34, v9, v151
    v_and_b32 v35, v9, v7
    v_mul_f32 v32, v32, v33
    v_mul_f32 v34, v34, v35
    v_cvt_pk_bf16_f32 v32, v32, v34
    v_lshlrev_b32 v33, 16, v32
    v_and_b32 v34, v9, v32
    v_add_f32 v42, v42, v33
    v_add_f32 v42, v42, v34
    v_lshlrev_b32 v32, 16, v152
    v_lshlrev_b32 v33, 16, v8
    v_and_b32 v34, v9, v152
    v_and_b32 v35, v9, v8
    v_mul_f32 v32, v32, v33
    v_mul_f32 v34, v34, v35
    v_cvt_pk_bf16_f32 v32, v32, v34
    v_lshlrev_b32 v33, 16, v32
    v_and_b32 v34, v9, v32
    v_add_f32 v42, v42, v33
    v_add_f32 v42, v42, v34
    v_mov_b32 v43, 0
    v_lshlrev_b32 v32, 16, v154
    v_lshlrev_b32 v33, 16, v4
    v_and_b32 v34, v9, v154
    v_and_b32 v35, v9, v4
    v_mul_f32 v32, v32, v33
    v_mul_f32 v34, v34, v35
    v_cvt_pk_bf16_f32 v32, v32, v34
    v_lshlrev_b32 v33, 16, v32
    v_and_b32 v34, v9, v32
    v_add_f32 v43, v43, v33
    v_add_f32 v43, v43, v34
    v_lshlrev_b32 v32, 16, v155
    v_lshlrev_b32 v33, 16, v5
    v_and_b32 v34, v9, v155
    v_and_b32 v35, v9, v5
    v_mul_f32 v32, v32, v33
    v_mul_f32 v34, v34, v35
    v_cvt_pk_bf16_f32 v32, v32, v34
    v_lshlrev_b32 v33, 16, v32
    v_and_b32 v34, v9, v32
    v_add_f32 v43, v43, v33
    v_add_f32 v43, v43, v34
    v_lshlrev_b32 v32, 16, v156
    v_lshlrev_b32 v33, 16, v6
    v_and_b32 v34, v9, v156
    v_and_b32 v35, v9, v6
    v_mul_f32 v32, v32, v33
    v_mul_f32 v34, v34, v35
    v_cvt_pk_bf16_f32 v32, v32, v34
    v_lshlrev_b32 v33, 16, v32
    v_and_b32 v34, v9, v32
    v_add_f32 v43, v43, v33
    v_add_f32 v43, v43, v34
    v_lshlrev_b32 v32, 16, v157
    v_lshlrev_b32 v33, 16, v7
    v_and_b32 v34, v9, v157
    v_and_b32 v35, v9, v7
    v_mul_f32 v32, v32, v33
    v_mul_f32 v34, v34, v35
    v_cvt_pk_bf16_f32 v32, v32, v34
    v_lshlrev_b32 v33, 16, v32
    v_and_b32 v34, v9, v32
    v_add_f32 v43, v43, v33
    v_add_f32 v43, v43, v34
    v_lshlrev_b32 v32, 16, v158
    v_lshlrev_b32 v33, 16, v8
    v_and_b32 v34, v9, v158
    v_and_b32 v35, v9, v8
    v_mul_f32 v32, v32, v33
    v_mul_f32 v34, v34, v35
    v_cvt_pk_bf16_f32 v32, v32, v34
    v_lshlrev_b32 v33, 16, v32
    v_and_b32 v34, v9, v32
    v_add_f32 v43, v43, v33
    v_add_f32 v43, v43, v34
    s_nop 1
    v_add_f32 v44, v40, v40 row_ror:1
    v_add_f32 v45, v41, v41 row_ror:1
    v_add_f32 v46, v42, v42 row_ror:1
    v_add_f32 v47, v43, v43 row_ror:1
    v_mov_b32 v40, v44
    v_mov_b32 v41, v45
    v_mov_b32 v42, v46
    v_mov_b32 v43, v47
    s_nop 1
    v_add_f32 v44, v40, v40 row_ror:2
    v_add_f32 v45, v41, v41 row_ror:2
    v_add_f32 v46, v42, v42 row_ror:2
    v_add_f32 v47, v43, v43 row_ror:2
    v_mov_b32 v40, v44
    v_mov_b32 v41, v45
    v_mov_b32 v42, v46
    v_mov_b32 v43, v47
    s_nop 1
    v_add_f32 v44, v40, v40 row_ror:4
    v_add_f32 v45, v41, v41 row_ror:4
    v_add_f32 v46, v42, v42 row_ror:4
    v_add_f32 v47, v43, v43 row_ror:4
    v_mov_b32 v40, v44
    v_mov_b32 v41, v45
    v_mov_b32 v42, v46
    v_mov_b32 v43, v47
    s_nop 1
    v_add_f32 v44, v40, v40 row_ror:8
    v_add_f32 v45, v41, v41 row_ror:8
    v_add_f32 v46, v42, v42 row_ror:8
    v_add_f32 v47, v43, v43 row_ror:8
    v_mov_b32 v40, v44
    v_mov_b32 v41, v45
    v_mov_b32 v42, v46
    v_mov_b32 v43, v47
    s_nop 1
    v_permlane16_swap_b32 v40, v44
    v_permlane16_swap_b32 v41, v45
    v_permlane16_swap_b32 v42, v46
    v_permlane16_swap_b32 v43, v47
    v_add_f32 v40, v40, v44
    v_add_f32 v41, v41, v45
    v_add_f32 v42, v42, v46
    v_add_f32 v43, v43, v47
    v_mov_b32 v44, v40
    v_mov_b32 v45, v41
    v_mov_b32 v46, v42
    v_mov_b32 v47, v43
    s_nop 1
    v_permlane32_swap_b32 v40, v44
    v_permlane32_swap_b32 v41, v45
    v_permlane32_swap_b32 v42, v46
    v_permlane32_swap_b32 v43, v47
    v_add_f32 v40, v40, v44
    v_add_f32 v41, v41, v45
    v_add_f32 v42, v42, v46
    v_add_f32 v43, v43, v47
    v_cvt_pk_bf16_f32 v40, v40, v40
    v_lshlrev_b32 v40, 16, v40
    v_mul_f32 v40, 0xbfb8aa3b, v40
    v_cvt_pk_bf16_f32 v41, v41, v41
    v_lshlrev_b32 v41, 16, v41
    v_mul_f32 v41, 0xbfb8aa3b, v41
    v_cvt_pk_bf16_f32 v42, v42, v42
    v_lshlrev_b32 v42, 16, v42
    v_mul_f32 v42, 0xbfb8aa3b, v42
    v_cvt_pk_bf16_f32 v43, v43, v43
    v_lshlrev_b32 v43, 16, v43
    v_mul_f32 v43, 0xbfb8aa3b, v43
    v_exp_f32 v40, v40
    v_exp_f32 v41, v41
    v_exp_f32 v42, v42
    v_exp_f32 v43, v43
    s_nop 0
    v_add_f32 v40, 1.0, v40
    v_add_f32 v41, 1.0, v41
    v_add_f32 v42, 1.0, v42
    v_add_f32 v43, 1.0, v43
    v_rcp_f32 v40, v40
    v_rcp_f32 v41, v41
    v_rcp_f32 v42, v42
    v_rcp_f32 v43, v43
    s_nop 0
    v_cvt_pk_bf16_f32 v60, v40, v40
    v_lshlrev_b32 v60, 16, v60
    v_cvt_pk_bf16_f32 v61, v41, v41
    v_lshlrev_b32 v61, 16, v61
    v_cvt_pk_bf16_f32 v62, v42, v42
    v_lshlrev_b32 v62, 16, v62
    v_cvt_pk_bf16_f32 v63, v43, v43
    v_lshlrev_b32 v63, 16, v63
    s_mov_b64 exec, 1
    buffer_store_dwordx4 v[48:51], v2, s[8:11], s25 offen offset:0 sc1
    buffer_store_dwordx4 v[52:55], v2, s[8:11], s25 offen offset:16 sc1
    buffer_store_dwordx4 v[56:59], v2, s[8:11], s25 offen offset:32 sc1
    buffer_store_dwordx4 v[60:63], v2, s[8:11], s25 offen offset:48 sc1
    s_mov_b64 exec, -1
    s_branch L_ch_hend
L_ch_hq:
    s_sub_u32 s17, s17, 148
    s_cmp_ge_u32 s17, 128
    s_cbranch_scc1 L_ch_hpr
    s_lshr_b32 s18, s17, 4
    s_and_b32 s20, s17, 7
    s_and_b32 s21, s17, 8
    s_lshl_b32 s55, s18, 3
    s_add_u32 s55, s55, s20
    s_lshl_b32 s55, s55, 2
    s_lshl_b32 s19, s21, 5
    s_add_u32 s55, s55, s19
    s_add_u32 s55, s55, 120595968
    s_mov_b32 s19, 0
    s_lshl_b32 s29, s20, 4
    s_mov_b32 s28, 16
    s_cmp_eq_u32 s21, 0
    s_cbranch_scc1 L_ch_hgo
    s_mov_b32 s19, 3
    s_mul_i32 s29, s20, 7
    s_mov_b32 s28, 14
    s_cmp_lt_u32 s20, 6
    s_cbranch_scc1 L_ch_hgo
    s_mov_b32 s28, 12
    s_cmp_eq_u32 s20, 6
    s_cselect_b32 s29, 42, 48
L_ch_hgo:
    s_load_dwordx2 s[6:7], s[0:1], 0
    s_load_dwordx2 s[44:45], s[0:1], 16
    s_load_dwordx2 s[46:47], s[0:1], 24
    s_load_dwordx2 s[48:49], s[0:1], 32
    s_load_dwordx2 s[50:51], s[0:1], 64
    s_load_dwordx2 s[52:53], s[0:1], 72
    s_waitcnt lgkmcnt(0)
    s_mov_b32 s12, s6
    s_mov_b32 s13, s7
    s_mov_b32 s14, 2621440
    s_mov_b32 s15, 0x00020000
    v_and_b32 v1, 15, v0
    v_lshrrev_b32 v2, 4, v0
    v_lshlrev_b32 v8, 4, v0
    s_lshl_b32 s21, s18, 2
    s_add_u32 s21, s21, s16
    s_mul_i32 s22, s21, 81920
    v_mul_u32_u24 v3, 1280, v1
    v_lshlrev_b32 v4, 4, v2
    v_add_u32 v3, v3, v4
    s_add_u32 s23, s22, 0
    buffer_load_dwordx4 a[0:3], v3, s[12:15], s23 offen offset:0
    buffer_load_dwordx4 a[4:7], v3, s[12:15], s23 offen offset:64
    buffer_load_dwordx4 a[8:11], v3, s[12:15], s23 offen offset:128
    buffer_load_dwordx4 a[12:15], v3, s[12:15], s23 offen offset:192
    buffer_load_dwordx4 a[16:19], v3, s[12:15], s23 offen offset:256
    buffer_load_dwordx4 a[20:23], v3, s[12:15], s23 offen offset:320
    buffer_load_dwordx4 a[24:27], v3, s[12:15], s23 offen offset:384
    buffer_load_dwordx4 a[28:31], v3, s[12:15], s23 offen offset:448
    buffer_load_dwordx4 a[32:35], v3, s[12:15], s23 offen offset:512
    buffer_load_dwordx4 a[36:39], v3, s[12:15], s23 offen offset:576
    buffer_load_dwordx4 a[40:43], v3, s[12:15], s23 offen offset:640
    buffer_load_dwordx4 a[44:47], v3, s[12:15], s23 offen offset:704
    buffer_load_dwordx4 a[48:51], v3, s[12:15], s23 offen offset:768
    buffer_load_dwordx4 a[52:55], v3, s[12:15], s23 offen offset:832
    buffer_load_dwordx4 a[56:59], v3, s[12:15], s23 offen offset:896
    buffer_load_dwordx4 a[60:63], v3, s[12:15], s23 offen offset:960
    buffer_load_dwordx4 a[64:67], v3, s[12:15], s23 offen offset:1024
    buffer_load_dwordx4 a[68:71], v3, s[12:15], s23 offen offset:1088
    buffer_load_dwordx4 a[72:75], v3, s[12:15], s23 offen offset:1152
    buffer_load_dwordx4 a[76:79], v3, s[12:15], s23 offen offset:1216
    s_add_u32 s23, s22, 20480
    buffer_load_dwordx4 a[80:83], v3, s[12:15], s23 offen offset:0
    buffer_load_dwordx4 a[84:87], v3, s[12:15], s23 offen offset:64
    buffer_load_dwordx4 a[88:91], v3, s[12:15], s23 offen offset:128
    buffer_load_dwordx4 a[92:95], v3, s[12:15], s23 offen offset:192
    buffer_load_dwordx4 a[96:99], v3, s[12:15], s23 offen offset:256
    buffer_load_dwordx4 a[100:103], v3, s[12:15], s23 offen offset:320
    buffer_load_dwordx4 a[104:107], v3, s[12:15], s23 offen offset:384
    buffer_load_dwordx4 a[108:111], v3, s[12:15], s23 offen offset:448
    buffer_load_dwordx4 a[112:115], v3, s[12:15], s23 offen offset:512
    buffer_load_dwordx4 a[116:119], v3, s[12:15], s23 offen offset:576
    buffer_load_dwordx4 a[120:123], v3, s[12:15], s23 offen offset:640
    buffer_load_dwordx4 a[124:127], v3, s[12:15], s23 offen offset:704
    buffer_load_dwordx4 a[128:131], v3, s[12:15], s23 offen offset:768
    buffer_load_dwordx4 a[132:135], v3, s[12:15], s23 offen offset:832
    buffer_load_dwordx4 a[136:139], v3, s[12:15], s23 offen offset:896
    buffer_load_dwordx4 a[140:143], v3, s[12:15], s23 offen offset:960
    buffer_load_dwordx4 a[144:147], v3, s[12:15], s23 offen offset:1024
    buffer_load_dwordx4 a[148:151], v3, s[12:15], s23 offen offset:1088
    buffer_load_dwordx4 a[152:155], v3, s[12:15], s23 offen offset:1152
    buffer_load_dwordx4 a[156:159], v3, s[12:15], s23 offen offset:1216
    s_add_u32 s23, s22, 40960
    buffer_load_dwordx4 a[160:163], v3, s[12:15], s23 offen offset:0
    buffer_load_dwordx4 a[164:167], v3, s[12:15], s23 offen offset:64
    buffer_load_dwordx4 a[168:171], v3, s[12:15], s23 offen offset:128
    buffer_load_dwordx4 a[172:175], v3, s[12:15], s23 offen offset:192
    buffer_load_dwordx4 a[176:179], v3, s[12:15], s23 offen offset:256
    buffer_load_dwordx4 a[180:183], v3, s[12:15], s23 offen offset:320
    buffer_load_dwordx4 a[184:187], v3, s[12:15], s23 offen offset:384
    buffer_load_dwordx4 a[188:191], v3, s[12:15], s23 offen offset:448
    buffer_load_dwordx4 a[192:195], v3, s[12:15], s23 offen offset:512
    buffer_load_dwordx4 a[196:199], v3, s[12:15], s23 offen offset:576
    buffer_load_dwordx4 a[200:203], v3, s[12:15], s23 offen offset:640
    buffer_load_dwordx4 a[204:207], v3, s[12:15], s23 offen offset:704
    buffer_load_dwordx4 a[208:211], v3, s[12:15], s23 offen offset:768
    buffer_load_dwordx4 a[212:215], v3, s[12:15], s23 offen offset:832
    buffer_load_dwordx4 a[216:219], v3, s[12:15], s23 offen offset:896
    buffer_load_dwordx4 a[220:223], v3, s[12:15], s23 offen offset:960
    buffer_load_dwordx4 a[224:227], v3, s[12:15], s23 offen offset:1024
    buffer_load_dwordx4 a[228:231], v3, s[12:15], s23 offen offset:1088
    buffer_load_dwordx4 a[232:235], v3, s[12:15], s23 offen offset:1152
    buffer_load_dwordx4 a[236:239], v3, s[12:15], s23 offen offset:1216
    s_add_u32 s23, s22, 61440
    buffer_load_dwordx4 a[240:243], v3, s[12:15], s23 offen offset:0
    buffer_load_dwordx4 a[244:247], v3, s[12:15], s23 offen offset:64
    buffer_load_dwordx4 a[248:251], v3, s[12:15], s23 offen offset:128
    buffer_load_dwordx4 a[252:255], v3, s[12:15], s23 offen offset:192
    buffer_load_dwordx4 v[192:195], v3, s[12:15], s23 offen offset:256
    buffer_load_dwordx4 v[196:199], v3, s[12:15], s23 offen offset:320
    buffer_load_dwordx4 v[200:203], v3, s[12:15], s23 offen offset:384
    buffer_load_dwordx4 v[204:207], v3, s[12:15], s23 offen offset:448
    buffer_load_dwordx4 v[208:211], v3, s[12:15], s23 offen offset:512
    buffer_load_dwordx4 v[212:215], v3, s[12:15], s23 offen offset:576
    buffer_load_dwordx4 v[216:219], v3, s[12:15], s23 offen offset:640
    buffer_load_dwordx4 v[220:223], v3, s[12:15], s23 offen offset:704
    buffer_load_dwordx4 v[224:227], v3, s[12:15], s23 offen offset:768
    buffer_load_dwordx4 v[228:231], v3, s[12:15], s23 offen offset:832
    buffer_load_dwordx4 v[232:235], v3, s[12:15], s23 offen offset:896
    buffer_load_dwordx4 v[236:239], v3, s[12:15], s23 offen offset:960
    buffer_load_dwordx4 v[240:243], v3, s[12:15], s23 offen offset:1024
    buffer_load_dwordx4 v[244:247], v3, s[12:15], s23 offen offset:1088
    buffer_load_dwordx4 v[248:251], v3, s[12:15], s23 offen offset:1152
    buffer_load_dwordx4 v[252:255], v3, s[12:15], s23 offen offset:1216
    s_cmp_eq_u32 s19, 3
    s_cbranch_scc1 L_chh_ffnsetup
    s_mov_b64 s[56:57], s[44:45]
    s_cmp_eq_u32 s19, 1
    s_cselect_b64 s[56:57], s[46:47], s[56:57]
    s_cmp_eq_u32 s19, 2
    s_cselect_b64 s[56:57], s[48:49], s[56:57]
    s_mov_b64 s[60:61], s[56:57]
    s_mov_b32 s58, 5242880
    s_mov_b32 s43, 8192
    s_lshl_b32 s24, s29, 6
    s_add_u32 s25, s24, 64
    s_mov_b32 s27, 128
    s_branch L_chh_setup2
L_chh_ffnsetup:
    s_mov_b64 s[56:57], s[50:51]
    s_mov_b64 s[60:61], s[52:53]
    s_mov_b32 s58, 2211840
    s_mov_b32 s43, 3456
    s_lshl_b32 s24, s29, 6
    s_mov_b32 s25, s24
    s_mov_b32 s27, 64
L_chh_setup2:
    s_mov_b32 s59, 0x00020000
    s_lshl_b32 s44, s43, 4
    s_add_u32 s45, s44, 3072
    s_sub_u32 s44, s44, 1024
    s_mul_i32 s30, s16, 10240
    s_mul_i32 s31, s16, 160
    v_lshrrev_b32 v4, 2, v0
    v_add_u32 v4, s31, v4
    v_mul_lo_u32 v9, v4, s43
    v_lshrrev_b32 v4, 5, v0
    v_lshlrev_b32 v4, 1, v4
    v_and_b32 v5, 3, v0
    v_xor_b32 v4, v4, v5
    v_lshl_add_u32 v9, v4, 4, v9
    v_lshlrev_b32 v4, 3, v2
    v_lshrrev_b32 v5, 2, v1
    v_add_u32 v4, v4, v5
    v_lshlrev_b32 v4, 6, v4
    v_and_b32 v5, 3, v1
    v_lshl_add_u32 v4, v5, 3, v4
    v_and_b32 v5, 1, v2
    v_lshl_add_u32 v5, v5, 5, v4
    v_xor_b32 v6, 32, v5
    s_mov_b32 s34, 0
    s_mov_b32 s35, 40960
    s_mov_b32 s36, 81920
    s_add_u32 s31, s34, s30
    s_mov_b32 m0, s31
    s_mov_b32 s33, s24
    buffer_load_dwordx4 v9, s[56:59], s33 offen offset:0 lds
    s_add_u32 s33, s33, s44
    buffer_load_dwordx4 v9, s[56:59], s33 offen offset:1024 lds
    s_add_u32 s33, s33, s44
    buffer_load_dwordx4 v9, s[56:59], s33 offen offset:2048 lds
    s_add_u32 s33, s33, s44
    buffer_load_dwordx4 v9, s[56:59], s33 offen offset:3072 lds
    s_add_u32 s31, s31, 4096
    s_mov_b32 m0, s31
    s_add_u32 s33, s33, s45
    buffer_load_dwordx4 v9, s[56:59], s33 offen offset:0 lds
    s_add_u32 s33, s33, s44
    buffer_load_dwordx4 v9, s[56:59], s33 offen offset:1024 lds
    s_add_u32 s33, s33, s44
    buffer_load_dwordx4 v9, s[56:59], s33 offen offset:2048 lds
    s_add_u32 s33, s33, s44
    buffer_load_dwordx4 v9, s[56:59], s33 offen offset:3072 lds
    s_add_u32 s31, s31, 4096
    s_mov_b32 m0, s31
    s_add_u32 s33, s33, s45
    buffer_load_dwordx4 v9, s[56:59], s33 offen offset:0 lds
    s_add_u32 s33, s33, s44
    buffer_load_dwordx4 v9, s[56:59], s33 offen offset:1024 lds
    s_add_u32 s33, s24, s27
    s_mov_b32 s24, s25
    s_mov_b32 s25, s33
    s_mov_b64 s[46:47], s[56:57]
    s_mov_b64 s[56:57], s[60:61]
    s_mov_b64 s[60:61], s[46:47]
    s_add_u32 s31, s35, s30
    s_mov_b32 m0, s31
    s_mov_b32 s33, s24
    buffer_load_dwordx4 v9, s[56:59], s33 offen offset:0 lds
    s_add_u32 s33, s33, s44
    buffer_load_dwordx4 v9, s[56:59], s33 offen offset:1024 lds
    s_add_u32 s33, s33, s44
    buffer_load_dwordx4 v9, s[56:59], s33 offen offset:2048 lds
    s_add_u32 s33, s33, s44
    buffer_load_dwordx4 v9, s[56:59], s33 offen offset:3072 lds
    s_add_u32 s31, s31, 4096
    s_mov_b32 m0, s31
    s_add_u32 s33, s33, s45
    buffer_load_dwordx4 v9, s[56:59], s33 offen offset:0 lds
    s_add_u32 s33, s33, s44
    buffer_load_dwordx4 v9, s[56:59], s33 offen offset:1024 lds
    s_add_u32 s33, s33, s44
    buffer_load_dwordx4 v9, s[56:59], s33 offen offset:2048 lds
    s_add_u32 s33, s33, s44
    buffer_load_dwordx4 v9, s[56:59], s33 offen offset:3072 lds
    s_add_u32 s31, s31, 4096
    s_mov_b32 m0, s31
    s_add_u32 s33, s33, s45
    buffer_load_dwordx4 v9, s[56:59], s33 offen offset:0 lds
    s_add_u32 s33, s33, s44
    buffer_load_dwordx4 v9, s[56:59], s33 offen offset:1024 lds
    s_add_u32 s33, s24, s27
    s_mov_b32 s24, s25
    s_mov_b32 s25, s33
    s_mov_b64 s[46:47], s[56:57]
    s_mov_b64 s[56:57], s[60:61]
    s_mov_b64 s[60:61], s[46:47]
    s_add_u32 s31, s36, s30
    s_mov_b32 m0, s31
    s_mov_b32 s33, s24
    buffer_load_dwordx4 v9, s[56:59], s33 offen offset:0 lds
    s_add_u32 s33, s33, s44
    buffer_load_dwordx4 v9, s[56:59], s33 offen offset:1024 lds
    s_add_u32 s33, s33, s44
    buffer_load_dwordx4 v9, s[56:59], s33 offen offset:2048 lds
    s_add_u32 s33, s33, s44
    buffer_load_dwordx4 v9, s[56:59], s33 offen offset:3072 lds
    s_add_u32 s31, s31, 4096
    s_mov_b32 m0, s31
    s_add_u32 s33, s33, s45
    buffer_load_dwordx4 v9, s[56:59], s33 offen offset:0 lds
    s_add_u32 s33, s33, s44
    buffer_load_dwordx4 v9, s[56:59], s33 offen offset:1024 lds
    s_add_u32 s33, s33, s44
    buffer_load_dwordx4 v9, s[56:59], s33 offen offset:2048 lds
    s_add_u32 s33, s33, s44
    buffer_load_dwordx4 v9, s[56:59], s33 offen offset:3072 lds
    s_add_u32 s31, s31, 4096
    s_mov_b32 m0, s31
    s_add_u32 s33, s33, s45
    buffer_load_dwordx4 v9, s[56:59], s33 offen offset:0 lds
    s_add_u32 s33, s33, s44
    buffer_load_dwordx4 v9, s[56:59], s33 offen offset:1024 lds
    s_add_u32 s33, s24, s27
    s_mov_b32 s24, s25
    s_mov_b32 s25, s33
    s_mov_b64 s[46:47], s[56:57]
    s_mov_b64 s[56:57], s[60:61]
    s_mov_b64 s[60:61], s[46:47]
    s_mov_b32 s37, 0
    s_mul_i32 s38, s21, 524288
    s_mul_i32 s39, s19, 16777216
    s_add_u32 s39, s39, 27607040
    s_add_u32 s38, s38, s39
    s_mul_i32 s40, s21, 221184
    s_add_u32 s40, s40, 111493120
    s_waitcnt vmcnt(20)
    s_barrier
L_chh_unit:
    v_add_u32 v10, s34, v5
    v_add_u32 v11, s34, v6
    s_cmp_eq_u32 s19, 2
    s_cbranch_scc1 L_chh_cv
    ds_read_b64_tr_b16 v[96:97], v10 offset:0
    ds_read_b64_tr_b16 v[98:99], v10 offset:256
    ds_read_b64_tr_b16 v[100:101], v11 offset:0
    ds_read_b64_tr_b16 v[102:103], v11 offset:256
    ds_read_b64_tr_b16 v[104:105], v10 offset:2048
    ds_read_b64_tr_b16 v[106:107], v10 offset:2304
    ds_read_b64_tr_b16 v[108:109], v11 offset:2048
    ds_read_b64_tr_b16 v[110:111], v11 offset:2304
    ds_read_b64_tr_b16 v[112:113], v10 offset:4096
    ds_read_b64_tr_b16 v[114:115], v10 offset:4352
    ds_read_b64_tr_b16 v[116:117], v11 offset:4096
    ds_read_b64_tr_b16 v[118:119], v11 offset:4352
    ds_read_b64_tr_b16 v[120:121], v10 offset:6144
    ds_read_b64_tr_b16 v[122:123], v10 offset:6400
    ds_read_b64_tr_b16 v[124:125], v11 offset:6144
    ds_read_b64_tr_b16 v[126:127], v11 offset:6400
    s_waitcnt lgkmcnt(12)
    v_mfma_f32_16x16x32_bf16 v[64:67], v[96:99], a[0:3], 0
    v_mfma_f32_16x16x32_bf16 v[68:71], v[96:99], a[80:83], 0
    v_mfma_f32_16x16x32_bf16 v[72:75], v[96:99], a[160:163], 0
    v_mfma_f32_16x16x32_bf16 v[76:79], v[96:99], a[240:243], 0
    v_mfma_f32_16x16x32_bf16 v[80:83], v[100:103], a[0:3], 0
    v_mfma_f32_16x16x32_bf16 v[84:87], v[100:103], a[80:83], 0
    v_mfma_f32_16x16x32_bf16 v[88:91], v[100:103], a[160:163], 0
    v_mfma_f32_16x16x32_bf16 v[92:95], v[100:103], a[240:243], 0
    ds_read_b64_tr_b16 v[96:97], v10 offset:8192
    ds_read_b64_tr_b16 v[98:99], v10 offset:8448
    ds_read_b64_tr_b16 v[100:101], v11 offset:8192
    ds_read_b64_tr_b16 v[102:103], v11 offset:8448
    s_waitcnt lgkmcnt(12)
    v_mfma_f32_16x16x32_bf16 v[64:67], v[104:107], a[4:7], v[64:67]
    v_mfma_f32_16x16x32_bf16 v[68:71], v[104:107], a[84:87], v[68:71]
    v_mfma_f32_16x16x32_bf16 v[72:75], v[104:107], a[164:167], v[72:75]
    v_mfma_f32_16x16x32_bf16 v[76:79], v[104:107], a[244:247], v[76:79]
    v_mfma_f32_16x16x32_bf16 v[80:83], v[108:111], a[4:7], v[80:83]
    v_mfma_f32_16x16x32_bf16 v[84:87], v[108:111], a[84:87], v[84:87]
    v_mfma_f32_16x16x32_bf16 v[88:91], v[108:111], a[164:167], v[88:91]
    v_mfma_f32_16x16x32_bf16 v[92:95], v[108:111], a[244:247], v[92:95]
    ds_read_b64_tr_b16 v[104:105], v10 offset:10240
    ds_read_b64_tr_b16 v[106:107], v10 offset:10496
    ds_read_b64_tr_b16 v[108:109], v11 offset:10240
    ds_read_b64_tr_b16 v[110:111], v11 offset:10496
    s_waitcnt lgkmcnt(12)
    v_mfma_f32_16x16x32_bf16 v[64:67], v[112:115], a[8:11], v[64:67]
    v_mfma_f32_16x16x32_bf16 v[68:71], v[112:115], a[88:91], v[68:71]
    v_mfma_f32_16x16x32_bf16 v[72:75], v[112:115], a[168:171], v[72:75]
    v_mfma_f32_16x16x32_bf16 v[76:79], v[112:115], a[248:251], v[76:79]
    v_mfma_f32_16x16x32_bf16 v[80:83], v[116:119], a[8:11], v[80:83]
    v_mfma_f32_16x16x32_bf16 v[84:87], v[116:119], a[88:91], v[84:87]
    v_mfma_f32_16x16x32_bf16 v[88:91], v[116:119], a[168:171], v[88:91]
    v_mfma_f32_16x16x32_bf16 v[92:95], v[116:119], a[248:251], v[92:95]
    ds_read_b64_tr_b16 v[112:113], v10 offset:12288
    ds_read_b64_tr_b16 v[114:115], v10 offset:12544
    ds_read_b64_tr_b16 v[116:117], v11 offset:12288
    ds_read_b64_tr_b16 v[118:119], v11 offset:12544
    s_waitcnt lgkmcnt(12)
    v_mfma_f32_16x16x32_bf16 v[64:67], v[120:123], a[12:15], v[64:67]
    v_mfma_f32_16x16x32_bf16 v[68:71], v[120:123], a[92:95], v[68:71]
    v_mfma_f32_16x16x32_bf16 v[72:75], v[120:123], a[172:175], v[72:75]
    v_mfma_f32_16x16x32_bf16 v[76:79], v[120:123], a[252:255], v[76:79]
    v_mfma_f32_16x16x32_bf16 v[80:83], v[124:127], a[12:15], v[80:83]
    v_mfma_f32_16x16x32_bf16 v[84:87], v[124:127], a[92:95], v[84:87]
    v_mfma_f32_16x16x32_bf16 v[88:91], v[124:127], a[172:175], v[88:91]
    v_mfma_f32_16x16x32_bf16 v[92:95], v[124:127], a[252:255], v[92:95]
    ds_read_b64_tr_b16 v[120:121], v10 offset:14336
    ds_read_b64_tr_b16 v[122:123], v10 offset:14592
    ds_read_b64_tr_b16 v[124:125], v11 offset:14336
    ds_read_b64_tr_b16 v[126:127], v11 offset:14592
    s_waitcnt lgkmcnt(12)
    v_mfma_f32_16x16x32_bf16 v[64:67], v[96:99], a[16:19], v[64:67]
    v_mfma_f32_16x16x32_bf16 v[68:71], v[96:99], a[96:99], v[68:71]
    v_mfma_f32_16x16x32_bf16 v[72:75], v[96:99], a[176:179], v[72:75]
    v_mfma_f32_16x16x32_bf16 v[76:79], v[96:99], v[192:195], v[76:79]
    v_mfma_f32_16x16x32_bf16 v[80:83], v[100:103], a[16:19], v[80:83]
    v_mfma_f32_16x16x32_bf16 v[84:87], v[100:103], a[96:99], v[84:87]
    v_mfma_f32_16x16x32_bf16 v[88:91], v[100:103], a[176:179], v[88:91]
    v_mfma_f32_16x16x32_bf16 v[92:95], v[100:103], v[192:195], v[92:95]
    ds_read_b64_tr_b16 v[96:97], v10 offset:16384
    ds_read_b64_tr_b16 v[98:99], v10 offset:16640
    ds_read_b64_tr_b16 v[100:101], v11 offset:16384
    ds_read_b64_tr_b16 v[102:103], v11 offset:16640
    s_waitcnt lgkmcnt(12)
    v_mfma_f32_16x16x32_bf16 v[64:67], v[104:107], a[20:23], v[64:67]
    v_mfma_f32_16x16x32_bf16 v[68:71], v[104:107], a[100:103], v[68:71]
    v_mfma_f32_16x16x32_bf16 v[72:75], v[104:107], a[180:183], v[72:75]
    v_mfma_f32_16x16x32_bf16 v[76:79], v[104:107], v[196:199], v[76:79]
    v_mfma_f32_16x16x32_bf16 v[80:83], v[108:111], a[20:23], v[80:83]
    v_mfma_f32_16x16x32_bf16 v[84:87], v[108:111], a[100:103], v[84:87]
    v_mfma_f32_16x16x32_bf16 v[88:91], v[108:111], a[180:183], v[88:91]
    v_mfma_f32_16x16x32_bf16 v[92:95], v[108:111], v[196:199], v[92:95]
    ds_read_b64_tr_b16 v[104:105], v10 offset:18432
    ds_read_b64_tr_b16 v[106:107], v10 offset:18688
    ds_read_b64_tr_b16 v[108:109], v11 offset:18432
    ds_read_b64_tr_b16 v[110:111], v11 offset:18688
    s_waitcnt lgkmcnt(12)
    v_mfma_f32_16x16x32_bf16 v[64:67], v[112:115], a[24:27], v[64:67]
    v_mfma_f32_16x16x32_bf16 v[68:71], v[112:115], a[104:107], v[68:71]
    v_mfma_f32_16x16x32_bf16 v[72:75], v[112:115], a[184:187], v[72:75]
    v_mfma_f32_16x16x32_bf16 v[76:79], v[112:115], v[200:203], v[76:79]
    v_mfma_f32_16x16x32_bf16 v[80:83], v[116:119], a[24:27], v[80:83]
    v_mfma_f32_16x16x32_bf16 v[84:87], v[116:119], a[104:107], v[84:87]
    v_mfma_f32_16x16x32_bf16 v[88:91], v[116:119], a[184:187], v[88:91]
    v_mfma_f32_16x16x32_bf16 v[92:95], v[116:119], v[200:203], v[92:95]
    ds_read_b64_tr_b16 v[112:113], v10 offset:20480
    ds_read_b64_tr_b16 v[114:115], v10 offset:20736
    ds_read_b64_tr_b16 v[116:117], v11 offset:20480
    ds_read_b64_tr_b16 v[118:119], v11 offset:20736
    s_waitcnt lgkmcnt(12)
    v_mfma_f32_16x16x32_bf16 v[64:67], v[120:123], a[28:31], v[64:67]
    v_mfma_f32_16x16x32_bf16 v[68:71], v[120:123], a[108:111], v[68:71]
    v_mfma_f32_16x16x32_bf16 v[72:75], v[120:123], a[188:191], v[72:75]
    v_mfma_f32_16x16x32_bf16 v[76:79], v[120:123], v[204:207], v[76:79]
    v_mfma_f32_16x16x32_bf16 v[80:83], v[124:127], a[28:31], v[80:83]
    v_mfma_f32_16x16x32_bf16 v[84:87], v[124:127], a[108:111], v[84:87]
    v_mfma_f32_16x16x32_bf16 v[88:91], v[124:127], a[188:191], v[88:91]
    v_mfma_f32_16x16x32_bf16 v[92:95], v[124:127], v[204:207], v[92:95]
    ds_read_b64_tr_b16 v[120:121], v10 offset:22528
    ds_read_b64_tr_b16 v[122:123], v10 offset:22784
    ds_read_b64_tr_b16 v[124:125], v11 offset:22528
    ds_read_b64_tr_b16 v[126:127], v11 offset:22784
    s_waitcnt lgkmcnt(12)
    v_mfma_f32_16x16x32_bf16 v[64:67], v[96:99], a[32:35], v[64:67]
    v_mfma_f32_16x16x32_bf16 v[68:71], v[96:99], a[112:115], v[68:71]
    v_mfma_f32_16x16x32_bf16 v[72:75], v[96:99], a[192:195], v[72:75]
    v_mfma_f32_16x16x32_bf16 v[76:79], v[96:99], v[208:211], v[76:79]
    v_mfma_f32_16x16x32_bf16 v[80:83], v[100:103], a[32:35], v[80:83]
    v_mfma_f32_16x16x32_bf16 v[84:87], v[100:103], a[112:115], v[84:87]
    v_mfma_f32_16x16x32_bf16 v[88:91], v[100:103], a[192:195], v[88:91]
    v_mfma_f32_16x16x32_bf16 v[92:95], v[100:103], v[208:211], v[92:95]
    ds_read_b64_tr_b16 v[96:97], v10 offset:24576
    ds_read_b64_tr_b16 v[98:99], v10 offset:24832
    ds_read_b64_tr_b16 v[100:101], v11 offset:24576
    ds_read_b64_tr_b16 v[102:103], v11 offset:24832
    s_waitcnt lgkmcnt(12)
    v_mfma_f32_16x16x32_bf16 v[64:67], v[104:107], a[36:39], v[64:67]
    v_mfma_f32_16x16x32_bf16 v[68:71], v[104:107], a[116:119], v[68:71]
    v_mfma_f32_16x16x32_bf16 v[72:75], v[104:107], a[196:199], v[72:75]
    v_mfma_f32_16x16x32_bf16 v[76:79], v[104:107], v[212:215], v[76:79]
    v_mfma_f32_16x16x32_bf16 v[80:83], v[108:111], a[36:39], v[80:83]
    v_mfma_f32_16x16x32_bf16 v[84:87], v[108:111], a[116:119], v[84:87]
    v_mfma_f32_16x16x32_bf16 v[88:91], v[108:111], a[196:199], v[88:91]
    v_mfma_f32_16x16x32_bf16 v[92:95], v[108:111], v[212:215], v[92:95]
    ds_read_b64_tr_b16 v[104:105], v10 offset:26624
    ds_read_b64_tr_b16 v[106:107], v10 offset:26880
    ds_read_b64_tr_b16 v[108:109], v11 offset:26624
    ds_read_b64_tr_b16 v[110:111], v11 offset:26880
    s_waitcnt lgkmcnt(12)
    v_mfma_f32_16x16x32_bf16 v[64:67], v[112:115], a[40:43], v[64:67]
    v_mfma_f32_16x16x32_bf16 v[68:71], v[112:115], a[120:123], v[68:71]
    v_mfma_f32_16x16x32_bf16 v[72:75], v[112:115], a[200:203], v[72:75]
    v_mfma_f32_16x16x32_bf16 v[76:79], v[112:115], v[216:219], v[76:79]
    v_mfma_f32_16x16x32_bf16 v[80:83], v[116:119], a[40:43], v[80:83]
    v_mfma_f32_16x16x32_bf16 v[84:87], v[116:119], a[120:123], v[84:87]
    v_mfma_f32_16x16x32_bf16 v[88:91], v[116:119], a[200:203], v[88:91]
    v_mfma_f32_16x16x32_bf16 v[92:95], v[116:119], v[216:219], v[92:95]
    ds_read_b64_tr_b16 v[112:113], v10 offset:28672
    ds_read_b64_tr_b16 v[114:115], v10 offset:28928
    ds_read_b64_tr_b16 v[116:117], v11 offset:28672
    ds_read_b64_tr_b16 v[118:119], v11 offset:28928
    s_waitcnt lgkmcnt(12)
    v_mfma_f32_16x16x32_bf16 v[64:67], v[120:123], a[44:47], v[64:67]
    v_mfma_f32_16x16x32_bf16 v[68:71], v[120:123], a[124:127], v[68:71]
    v_mfma_f32_16x16x32_bf16 v[72:75], v[120:123], a[204:207], v[72:75]
    v_mfma_f32_16x16x32_bf16 v[76:79], v[120:123], v[220:223], v[76:79]
    v_mfma_f32_16x16x32_bf16 v[80:83], v[124:127], a[44:47], v[80:83]
    v_mfma_f32_16x16x32_bf16 v[84:87], v[124:127], a[124:127], v[84:87]
    v_mfma_f32_16x16x32_bf16 v[88:91], v[124:127], a[204:207], v[88:91]
    v_mfma_f32_16x16x32_bf16 v[92:95], v[124:127], v[220:223], v[92:95]
    ds_read_b64_tr_b16 v[120:121], v10 offset:30720
    ds_read_b64_tr_b16 v[122:123], v10 offset:30976
    ds_read_b64_tr_b16 v[124:125], v11 offset:30720
    ds_read_b64_tr_b16 v[126:127], v11 offset:30976
    s_waitcnt lgkmcnt(12)
    v_mfma_f32_16x16x32_bf16 v[64:67], v[96:99], a[48:51], v[64:67]
    v_mfma_f32_16x16x32_bf16 v[68:71], v[96:99], a[128:131], v[68:71]
    v_mfma_f32_16x16x32_bf16 v[72:75], v[96:99], a[208:211], v[72:75]
    v_mfma_f32_16x16x32_bf16 v[76:79], v[96:99], v[224:227], v[76:79]
    v_mfma_f32_16x16x32_bf16 v[80:83], v[100:103], a[48:51], v[80:83]
    v_mfma_f32_16x16x32_bf16 v[84:87], v[100:103], a[128:131], v[84:87]
    v_mfma_f32_16x16x32_bf16 v[88:91], v[100:103], a[208:211], v[88:91]
    v_mfma_f32_16x16x32_bf16 v[92:95], v[100:103], v[224:227], v[92:95]
    ds_read_b64_tr_b16 v[96:97], v10 offset:32768
    ds_read_b64_tr_b16 v[98:99], v10 offset:33024
    ds_read_b64_tr_b16 v[100:101], v11 offset:32768
    ds_read_b64_tr_b16 v[102:103], v11 offset:33024
    s_waitcnt lgkmcnt(12)
    v_mfma_f32_16x16x32_bf16 v[64:67], v[104:107], a[52:55], v[64:67]
    v_mfma_f32_16x16x32_bf16 v[68:71], v[104:107], a[132:135], v[68:71]
    v_mfma_f32_16x16x32_bf16 v[72:75], v[104:107], a[212:215], v[72:75]
    v_mfma_f32_16x16x32_bf16 v[76:79], v[104:107], v[228:231], v[76:79]
    v_mfma_f32_16x16x32_bf16 v[80:83], v[108:111], a[52:55], v[80:83]
    v_mfma_f32_16x16x32_bf16 v[84:87], v[108:111], a[132:135], v[84:87]
    v_mfma_f32_16x16x32_bf16 v[88:91], v[108:111], a[212:215], v[88:91]
    v_mfma_f32_16x16x32_bf16 v[92:95], v[108:111], v[228:231], v[92:95]
    ds_read_b64_tr_b16 v[104:105], v10 offset:34816
    ds_read_b64_tr_b16 v[106:107], v10 offset:35072
    ds_read_b64_tr_b16 v[108:109], v11 offset:34816
    ds_read_b64_tr_b16 v[110:111], v11 offset:35072
    s_waitcnt lgkmcnt(12)
    v_mfma_f32_16x16x32_bf16 v[64:67], v[112:115], a[56:59], v[64:67]
    v_mfma_f32_16x16x32_bf16 v[68:71], v[112:115], a[136:139], v[68:71]
    v_mfma_f32_16x16x32_bf16 v[72:75], v[112:115], a[216:219], v[72:75]
    v_mfma_f32_16x16x32_bf16 v[76:79], v[112:115], v[232:235], v[76:79]
    v_mfma_f32_16x16x32_bf16 v[80:83], v[116:119], a[56:59], v[80:83]
    v_mfma_f32_16x16x32_bf16 v[84:87], v[116:119], a[136:139], v[84:87]
    v_mfma_f32_16x16x32_bf16 v[88:91], v[116:119], a[216:219], v[88:91]
    v_mfma_f32_16x16x32_bf16 v[92:95], v[116:119], v[232:235], v[92:95]
    ds_read_b64_tr_b16 v[112:113], v10 offset:36864
    ds_read_b64_tr_b16 v[114:115], v10 offset:37120
    ds_read_b64_tr_b16 v[116:117], v11 offset:36864
    ds_read_b64_tr_b16 v[118:119], v11 offset:37120
    s_waitcnt lgkmcnt(12)
    v_mfma_f32_16x16x32_bf16 v[64:67], v[120:123], a[60:63], v[64:67]
    v_mfma_f32_16x16x32_bf16 v[68:71], v[120:123], a[140:143], v[68:71]
    v_mfma_f32_16x16x32_bf16 v[72:75], v[120:123], a[220:223], v[72:75]
    v_mfma_f32_16x16x32_bf16 v[76:79], v[120:123], v[236:239], v[76:79]
    v_mfma_f32_16x16x32_bf16 v[80:83], v[124:127], a[60:63], v[80:83]
    v_mfma_f32_16x16x32_bf16 v[84:87], v[124:127], a[140:143], v[84:87]
    v_mfma_f32_16x16x32_bf16 v[88:91], v[124:127], a[220:223], v[88:91]
    v_mfma_f32_16x16x32_bf16 v[92:95], v[124:127], v[236:239], v[92:95]
    ds_read_b64_tr_b16 v[120:121], v10 offset:38912
    ds_read_b64_tr_b16 v[122:123], v10 offset:39168
    ds_read_b64_tr_b16 v[124:125], v11 offset:38912
    ds_read_b64_tr_b16 v[126:127], v11 offset:39168
    s_waitcnt lgkmcnt(12)
    v_mfma_f32_16x16x32_bf16 v[64:67], v[96:99], a[64:67], v[64:67]
    v_mfma_f32_16x16x32_bf16 v[68:71], v[96:99], a[144:147], v[68:71]
    v_mfma_f32_16x16x32_bf16 v[72:75], v[96:99], a[224:227], v[72:75]
    v_mfma_f32_16x16x32_bf16 v[76:79], v[96:99], v[240:243], v[76:79]
    v_mfma_f32_16x16x32_bf16 v[80:83], v[100:103], a[64:67], v[80:83]
    v_mfma_f32_16x16x32_bf16 v[84:87], v[100:103], a[144:147], v[84:87]
    v_mfma_f32_16x16x32_bf16 v[88:91], v[100:103], a[224:227], v[88:91]
    v_mfma_f32_16x16x32_bf16 v[92:95], v[100:103], v[240:243], v[92:95]
    s_waitcnt lgkmcnt(8)
    v_mfma_f32_16x16x32_bf16 v[64:67], v[104:107], a[68:71], v[64:67]
    v_mfma_f32_16x16x32_bf16 v[68:71], v[104:107], a[148:151], v[68:71]
    v_mfma_f32_16x16x32_bf16 v[72:75], v[104:107], a[228:231], v[72:75]
    v_mfma_f32_16x16x32_bf16 v[76:79], v[104:107], v[244:247], v[76:79]
    v_mfma_f32_16x16x32_bf16 v[80:83], v[108:111], a[68:71], v[80:83]
    v_mfma_f32_16x16x32_bf16 v[84:87], v[108:111], a[148:151], v[84:87]
    v_mfma_f32_16x16x32_bf16 v[88:91], v[108:111], a[228:231], v[88:91]
    v_mfma_f32_16x16x32_bf16 v[92:95], v[108:111], v[244:247], v[92:95]
    s_waitcnt lgkmcnt(4)
    v_mfma_f32_16x16x32_bf16 v[64:67], v[112:115], a[72:75], v[64:67]
    v_mfma_f32_16x16x32_bf16 v[68:71], v[112:115], a[152:155], v[68:71]
    v_mfma_f32_16x16x32_bf16 v[72:75], v[112:115], a[232:235], v[72:75]
    v_mfma_f32_16x16x32_bf16 v[76:79], v[112:115], v[248:251], v[76:79]
    v_mfma_f32_16x16x32_bf16 v[80:83], v[116:119], a[72:75], v[80:83]
    v_mfma_f32_16x16x32_bf16 v[84:87], v[116:119], a[152:155], v[84:87]
    v_mfma_f32_16x16x32_bf16 v[88:91], v[116:119], a[232:235], v[88:91]
    v_mfma_f32_16x16x32_bf16 v[92:95], v[116:119], v[248:251], v[92:95]
    s_waitcnt lgkmcnt(0)
    v_mfma_f32_16x16x32_bf16 v[64:67], v[120:123], a[76:79], v[64:67]
    v_mfma_f32_16x16x32_bf16 v[68:71], v[120:123], a[156:159], v[68:71]
    v_mfma_f32_16x16x32_bf16 v[72:75], v[120:123], a[236:239], v[72:75]
    v_mfma_f32_16x16x32_bf16 v[76:79], v[120:123], v[252:255], v[76:79]
    v_mfma_f32_16x16x32_bf16 v[80:83], v[124:127], a[76:79], v[80:83]
    v_mfma_f32_16x16x32_bf16 v[84:87], v[124:127], a[156:159], v[84:87]
    v_mfma_f32_16x16x32_bf16 v[88:91], v[124:127], a[236:239], v[88:91]
    v_mfma_f32_16x16x32_bf16 v[92:95], v[124:127], v[252:255], v[92:95]
    s_branch L_chh_cd
L_chh_cv:
    ds_read_b64_tr_b16 v[96:97], v10 offset:0
    ds_read_b64_tr_b16 v[98:99], v10 offset:256
    ds_read_b64_tr_b16 v[100:101], v11 offset:0
    ds_read_b64_tr_b16 v[102:103], v11 offset:256
    ds_read_b64_tr_b16 v[104:105], v10 offset:2048
    ds_read_b64_tr_b16 v[106:107], v10 offset:2304
    ds_read_b64_tr_b16 v[108:109], v11 offset:2048
    ds_read_b64_tr_b16 v[110:111], v11 offset:2304
    ds_read_b64_tr_b16 v[112:113], v10 offset:4096
    ds_read_b64_tr_b16 v[114:115], v10 offset:4352
    ds_read_b64_tr_b16 v[116:117], v11 offset:4096
    ds_read_b64_tr_b16 v[118:119], v11 offset:4352
    ds_read_b64_tr_b16 v[120:121], v10 offset:6144
    ds_read_b64_tr_b16 v[122:123], v10 offset:6400
    ds_read_b64_tr_b16 v[124:125], v11 offset:6144
    ds_read_b64_tr_b16 v[126:127], v11 offset:6400
    s_waitcnt lgkmcnt(12)
    v_mfma_f32_16x16x32_bf16 v[64:67], a[0:3], v[96:99], 0
    v_mfma_f32_16x16x32_bf16 v[68:71], a[80:83], v[96:99], 0
    v_mfma_f32_16x16x32_bf16 v[72:75], a[160:163], v[96:99], 0
    v_mfma_f32_16x16x32_bf16 v[76:79], a[240:243], v[96:99], 0
    v_mfma_f32_16x16x32_bf16 v[80:83], a[0:3], v[100:103], 0
    v_mfma_f32_16x16x32_bf16 v[84:87], a[80:83], v[100:103], 0
    v_mfma_f32_16x16x32_bf16 v[88:91], a[160:163], v[100:103], 0
    v_mfma_f32_16x16x32_bf16 v[92:95], a[240:243], v[100:103], 0
    ds_read_b64_tr_b16 v[96:97], v10 offset:8192
    ds_read_b64_tr_b16 v[98:99], v10 offset:8448
    ds_read_b64_tr_b16 v[100:101], v11 offset:8192
    ds_read_b64_tr_b16 v[102:103], v11 offset:8448
    s_waitcnt lgkmcnt(12)
    v_mfma_f32_16x16x32_bf16 v[64:67], a[4:7], v[104:107], v[64:67]
    v_mfma_f32_16x16x32_bf16 v[68:71], a[84:87], v[104:107], v[68:71]
    v_mfma_f32_16x16x32_bf16 v[72:75], a[164:167], v[104:107], v[72:75]
    v_mfma_f32_16x16x32_bf16 v[76:79], a[244:247], v[104:107], v[76:79]
    v_mfma_f32_16x16x32_bf16 v[80:83], a[4:7], v[108:111], v[80:83]
    v_mfma_f32_16x16x32_bf16 v[84:87], a[84:87], v[108:111], v[84:87]
    v_mfma_f32_16x16x32_bf16 v[88:91], a[164:167], v[108:111], v[88:91]
    v_mfma_f32_16x16x32_bf16 v[92:95], a[244:247], v[108:111], v[92:95]
    ds_read_b64_tr_b16 v[104:105], v10 offset:10240
    ds_read_b64_tr_b16 v[106:107], v10 offset:10496
    ds_read_b64_tr_b16 v[108:109], v11 offset:10240
    ds_read_b64_tr_b16 v[110:111], v11 offset:10496
    s_waitcnt lgkmcnt(12)
    v_mfma_f32_16x16x32_bf16 v[64:67], a[8:11], v[112:115], v[64:67]
    v_mfma_f32_16x16x32_bf16 v[68:71], a[88:91], v[112:115], v[68:71]
    v_mfma_f32_16x16x32_bf16 v[72:75], a[168:171], v[112:115], v[72:75]
    v_mfma_f32_16x16x32_bf16 v[76:79], a[248:251], v[112:115], v[76:79]
    v_mfma_f32_16x16x32_bf16 v[80:83], a[8:11], v[116:119], v[80:83]
    v_mfma_f32_16x16x32_bf16 v[84:87], a[88:91], v[116:119], v[84:87]
    v_mfma_f32_16x16x32_bf16 v[88:91], a[168:171], v[116:119], v[88:91]
    v_mfma_f32_16x16x32_bf16 v[92:95], a[248:251], v[116:119], v[92:95]
    ds_read_b64_tr_b16 v[112:113], v10 offset:12288
    ds_read_b64_tr_b16 v[114:115], v10 offset:12544
    ds_read_b64_tr_b16 v[116:117], v11 offset:12288
    ds_read_b64_tr_b16 v[118:119], v11 offset:12544
    s_waitcnt lgkmcnt(12)
    v_mfma_f32_16x16x32_bf16 v[64:67], a[12:15], v[120:123], v[64:67]
    v_mfma_f32_16x16x32_bf16 v[68:71], a[92:95], v[120:123], v[68:71]
    v_mfma_f32_16x16x32_bf16 v[72:75], a[172:175], v[120:123], v[72:75]
    v_mfma_f32_16x16x32_bf16 v[76:79], a[252:255], v[120:123], v[76:79]
    v_mfma_f32_16x16x32_bf16 v[80:83], a[12:15], v[124:127], v[80:83]
    v_mfma_f32_16x16x32_bf16 v[84:87], a[92:95], v[124:127], v[84:87]
    v_mfma_f32_16x16x32_bf16 v[88:91], a[172:175], v[124:127], v[88:91]
    v_mfma_f32_16x16x32_bf16 v[92:95], a[252:255], v[124:127], v[92:95]
    ds_read_b64_tr_b16 v[120:121], v10 offset:14336
    ds_read_b64_tr_b16 v[122:123], v10 offset:14592
    ds_read_b64_tr_b16 v[124:125], v11 offset:14336
    ds_read_b64_tr_b16 v[126:127], v11 offset:14592
    s_waitcnt lgkmcnt(12)
    v_mfma_f32_16x16x32_bf16 v[64:67], a[16:19], v[96:99], v[64:67]
    v_mfma_f32_16x16x32_bf16 v[68:71], a[96:99], v[96:99], v[68:71]
    v_mfma_f32_16x16x32_bf16 v[72:75], a[176:179], v[96:99], v[72:75]
    v_mfma_f32_16x16x32_bf16 v[76:79], v[192:195], v[96:99], v[76:79]
    v_mfma_f32_16x16x32_bf16 v[80:83], a[16:19], v[100:103], v[80:83]
    v_mfma_f32_16x16x32_bf16 v[84:87], a[96:99], v[100:103], v[84:87]
    v_mfma_f32_16x16x32_bf16 v[88:91], a[176:179], v[100:103], v[88:91]
    v_mfma_f32_16x16x32_bf16 v[92:95], v[192:195], v[100:103], v[92:95]
    ds_read_b64_tr_b16 v[96:97], v10 offset:16384
    ds_read_b64_tr_b16 v[98:99], v10 offset:16640
    ds_read_b64_tr_b16 v[100:101], v11 offset:16384
    ds_read_b64_tr_b16 v[102:103], v11 offset:16640
    s_waitcnt lgkmcnt(12)
    v_mfma_f32_16x16x32_bf16 v[64:67], a[20:23], v[104:107], v[64:67]
    v_mfma_f32_16x16x32_bf16 v[68:71], a[100:103], v[104:107], v[68:71]
    v_mfma_f32_16x16x32_bf16 v[72:75], a[180:183], v[104:107], v[72:75]
    v_mfma_f32_16x16x32_bf16 v[76:79], v[196:199], v[104:107], v[76:79]
    v_mfma_f32_16x16x32_bf16 v[80:83], a[20:23], v[108:111], v[80:83]
    v_mfma_f32_16x16x32_bf16 v[84:87], a[100:103], v[108:111], v[84:87]
    v_mfma_f32_16x16x32_bf16 v[88:91], a[180:183], v[108:111], v[88:91]
    v_mfma_f32_16x16x32_bf16 v[92:95], v[196:199], v[108:111], v[92:95]
    ds_read_b64_tr_b16 v[104:105], v10 offset:18432
    ds_read_b64_tr_b16 v[106:107], v10 offset:18688
    ds_read_b64_tr_b16 v[108:109], v11 offset:18432
    ds_read_b64_tr_b16 v[110:111], v11 offset:18688
    s_waitcnt lgkmcnt(12)
    v_mfma_f32_16x16x32_bf16 v[64:67], a[24:27], v[112:115], v[64:67]
    v_mfma_f32_16x16x32_bf16 v[68:71], a[104:107], v[112:115], v[68:71]
    v_mfma_f32_16x16x32_bf16 v[72:75], a[184:187], v[112:115], v[72:75]
    v_mfma_f32_16x16x32_bf16 v[76:79], v[200:203], v[112:115], v[76:79]
    v_mfma_f32_16x16x32_bf16 v[80:83], a[24:27], v[116:119], v[80:83]
    v_mfma_f32_16x16x32_bf16 v[84:87], a[104:107], v[116:119], v[84:87]
    v_mfma_f32_16x16x32_bf16 v[88:91], a[184:187], v[116:119], v[88:91]
    v_mfma_f32_16x16x32_bf16 v[92:95], v[200:203], v[116:119], v[92:95]
    ds_read_b64_tr_b16 v[112:113], v10 offset:20480
    ds_read_b64_tr_b16 v[114:115], v10 offset:20736
    ds_read_b64_tr_b16 v[116:117], v11 offset:20480
    ds_read_b64_tr_b16 v[118:119], v11 offset:20736
    s_waitcnt lgkmcnt(12)
    v_mfma_f32_16x16x32_bf16 v[64:67], a[28:31], v[120:123], v[64:67]
    v_mfma_f32_16x16x32_bf16 v[68:71], a[108:111], v[120:123], v[68:71]
    v_mfma_f32_16x16x32_bf16 v[72:75], a[188:191], v[120:123], v[72:75]
    v_mfma_f32_16x16x32_bf16 v[76:79], v[204:207], v[120:123], v[76:79]
    v_mfma_f32_16x16x32_bf16 v[80:83], a[28:31], v[124:127], v[80:83]
    v_mfma_f32_16x16x32_bf16 v[84:87], a[108:111], v[124:127], v[84:87]
    v_mfma_f32_16x16x32_bf16 v[88:91], a[188:191], v[124:127], v[88:91]
    v_mfma_f32_16x16x32_bf16 v[92:95], v[204:207], v[124:127], v[92:95]
    ds_read_b64_tr_b16 v[120:121], v10 offset:22528
    ds_read_b64_tr_b16 v[122:123], v10 offset:22784
    ds_read_b64_tr_b16 v[124:125], v11 offset:22528
    ds_read_b64_tr_b16 v[126:127], v11 offset:22784
    s_waitcnt lgkmcnt(12)
    v_mfma_f32_16x16x32_bf16 v[64:67], a[32:35], v[96:99], v[64:67]
    v_mfma_f32_16x16x32_bf16 v[68:71], a[112:115], v[96:99], v[68:71]
    v_mfma_f32_16x16x32_bf16 v[72:75], a[192:195], v[96:99], v[72:75]
    v_mfma_f32_16x16x32_bf16 v[76:79], v[208:211], v[96:99], v[76:79]
    v_mfma_f32_16x16x32_bf16 v[80:83], a[32:35], v[100:103], v[80:83]
    v_mfma_f32_16x16x32_bf16 v[84:87], a[112:115], v[100:103], v[84:87]
    v_mfma_f32_16x16x32_bf16 v[88:91], a[192:195], v[100:103], v[88:91]
    v_mfma_f32_16x16x32_bf16 v[92:95], v[208:211], v[100:103], v[92:95]
    ds_read_b64_tr_b16 v[96:97], v10 offset:24576
    ds_read_b64_tr_b16 v[98:99], v10 offset:24832
    ds_read_b64_tr_b16 v[100:101], v11 offset:24576
    ds_read_b64_tr_b16 v[102:103], v11 offset:24832
    s_waitcnt lgkmcnt(12)
    v_mfma_f32_16x16x32_bf16 v[64:67], a[36:39], v[104:107], v[64:67]
    v_mfma_f32_16x16x32_bf16 v[68:71], a[116:119], v[104:107], v[68:71]
    v_mfma_f32_16x16x32_bf16 v[72:75], a[196:199], v[104:107], v[72:75]
    v_mfma_f32_16x16x32_bf16 v[76:79], v[212:215], v[104:107], v[76:79]
    v_mfma_f32_16x16x32_bf16 v[80:83], a[36:39], v[108:111], v[80:83]
    v_mfma_f32_16x16x32_bf16 v[84:87], a[116:119], v[108:111], v[84:87]
    v_mfma_f32_16x16x32_bf16 v[88:91], a[196:199], v[108:111], v[88:91]
    v_mfma_f32_16x16x32_bf16 v[92:95], v[212:215], v[108:111], v[92:95]
    ds_read_b64_tr_b16 v[104:105], v10 offset:26624
    ds_read_b64_tr_b16 v[106:107], v10 offset:26880
    ds_read_b64_tr_b16 v[108:109], v11 offset:26624
    ds_read_b64_tr_b16 v[110:111], v11 offset:26880
    s_waitcnt lgkmcnt(12)
    v_mfma_f32_16x16x32_bf16 v[64:67], a[40:43], v[112:115], v[64:67]
    v_mfma_f32_16x16x32_bf16 v[68:71], a[120:123], v[112:115], v[68:71]
    v_mfma_f32_16x16x32_bf16 v[72:75], a[200:203], v[112:115], v[72:75]
    v_mfma_f32_16x16x32_bf16 v[76:79], v[216:219], v[112:115], v[76:79]
    v_mfma_f32_16x16x32_bf16 v[80:83], a[40:43], v[116:119], v[80:83]
    v_mfma_f32_16x16x32_bf16 v[84:87], a[120:123], v[116:119], v[84:87]
    v_mfma_f32_16x16x32_bf16 v[88:91], a[200:203], v[116:119], v[88:91]
    v_mfma_f32_16x16x32_bf16 v[92:95], v[216:219], v[116:119], v[92:95]
    ds_read_b64_tr_b16 v[112:113], v10 offset:28672
    ds_read_b64_tr_b16 v[114:115], v10 offset:28928
    ds_read_b64_tr_b16 v[116:117], v11 offset:28672
    ds_read_b64_tr_b16 v[118:119], v11 offset:28928
    s_waitcnt lgkmcnt(12)
    v_mfma_f32_16x16x32_bf16 v[64:67], a[44:47], v[120:123], v[64:67]
    v_mfma_f32_16x16x32_bf16 v[68:71], a[124:127], v[120:123], v[68:71]
    v_mfma_f32_16x16x32_bf16 v[72:75], a[204:207], v[120:123], v[72:75]
    v_mfma_f32_16x16x32_bf16 v[76:79], v[220:223], v[120:123], v[76:79]
    v_mfma_f32_16x16x32_bf16 v[80:83], a[44:47], v[124:127], v[80:83]
    v_mfma_f32_16x16x32_bf16 v[84:87], a[124:127], v[124:127], v[84:87]
    v_mfma_f32_16x16x32_bf16 v[88:91], a[204:207], v[124:127], v[88:91]
    v_mfma_f32_16x16x32_bf16 v[92:95], v[220:223], v[124:127], v[92:95]
    ds_read_b64_tr_b16 v[120:121], v10 offset:30720
    ds_read_b64_tr_b16 v[122:123], v10 offset:30976
    ds_read_b64_tr_b16 v[124:125], v11 offset:30720
    ds_read_b64_tr_b16 v[126:127], v11 offset:30976
    s_waitcnt lgkmcnt(12)
    v_mfma_f32_16x16x32_bf16 v[64:67], a[48:51], v[96:99], v[64:67]
    v_mfma_f32_16x16x32_bf16 v[68:71], a[128:131], v[96:99], v[68:71]
    v_mfma_f32_16x16x32_bf16 v[72:75], a[208:211], v[96:99], v[72:75]
    v_mfma_f32_16x16x32_bf16 v[76:79], v[224:227], v[96:99], v[76:79]
    v_mfma_f32_16x16x32_bf16 v[80:83], a[48:51], v[100:103], v[80:83]
    v_mfma_f32_16x16x32_bf16 v[84:87], a[128:131], v[100:103], v[84:87]
    v_mfma_f32_16x16x32_bf16 v[88:91], a[208:211], v[100:103], v[88:91]
    v_mfma_f32_16x16x32_bf16 v[92:95], v[224:227], v[100:103], v[92:95]
    ds_read_b64_tr_b16 v[96:97], v10 offset:32768
    ds_read_b64_tr_b16 v[98:99], v10 offset:33024
    ds_read_b64_tr_b16 v[100:101], v11 offset:32768
    ds_read_b64_tr_b16 v[102:103], v11 offset:33024
    s_waitcnt lgkmcnt(12)
    v_mfma_f32_16x16x32_bf16 v[64:67], a[52:55], v[104:107], v[64:67]
    v_mfma_f32_16x16x32_bf16 v[68:71], a[132:135], v[104:107], v[68:71]
    v_mfma_f32_16x16x32_bf16 v[72:75], a[212:215], v[104:107], v[72:75]
    v_mfma_f32_16x16x32_bf16 v[76:79], v[228:231], v[104:107], v[76:79]
    v_mfma_f32_16x16x32_bf16 v[80:83], a[52:55], v[108:111], v[80:83]
    v_mfma_f32_16x16x32_bf16 v[84:87], a[132:135], v[108:111], v[84:87]
    v_mfma_f32_16x16x32_bf16 v[88:91], a[212:215], v[108:111], v[88:91]
    v_mfma_f32_16x16x32_bf16 v[92:95], v[228:231], v[108:111], v[92:95]
    ds_read_b64_tr_b16 v[104:105], v10 offset:34816
    ds_read_b64_tr_b16 v[106:107], v10 offset:35072
    ds_read_b64_tr_b16 v[108:109], v11 offset:34816
    ds_read_b64_tr_b16 v[110:111], v11 offset:35072
    s_waitcnt lgkmcnt(12)
    v_mfma_f32_16x16x32_bf16 v[64:67], a[56:59], v[112:115], v[64:67]
    v_mfma_f32_16x16x32_bf16 v[68:71], a[136:139], v[112:115], v[68:71]
    v_mfma_f32_16x16x32_bf16 v[72:75], a[216:219], v[112:115], v[72:75]
    v_mfma_f32_16x16x32_bf16 v[76:79], v[232:235], v[112:115], v[76:79]
    v_mfma_f32_16x16x32_bf16 v[80:83], a[56:59], v[116:119], v[80:83]
    v_mfma_f32_16x16x32_bf16 v[84:87], a[136:139], v[116:119], v[84:87]
    v_mfma_f32_16x16x32_bf16 v[88:91], a[216:219], v[116:119], v[88:91]
    v_mfma_f32_16x16x32_bf16 v[92:95], v[232:235], v[116:119], v[92:95]
    ds_read_b64_tr_b16 v[112:113], v10 offset:36864
    ds_read_b64_tr_b16 v[114:115], v10 offset:37120
    ds_read_b64_tr_b16 v[116:117], v11 offset:36864
    ds_read_b64_tr_b16 v[118:119], v11 offset:37120
    s_waitcnt lgkmcnt(12)
    v_mfma_f32_16x16x32_bf16 v[64:67], a[60:63], v[120:123], v[64:67]
    v_mfma_f32_16x16x32_bf16 v[68:71], a[140:143], v[120:123], v[68:71]
    v_mfma_f32_16x16x32_bf16 v[72:75], a[220:223], v[120:123], v[72:75]
    v_mfma_f32_16x16x32_bf16 v[76:79], v[236:239], v[120:123], v[76:79]
    v_mfma_f32_16x16x32_bf16 v[80:83], a[60:63], v[124:127], v[80:83]
    v_mfma_f32_16x16x32_bf16 v[84:87], a[140:143], v[124:127], v[84:87]
    v_mfma_f32_16x16x32_bf16 v[88:91], a[220:223], v[124:127], v[88:91]
    v_mfma_f32_16x16x32_bf16 v[92:95], v[236:239], v[124:127], v[92:95]
    ds_read_b64_tr_b16 v[120:121], v10 offset:38912
    ds_read_b64_tr_b16 v[122:123], v10 offset:39168
    ds_read_b64_tr_b16 v[124:125], v11 offset:38912
    ds_read_b64_tr_b16 v[126:127], v11 offset:39168
    s_waitcnt lgkmcnt(12)
    v_mfma_f32_16x16x32_bf16 v[64:67], a[64:67], v[96:99], v[64:67]
    v_mfma_f32_16x16x32_bf16 v[68:71], a[144:147], v[96:99], v[68:71]
    v_mfma_f32_16x16x32_bf16 v[72:75], a[224:227], v[96:99], v[72:75]
    v_mfma_f32_16x16x32_bf16 v[76:79], v[240:243], v[96:99], v[76:79]
    v_mfma_f32_16x16x32_bf16 v[80:83], a[64:67], v[100:103], v[80:83]
    v_mfma_f32_16x16x32_bf16 v[84:87], a[144:147], v[100:103], v[84:87]
    v_mfma_f32_16x16x32_bf16 v[88:91], a[224:227], v[100:103], v[88:91]
    v_mfma_f32_16x16x32_bf16 v[92:95], v[240:243], v[100:103], v[92:95]
    s_waitcnt lgkmcnt(8)
    v_mfma_f32_16x16x32_bf16 v[64:67], a[68:71], v[104:107], v[64:67]
    v_mfma_f32_16x16x32_bf16 v[68:71], a[148:151], v[104:107], v[68:71]
    v_mfma_f32_16x16x32_bf16 v[72:75], a[228:231], v[104:107], v[72:75]
    v_mfma_f32_16x16x32_bf16 v[76:79], v[244:247], v[104:107], v[76:79]
    v_mfma_f32_16x16x32_bf16 v[80:83], a[68:71], v[108:111], v[80:83]
    v_mfma_f32_16x16x32_bf16 v[84:87], a[148:151], v[108:111], v[84:87]
    v_mfma_f32_16x16x32_bf16 v[88:91], a[228:231], v[108:111], v[88:91]
    v_mfma_f32_16x16x32_bf16 v[92:95], v[244:247], v[108:111], v[92:95]
    s_waitcnt lgkmcnt(4)
    v_mfma_f32_16x16x32_bf16 v[64:67], a[72:75], v[112:115], v[64:67]
    v_mfma_f32_16x16x32_bf16 v[68:71], a[152:155], v[112:115], v[68:71]
    v_mfma_f32_16x16x32_bf16 v[72:75], a[232:235], v[112:115], v[72:75]
    v_mfma_f32_16x16x32_bf16 v[76:79], v[248:251], v[112:115], v[76:79]
    v_mfma_f32_16x16x32_bf16 v[80:83], a[72:75], v[116:119], v[80:83]
    v_mfma_f32_16x16x32_bf16 v[84:87], a[152:155], v[116:119], v[84:87]
    v_mfma_f32_16x16x32_bf16 v[88:91], a[232:235], v[116:119], v[88:91]
    v_mfma_f32_16x16x32_bf16 v[92:95], v[248:251], v[116:119], v[92:95]
    s_waitcnt lgkmcnt(0)
    v_mfma_f32_16x16x32_bf16 v[64:67], a[76:79], v[120:123], v[64:67]
    v_mfma_f32_16x16x32_bf16 v[68:71], a[156:159], v[120:123], v[68:71]
    v_mfma_f32_16x16x32_bf16 v[72:75], a[236:239], v[120:123], v[72:75]
    v_mfma_f32_16x16x32_bf16 v[76:79], v[252:255], v[120:123], v[76:79]
    v_mfma_f32_16x16x32_bf16 v[80:83], a[76:79], v[124:127], v[80:83]
    v_mfma_f32_16x16x32_bf16 v[84:87], a[156:159], v[124:127], v[84:87]
    v_mfma_f32_16x16x32_bf16 v[88:91], a[236:239], v[124:127], v[88:91]
    v_mfma_f32_16x16x32_bf16 v[92:95], v[252:255], v[124:127], v[92:95]
L_chh_cd:
    s_add_u32 s41, s37, 2
    s_cmp_lt_u32 s41, s28
    s_cbranch_scc1 L_chh_w10
    s_waitcnt vmcnt(0)
    s_branch L_chh_w
L_chh_w10:
    s_waitcnt vmcnt(10)
L_chh_w:
    s_nop 7
    s_cmp_eq_u32 s19, 3
    s_cbranch_scc1 L_chh_effn
    s_cmp_eq_u32 s19, 2
    s_cbranch_scc1 L_chh_ev
    s_add_u32 s41, s29, s37
    s_lshr_b32 s42, s41, 2
    s_lshl_b32 s42, s42, 13
    s_and_b32 s41, s41, 3
    s_lshl_b32 s41, s41, 10
    s_add_u32 s41, s41, s42
    s_add_u32 s41, s41, s38
    v_cvt_pk_bf16_f32 v144, v64, v65
    v_cvt_pk_bf16_f32 v145, v66, v67
    v_cvt_pk_bf16_f32 v146, v80, v81
    v_cvt_pk_bf16_f32 v147, v82, v83
    s_add_u32 s42, s41, 0
    buffer_store_dwordx4 v[144:147], v8, s[8:11], s42 offen sc1
    v_cvt_pk_bf16_f32 v148, v68, v69
    v_cvt_pk_bf16_f32 v149, v70, v71
    v_cvt_pk_bf16_f32 v150, v84, v85
    v_cvt_pk_bf16_f32 v151, v86, v87
    s_add_u32 s42, s41, 4096
    buffer_store_dwordx4 v[148:151], v8, s[8:11], s42 offen sc1
    v_cvt_pk_bf16_f32 v152, v72, v73
    v_cvt_pk_bf16_f32 v153, v74, v75
    v_cvt_pk_bf16_f32 v154, v88, v89
    v_cvt_pk_bf16_f32 v155, v90, v91
    s_add_u32 s42, s41, 262144
    buffer_store_dwordx4 v[152:155], v8, s[8:11], s42 offen sc1
    v_cvt_pk_bf16_f32 v156, v76, v77
    v_cvt_pk_bf16_f32 v157, v78, v79
    v_cvt_pk_bf16_f32 v158, v92, v93
    v_cvt_pk_bf16_f32 v159, v94, v95
    s_add_u32 s42, s41, 266240
    buffer_store_dwordx4 v[156:159], v8, s[8:11], s42 offen sc1
    s_branch L_chh_ed
L_chh_ev:
    s_add_u32 s41, s29, s37
    s_lshl_b32 s41, s41, 11
    s_add_u32 s41, s41, s38
    v_cvt_pk_bf16_f32 v144, v64, v65
    v_cvt_pk_bf16_f32 v145, v66, v67
    v_cvt_pk_bf16_f32 v146, v68, v69
    v_cvt_pk_bf16_f32 v147, v70, v71
    s_add_u32 s42, s41, 0
    buffer_store_dwordx4 v[144:147], v8, s[8:11], s42 offen offset:0 sc1
    v_cvt_pk_bf16_f32 v148, v72, v73
    v_cvt_pk_bf16_f32 v149, v74, v75
    v_cvt_pk_bf16_f32 v150, v76, v77
    v_cvt_pk_bf16_f32 v151, v78, v79
    s_add_u32 s42, s41, 262144
    buffer_store_dwordx4 v[148:151], v8, s[8:11], s42 offen offset:0 sc1
    v_cvt_pk_bf16_f32 v152, v80, v81
    v_cvt_pk_bf16_f32 v153, v82, v83
    v_cvt_pk_bf16_f32 v154, v84, v85
    v_cvt_pk_bf16_f32 v155, v86, v87
    s_add_u32 s42, s41, 0
    buffer_store_dwordx4 v[152:155], v8, s[8:11], s42 offen offset:1024 sc1
    v_cvt_pk_bf16_f32 v156, v88, v89
    v_cvt_pk_bf16_f32 v157, v90, v91
    v_cvt_pk_bf16_f32 v158, v92, v93
    v_cvt_pk_bf16_f32 v159, v94, v95
    s_add_u32 s42, s41, 262144
    buffer_store_dwordx4 v[156:159], v8, s[8:11], s42 offen offset:1024 sc1
    s_branch L_chh_ed
L_chh_effn:
    s_and_b32 s41, s37, 1
    s_cmp_eq_u32 s41, 1
    s_cbranch_scc1 L_chh_eup
    v_cvt_pk_bf16_f32 v128, v64, v65
    v_cvt_pk_bf16_f32 v129, v66, v67
    v_cvt_pk_bf16_f32 v130, v68, v69
    v_cvt_pk_bf16_f32 v131, v70, v71
    v_cvt_pk_bf16_f32 v132, v72, v73
    v_cvt_pk_bf16_f32 v133, v74, v75
    v_cvt_pk_bf16_f32 v134, v76, v77
    v_cvt_pk_bf16_f32 v135, v78, v79
    v_cvt_pk_bf16_f32 v136, v80, v81
    v_cvt_pk_bf16_f32 v137, v82, v83
    v_cvt_pk_bf16_f32 v138, v84, v85
    v_cvt_pk_bf16_f32 v139, v86, v87
    v_cvt_pk_bf16_f32 v140, v88, v89
    v_cvt_pk_bf16_f32 v141, v90, v91
    v_cvt_pk_bf16_f32 v142, v92, v93
    v_cvt_pk_bf16_f32 v143, v94, v95
    s_branch L_chh_ed
L_chh_eup:
    v_mov_b32 v20, 0xc0135761
    v_mov_b32 v21, 0xbdd2d3e8
    v_mov_b32 v22, 0xffff0000
    s_lshr_b32 s41, s37, 1
    s_add_u32 s41, s41, s29
    s_lshl_b32 s41, s41, 10
    s_add_u32 s41, s41, s40
    v_cvt_pk_bf16_f32 v160, v64, v65
    v_cvt_pk_bf16_f32 v161, v66, v67
    v_lshlrev_b32 v164, 16, v128
    v_lshlrev_b32 v168, 16, v160
    v_and_b32 v165, v22, v128
    v_and_b32 v169, v22, v160
    v_lshlrev_b32 v166, 16, v129
    v_lshlrev_b32 v170, 16, v161
    v_and_b32 v167, v22, v129
    v_and_b32 v171, v22, v161
    v_mul_f32 v172, v164, v164
    v_fma_f32 v172, v172, v21, v20
    v_mul_f32 v172, v172, v164
    v_mul_f32 v173, v165, v165
    v_fma_f32 v173, v173, v21, v20
    v_mul_f32 v173, v173, v165
    v_mul_f32 v174, v166, v166
    v_fma_f32 v174, v174, v21, v20
    v_mul_f32 v174, v174, v166
    v_mul_f32 v175, v167, v167
    v_fma_f32 v175, v175, v21, v20
    v_mul_f32 v175, v175, v167
    v_exp_f32 v172, v172
    v_exp_f32 v173, v173
    v_exp_f32 v174, v174
    v_exp_f32 v175, v175
    v_add_f32 v172, 1.0, v172
    v_add_f32 v173, 1.0, v173
    v_add_f32 v174, 1.0, v174
    v_add_f32 v175, 1.0, v175
    v_rcp_f32 v172, v172
    v_rcp_f32 v173, v173
    v_rcp_f32 v174, v174
    v_rcp_f32 v175, v175
    s_nop 0
    v_mul_f32 v172, v172, v164
    v_mul_f32 v173, v173, v165
    v_mul_f32 v174, v174, v166
    v_mul_f32 v175, v175, v167
    v_cvt_pk_bf16_f32 v164, v172, v173
    v_cvt_pk_bf16_f32 v165, v174, v175
    v_lshlrev_b32 v172, 16, v164
    v_and_b32 v173, v22, v164
    v_lshlrev_b32 v174, 16, v165
    v_and_b32 v175, v22, v165
    v_mul_f32 v172, v172, v168
    v_mul_f32 v173, v173, v169
    v_mul_f32 v174, v174, v170
    v_mul_f32 v175, v175, v171
    v_cvt_pk_bf16_f32 v144, v172, v173
    v_cvt_pk_bf16_f32 v145, v174, v175
    v_cvt_pk_bf16_f32 v160, v68, v69
    v_cvt_pk_bf16_f32 v161, v70, v71
    v_lshlrev_b32 v164, 16, v130
    v_lshlrev_b32 v168, 16, v160
    v_and_b32 v165, v22, v130
    v_and_b32 v169, v22, v160
    v_lshlrev_b32 v166, 16, v131
    v_lshlrev_b32 v170, 16, v161
    v_and_b32 v167, v22, v131
    v_and_b32 v171, v22, v161
    v_mul_f32 v172, v164, v164
    v_fma_f32 v172, v172, v21, v20
    v_mul_f32 v172, v172, v164
    v_mul_f32 v173, v165, v165
    v_fma_f32 v173, v173, v21, v20
    v_mul_f32 v173, v173, v165
    v_mul_f32 v174, v166, v166
    v_fma_f32 v174, v174, v21, v20
    v_mul_f32 v174, v174, v166
    v_mul_f32 v175, v167, v167
    v_fma_f32 v175, v175, v21, v20
    v_mul_f32 v175, v175, v167
    v_exp_f32 v172, v172
    v_exp_f32 v173, v173
    v_exp_f32 v174, v174
    v_exp_f32 v175, v175
    v_add_f32 v172, 1.0, v172
    v_add_f32 v173, 1.0, v173
    v_add_f32 v174, 1.0, v174
    v_add_f32 v175, 1.0, v175
    v_rcp_f32 v172, v172
    v_rcp_f32 v173, v173
    v_rcp_f32 v174, v174
    v_rcp_f32 v175, v175
    s_nop 0
    v_mul_f32 v172, v172, v164
    v_mul_f32 v173, v173, v165
    v_mul_f32 v174, v174, v166
    v_mul_f32 v175, v175, v167
    v_cvt_pk_bf16_f32 v164, v172, v173
    v_cvt_pk_bf16_f32 v165, v174, v175
    v_lshlrev_b32 v172, 16, v164
    v_and_b32 v173, v22, v164
    v_lshlrev_b32 v174, 16, v165
    v_and_b32 v175, v22, v165
    v_mul_f32 v172, v172, v168
    v_mul_f32 v173, v173, v169
    v_mul_f32 v174, v174, v170
    v_mul_f32 v175, v175, v171
    v_cvt_pk_bf16_f32 v148, v172, v173
    v_cvt_pk_bf16_f32 v149, v174, v175
    v_cvt_pk_bf16_f32 v160, v72, v73
    v_cvt_pk_bf16_f32 v161, v74, v75
    v_lshlrev_b32 v164, 16, v132
    v_lshlrev_b32 v168, 16, v160
    v_and_b32 v165, v22, v132
    v_and_b32 v169, v22, v160
    v_lshlrev_b32 v166, 16, v133
    v_lshlrev_b32 v170, 16, v161
    v_and_b32 v167, v22, v133
    v_and_b32 v171, v22, v161
    v_mul_f32 v172, v164, v164
    v_fma_f32 v172, v172, v21, v20
    v_mul_f32 v172, v172, v164
    v_mul_f32 v173, v165, v165
    v_fma_f32 v173, v173, v21, v20
    v_mul_f32 v173, v173, v165
    v_mul_f32 v174, v166, v166
    v_fma_f32 v174, v174, v21, v20
    v_mul_f32 v174, v174, v166
    v_mul_f32 v175, v167, v167
    v_fma_f32 v175, v175, v21, v20
    v_mul_f32 v175, v175, v167
    v_exp_f32 v172, v172
    v_exp_f32 v173, v173
    v_exp_f32 v174, v174
    v_exp_f32 v175, v175
    v_add_f32 v172, 1.0, v172
    v_add_f32 v173, 1.0, v173
    v_add_f32 v174, 1.0, v174
    v_add_f32 v175, 1.0, v175
    v_rcp_f32 v172, v172
    v_rcp_f32 v173, v173
    v_rcp_f32 v174, v174
    v_rcp_f32 v175, v175
    s_nop 0
    v_mul_f32 v172, v172, v164
    v_mul_f32 v173, v173, v165
    v_mul_f32 v174, v174, v166
    v_mul_f32 v175, v175, v167
    v_cvt_pk_bf16_f32 v164, v172, v173
    v_cvt_pk_bf16_f32 v165, v174, v175
    v_lshlrev_b32 v172, 16, v164
    v_and_b32 v173, v22, v164
    v_lshlrev_b32 v174, 16, v165
    v_and_b32 v175, v22, v165
    v_mul_f32 v172, v172, v168
    v_mul_f32 v173, v173, v169
    v_mul_f32 v174, v174, v170
    v_mul_f32 v175, v175, v171
    v_cvt_pk_bf16_f32 v152, v172, v173
    v_cvt_pk_bf16_f32 v153, v174, v175
    v_cvt_pk_bf16_f32 v160, v76, v77
    v_cvt_pk_bf16_f32 v161, v78, v79
    v_lshlrev_b32 v164, 16, v134
    v_lshlrev_b32 v168, 16, v160
    v_and_b32 v165, v22, v134
    v_and_b32 v169, v22, v160
    v_lshlrev_b32 v166, 16, v135
    v_lshlrev_b32 v170, 16, v161
    v_and_b32 v167, v22, v135
    v_and_b32 v171, v22, v161
    v_mul_f32 v172, v164, v164
    v_fma_f32 v172, v172, v21, v20
    v_mul_f32 v172, v172, v164
    v_mul_f32 v173, v165, v165
    v_fma_f32 v173, v173, v21, v20
    v_mul_f32 v173, v173, v165
    v_mul_f32 v174, v166, v166
    v_fma_f32 v174, v174, v21, v20
    v_mul_f32 v174, v174, v166
    v_mul_f32 v175, v167, v167
    v_fma_f32 v175, v175, v21, v20
    v_mul_f32 v175, v175, v167
    v_exp_f32 v172, v172
    v_exp_f32 v173, v173
    v_exp_f32 v174, v174
    v_exp_f32 v175, v175
    v_add_f32 v172, 1.0, v172
    v_add_f32 v173, 1.0, v173
    v_add_f32 v174, 1.0, v174
    v_add_f32 v175, 1.0, v175
    v_rcp_f32 v172, v172
    v_rcp_f32 v173, v173
    v_rcp_f32 v174, v174
    v_rcp_f32 v175, v175
    s_nop 0
    v_mul_f32 v172, v172, v164
    v_mul_f32 v173, v173, v165
    v_mul_f32 v174, v174, v166
    v_mul_f32 v175, v175, v167
    v_cvt_pk_bf16_f32 v164, v172, v173
    v_cvt_pk_bf16_f32 v165, v174, v175
    v_lshlrev_b32 v172, 16, v164
    v_and_b32 v173, v22, v164
    v_lshlrev_b32 v174, 16, v165
    v_and_b32 v175, v22, v165
    v_mul_f32 v172, v172, v168
    v_mul_f32 v173, v173, v169
    v_mul_f32 v174, v174, v170
    v_mul_f32 v175, v175, v171
    v_cvt_pk_bf16_f32 v156, v172, v173
    v_cvt_pk_bf16_f32 v157, v174, v175
    v_cvt_pk_bf16_f32 v160, v80, v81
    v_cvt_pk_bf16_f32 v161, v82, v83
    v_lshlrev_b32 v164, 16, v136
    v_lshlrev_b32 v168, 16, v160
    v_and_b32 v165, v22, v136
    v_and_b32 v169, v22, v160
    v_lshlrev_b32 v166, 16, v137
    v_lshlrev_b32 v170, 16, v161
    v_and_b32 v167, v22, v137
    v_and_b32 v171, v22, v161
    v_mul_f32 v172, v164, v164
    v_fma_f32 v172, v172, v21, v20
    v_mul_f32 v172, v172, v164
    v_mul_f32 v173, v165, v165
    v_fma_f32 v173, v173, v21, v20
    v_mul_f32 v173, v173, v165
    v_mul_f32 v174, v166, v166
    v_fma_f32 v174, v174, v21, v20
    v_mul_f32 v174, v174, v166
    v_mul_f32 v175, v167, v167
    v_fma_f32 v175, v175, v21, v20
    v_mul_f32 v175, v175, v167
    v_exp_f32 v172, v172
    v_exp_f32 v173, v173
    v_exp_f32 v174, v174
    v_exp_f32 v175, v175
    v_add_f32 v172, 1.0, v172
    v_add_f32 v173, 1.0, v173
    v_add_f32 v174, 1.0, v174
    v_add_f32 v175, 1.0, v175
    v_rcp_f32 v172, v172
    v_rcp_f32 v173, v173
    v_rcp_f32 v174, v174
    v_rcp_f32 v175, v175
    s_nop 0
    v_mul_f32 v172, v172, v164
    v_mul_f32 v173, v173, v165
    v_mul_f32 v174, v174, v166
    v_mul_f32 v175, v175, v167
    v_cvt_pk_bf16_f32 v164, v172, v173
    v_cvt_pk_bf16_f32 v165, v174, v175
    v_lshlrev_b32 v172, 16, v164
    v_and_b32 v173, v22, v164
    v_lshlrev_b32 v174, 16, v165
    v_and_b32 v175, v22, v165
    v_mul_f32 v172, v172, v168
    v_mul_f32 v173, v173, v169
    v_mul_f32 v174, v174, v170
    v_mul_f32 v175, v175, v171
    v_cvt_pk_bf16_f32 v146, v172, v173
    v_cvt_pk_bf16_f32 v147, v174, v175
    v_cvt_pk_bf16_f32 v160, v84, v85
    v_cvt_pk_bf16_f32 v161, v86, v87
    v_lshlrev_b32 v164, 16, v138
    v_lshlrev_b32 v168, 16, v160
    v_and_b32 v165, v22, v138
    v_and_b32 v169, v22, v160
    v_lshlrev_b32 v166, 16, v139
    v_lshlrev_b32 v170, 16, v161
    v_and_b32 v167, v22, v139
    v_and_b32 v171, v22, v161
    v_mul_f32 v172, v164, v164
    v_fma_f32 v172, v172, v21, v20
    v_mul_f32 v172, v172, v164
    v_mul_f32 v173, v165, v165
    v_fma_f32 v173, v173, v21, v20
    v_mul_f32 v173, v173, v165
    v_mul_f32 v174, v166, v166
    v_fma_f32 v174, v174, v21, v20
    v_mul_f32 v174, v174, v166
    v_mul_f32 v175, v167, v167
    v_fma_f32 v175, v175, v21, v20
    v_mul_f32 v175, v175, v167
    v_exp_f32 v172, v172
    v_exp_f32 v173, v173
    v_exp_f32 v174, v174
    v_exp_f32 v175, v175
    v_add_f32 v172, 1.0, v172
    v_add_f32 v173, 1.0, v173
    v_add_f32 v174, 1.0, v174
    v_add_f32 v175, 1.0, v175
    v_rcp_f32 v172, v172
    v_rcp_f32 v173, v173
    v_rcp_f32 v174, v174
    v_rcp_f32 v175, v175
    s_nop 0
    v_mul_f32 v172, v172, v164
    v_mul_f32 v173, v173, v165
    v_mul_f32 v174, v174, v166
    v_mul_f32 v175, v175, v167
    v_cvt_pk_bf16_f32 v164, v172, v173
    v_cvt_pk_bf16_f32 v165, v174, v175
    v_lshlrev_b32 v172, 16, v164
    v_and_b32 v173, v22, v164
    v_lshlrev_b32 v174, 16, v165
    v_and_b32 v175, v22, v165
    v_mul_f32 v172, v172, v168
    v_mul_f32 v173, v173, v169
    v_mul_f32 v174, v174, v170
    v_mul_f32 v175, v175, v171
    v_cvt_pk_bf16_f32 v150, v172, v173
    v_cvt_pk_bf16_f32 v151, v174, v175
    v_cvt_pk_bf16_f32 v160, v88, v89
    v_cvt_pk_bf16_f32 v161, v90, v91
    v_lshlrev_b32 v164, 16, v140
    v_lshlrev_b32 v168, 16, v160
    v_and_b32 v165, v22, v140
    v_and_b32 v169, v22, v160
    v_lshlrev_b32 v166, 16, v141
    v_lshlrev_b32 v170, 16, v161
    v_and_b32 v167, v22, v141
    v_and_b32 v171, v22, v161
    v_mul_f32 v172, v164, v164
    v_fma_f32 v172, v172, v21, v20
    v_mul_f32 v172, v172, v164
    v_mul_f32 v173, v165, v165
    v_fma_f32 v173, v173, v21, v20
    v_mul_f32 v173, v173, v165
    v_mul_f32 v174, v166, v166
    v_fma_f32 v174, v174, v21, v20
    v_mul_f32 v174, v174, v166
    v_mul_f32 v175, v167, v167
    v_fma_f32 v175, v175, v21, v20
    v_mul_f32 v175, v175, v167
    v_exp_f32 v172, v172
    v_exp_f32 v173, v173
    v_exp_f32 v174, v174
    v_exp_f32 v175, v175
    v_add_f32 v172, 1.0, v172
    v_add_f32 v173, 1.0, v173
    v_add_f32 v174, 1.0, v174
    v_add_f32 v175, 1.0, v175
    v_rcp_f32 v172, v172
    v_rcp_f32 v173, v173
    v_rcp_f32 v174, v174
    v_rcp_f32 v175, v175
    s_nop 0
    v_mul_f32 v172, v172, v164
    v_mul_f32 v173, v173, v165
    v_mul_f32 v174, v174, v166
    v_mul_f32 v175, v175, v167
    v_cvt_pk_bf16_f32 v164, v172, v173
    v_cvt_pk_bf16_f32 v165, v174, v175
    v_lshlrev_b32 v172, 16, v164
    v_and_b32 v173, v22, v164
    v_lshlrev_b32 v174, 16, v165
    v_and_b32 v175, v22, v165
    v_mul_f32 v172, v172, v168
    v_mul_f32 v173, v173, v169
    v_mul_f32 v174, v174, v170
    v_mul_f32 v175, v175, v171
    v_cvt_pk_bf16_f32 v154, v172, v173
    v_cvt_pk_bf16_f32 v155, v174, v175
    v_cvt_pk_bf16_f32 v160, v92, v93
    v_cvt_pk_bf16_f32 v161, v94, v95
    v_lshlrev_b32 v164, 16, v142
    v_lshlrev_b32 v168, 16, v160
    v_and_b32 v165, v22, v142
    v_and_b32 v169, v22, v160
    v_lshlrev_b32 v166, 16, v143
    v_lshlrev_b32 v170, 16, v161
    v_and_b32 v167, v22, v143
    v_and_b32 v171, v22, v161
    v_mul_f32 v172, v164, v164
    v_fma_f32 v172, v172, v21, v20
    v_mul_f32 v172, v172, v164
    v_mul_f32 v173, v165, v165
    v_fma_f32 v173, v173, v21, v20
    v_mul_f32 v173, v173, v165
    v_mul_f32 v174, v166, v166
    v_fma_f32 v174, v174, v21, v20
    v_mul_f32 v174, v174, v166
    v_mul_f32 v175, v167, v167
    v_fma_f32 v175, v175, v21, v20
    v_mul_f32 v175, v175, v167
    v_exp_f32 v172, v172
    v_exp_f32 v173, v173
    v_exp_f32 v174, v174
    v_exp_f32 v175, v175
    v_add_f32 v172, 1.0, v172
    v_add_f32 v173, 1.0, v173
    v_add_f32 v174, 1.0, v174
    v_add_f32 v175, 1.0, v175
    v_rcp_f32 v172, v172
    v_rcp_f32 v173, v173
    v_rcp_f32 v174, v174
    v_rcp_f32 v175, v175
    s_nop 0
    v_mul_f32 v172, v172, v164
    v_mul_f32 v173, v173, v165
    v_mul_f32 v174, v174, v166
    v_mul_f32 v175, v175, v167
    v_cvt_pk_bf16_f32 v164, v172, v173
    v_cvt_pk_bf16_f32 v165, v174, v175
    v_lshlrev_b32 v172, 16, v164
    v_and_b32 v173, v22, v164
    v_lshlrev_b32 v174, 16, v165
    v_and_b32 v175, v22, v165
    v_mul_f32 v172, v172, v168
    v_mul_f32 v173, v173, v169
    v_mul_f32 v174, v174, v170
    v_mul_f32 v175, v175, v171
    v_cvt_pk_bf16_f32 v158, v172, v173
    v_cvt_pk_bf16_f32 v159, v174, v175
    s_add_u32 s42, s41, 0
    buffer_store_dwordx4 v[144:147], v8, s[8:11], s42 offen sc1
    s_add_u32 s42, s41, 55296
    buffer_store_dwordx4 v[148:151], v8, s[8:11], s42 offen sc1
    s_add_u32 s42, s41, 110592
    buffer_store_dwordx4 v[152:155], v8, s[8:11], s42 offen sc1
    s_add_u32 s42, s41, 165888
    buffer_store_dwordx4 v[156:159], v8, s[8:11], s42 offen sc1
L_chh_ed:
    s_barrier
    s_add_u32 s41, s37, 3
    s_cmp_ge_u32 s41, s28
    s_cbranch_scc1 L_chh_noissue
    s_add_u32 s31, s34, s30
    s_mov_b32 m0, s31
    s_mov_b32 s33, s24
    buffer_load_dwordx4 v9, s[56:59], s33 offen offset:0 lds
    s_add_u32 s33, s33, s44
    buffer_load_dwordx4 v9, s[56:59], s33 offen offset:1024 lds
    s_add_u32 s33, s33, s44
    buffer_load_dwordx4 v9, s[56:59], s33 offen offset:2048 lds
    s_add_u32 s33, s33, s44
    buffer_load_dwordx4 v9, s[56:59], s33 offen offset:3072 lds
    s_add_u32 s31, s31, 4096
    s_mov_b32 m0, s31
    s_add_u32 s33, s33, s45
    buffer_load_dwordx4 v9, s[56:59], s33 offen offset:0 lds
    s_add_u32 s33, s33, s44
    buffer_load_dwordx4 v9, s[56:59], s33 offen offset:1024 lds
    s_add_u32 s33, s33, s44
    buffer_load_dwordx4 v9, s[56:59], s33 offen offset:2048 lds
    s_add_u32 s33, s33, s44
    buffer_load_dwordx4 v9, s[56:59], s33 offen offset:3072 lds
    s_add_u32 s31, s31, 4096
    s_mov_b32 m0, s31
    s_add_u32 s33, s33, s45
    buffer_load_dwordx4 v9, s[56:59], s33 offen offset:0 lds
    s_add_u32 s33, s33, s44
    buffer_load_dwordx4 v9, s[56:59], s33 offen offset:1024 lds
    s_add_u32 s33, s24, s27
    s_mov_b32 s24, s25
    s_mov_b32 s25, s33
    s_mov_b64 s[46:47], s[56:57]
    s_mov_b64 s[56:57], s[60:61]
    s_mov_b64 s[60:61], s[46:47]
L_chh_noissue:
    s_mov_b32 s41, s34
    s_mov_b32 s34, s35
    s_mov_b32 s35, s36
    s_mov_b32 s36, s41
    s_add_u32 s37, s37, 1
    s_cmp_lt_u32 s37, s28
    s_cbranch_scc1 L_chh_unit
L_ch_hend:
    s_waitcnt vmcnt(0)
    s_barrier
    s_cmp_lg_u32 s16, 0
    s_cbranch_scc1 L_ch_helper
    s_mov_b64 exec, 1
    s_cmp_eq_u32 s55, 0
    s_cbranch_scc1 L_ch_he2
    s_cmp_gt_u32 s55, 2
    s_cbranch_scc1 L_ch_he1
    s_load_dwordx2 s[6:7], s[0:1], 104
    s_waitcnt lgkmcnt(0)
    s_mov_b32 s84, s6
    s_mov_b32 s85, s7
    s_mov_b32 s86, 256
    s_mov_b32 s87, 0x00020000
    s_lshl_b32 s18, s55, 2
    v_mov_b32 v3, 0
    v_mov_b32 v4, 1
    buffer_atomic_add v4, v3, s[84:87], s18 offen offset:132 sc1
    s_cmp_eq_u32 s55, 2
    s_cbranch_scc1 L_ch_he2
    s_mov_b64 exec, -1
    s_branch L_ch_helper
L_ch_he1:
    s_cmp_lg_u32 s94, 0
    s_cbranch_scc1 L_chd_36_d
    s_load_dwordx2 s[6:7], s[0:1], 104
    s_waitcnt lgkmcnt(0)
    s_mov_b32 s84, s6
    s_mov_b32 s85, s7
    s_mov_b32 s86, 256
    s_mov_b32 s87, 0x00020000
L_chd_36:
    v_mov_b32 v3, 0
    buffer_load_dword v4, v3, s[84:87], 0 offen offset:136 sc1
    s_waitcnt vmcnt(0)
    v_readfirstlane_b32 s7, v4
    s_cmp_ge_u32 s7, 52
    s_cbranch_scc1 L_chd_36_s
    s_sleep 8
    s_branch L_chd_36
L_chd_36_s:
    s_mov_b32 s94, 1
    s_lshl_b32 s7, s2, 2
    s_add_u32 s7, s7, 120599552
    v_mov_b32 v4, s93
    buffer_store_dword v4, v3, s[8:11], s7 offen sc1
L_chd_36_d:
    v_mov_b32 v3, 0
    v_mov_b32 v4, 0
    buffer_store_dword v4, v3, s[8:11], s55 offen sc1
L_ch_he2:
    s_cmp_lg_u32 s94, 0
    s_cbranch_scc1 L_chd_37_d
    s_load_dwordx2 s[6:7], s[0:1], 104
    s_waitcnt lgkmcnt(0)
    s_mov_b32 s84, s6
    s_mov_b32 s85, s7
    s_mov_b32 s86, 256
    s_mov_b32 s87, 0x00020000
L_chd_37:
    v_mov_b32 v3, 0
    buffer_load_dword v4, v3, s[84:87], 0 offen offset:136 sc1
    s_waitcnt vmcnt(0)
    v_readfirstlane_b32 s7, v4
    s_cmp_ge_u32 s7, 52
    s_cbranch_scc1 L_chd_37_s
    s_sleep 8
    s_branch L_chd_37
L_chd_37_s:
    s_mov_b32 s94, 1
    s_lshl_b32 s7, s2, 2
    s_add_u32 s7, s7, 120599552
    v_mov_b32 v4, s93
    buffer_store_dword v4, v3, s[8:11], s7 offen sc1
L_chd_37_d:
    s_mov_b64 exec, -1
    s_branch L_ch_helper
L_ch_h2:
    s_cmp_lg_u32 s94, 0
    s_cbranch_scc1 L_chd_38_d
    s_load_dwordx2 s[6:7], s[0:1], 104
    s_waitcnt lgkmcnt(0)
    s_mov_b32 s84, s6
    s_mov_b32 s85, s7
    s_mov_b32 s86, 256
    s_mov_b32 s87, 0x00020000
L_chd_38:
    v_mov_b32 v10, 0
    buffer_load_dword v11, v10, s[84:87], 0 offen offset:136 sc1
    s_waitcnt vmcnt(0)
    v_readfirstlane_b32 s7, v11
    s_cmp_ge_u32 s7, 52
    s_cbranch_scc1 L_chd_38_s
    s_sleep 8
    s_branch L_chd_38
L_chd_38_s:
    s_mov_b32 s94, 1
    s_lshl_b32 s7, s2, 2
    s_add_u32 s7, s7, 120599552
    v_mov_b32 v11, s93
    buffer_store_dword v11, v10, s[8:11], s7 offen sc1
L_chd_38_d:
    s_cmp_ge_u32 s17, 1203
    s_cbranch_scc1 L_ch_done
    s_cmp_lg_u32 s95, 0
    s_cbranch_scc1 L_chd_39_d
    s_load_dwordx2 s[6:7], s[0:1], 104
    s_waitcnt lgkmcnt(0)
    s_mov_b32 s84, s6
    s_mov_b32 s85, s7
    s_mov_b32 s86, 256
    s_mov_b32 s87, 0x00020000
L_chd_39:
    v_mov_b32 v10, 0
    buffer_load_dword v11, v10, s[84:87], 0 offen offset:140 sc1
    s_waitcnt vmcnt(0)
    v_readfirstlane_b32 s7, v11
    s_cmp_ge_u32 s7, 123
    s_cbranch_scc1 L_chd_39_s
    s_sleep 8
    s_branch L_chd_39
L_chd_39_s:
    s_mov_b32 s95, 1
L_chd_39_d:
    s_sub_u32 s17, s17, 399
    s_mul_hi_u32 s53, s17, 0xaaaaaab
    s_mul_i32 s18, s53, 24
    s_sub_u32 s54, s17, s18
    s_cmp_lt_u32 s17, 600
    s_cbranch_scc1 L_ch_h3
    s_sub_u32 s17, s17, 624
    s_cbranch_scc0 L_ch_hl
    s_add_u32 s99, s17, 24
L_ch_hA:
    s_mov_b32 s17, s99
    s_add_u32 s99, s99, 24
    s_cmp_lt_u32 s99, 104
    s_cselect_b32 s99, s99, 0
    s_add_u32 s73, s17, 1203
    s_and_b32 s54, s17, 7
    s_lshr_b32 s72, s17, 3
    s_add_u32 s72, s72, 50
    s_lshr_b32 s53, s72, 1
    s_and_b32 s18, s72, 1
    s_lshl_b32 s18, s18, 3
    s_add_u32 s54, s54, s18
L_ch_h3:
    s_cmp_ge_u32 s54, 16
    s_cbranch_scc1 L_ch_hf
    s_and_b32 s52, s54, 7
    s_lshr_b32 s18, s53, 2
    s_lshl_b32 s18, s18, 3
    s_add_u32 s18, s18, s52
    s_lshl_b32 s18, s18, 2
    s_add_u32 s70, s18, 120595968
L_chw_40:
    v_lshlrev_b32 v10, 2, v0
    v_cmp_gt_u32 vcc, 1, v0
    s_mov_b64 exec, vcc
    buffer_load_dword v11, v10, s[8:11], s70 offen sc1
    s_waitcnt vmcnt(0)
    v_cmp_gt_i32 vcc, 0, v11
    s_mov_b64 exec, -1
    s_cbranch_vccz L_chw_40_d
    s_sleep 16
    s_branch L_chw_40
L_chw_40_d:
    s_lshl_b32 s18, s52, 12
    s_add_u32 s70, s18, 120537088
    s_lshl_b32 s71, s53, 1
    s_lshr_b32 s18, s54, 3
    s_add_u32 s72, s71, s18
    s_sub_i32 s71, s72, 1
    s_max_i32 s71, s71, 0
L_chw_41:
    v_lshlrev_b32 v10, 7, v0
    v_cmp_gt_u32 vcc, 32, v0
    s_mov_b64 exec, vcc
    buffer_load_dword v11, v10, s[8:11], s70 offen sc1
    s_waitcnt vmcnt(0)
    v_cmp_gt_i32 vcc, s71, v11
    s_mov_b64 exec, -1
    s_cbranch_vccz L_chw_41_d
    s_sleep 16
    s_branch L_chw_41
L_chw_41_d:
    s_add_u32 s71, s72, 1
    s_lshl_b32 s17, s72, 5
    s_lshl_b32 s18, s52, 2
    s_add_u32 s17, s17, s18
    s_add_u32 s17, s17, s16
    v_and_b32 v1, 15, v0
    v_lshrrev_b32 v2, 4, v0
    v_lshlrev_b32 v3, 4, v0
    v_lshlrev_b32 v4, 3, v0
    s_lshl_b32 s18, s17, 13
    s_add_u32 s20, s18, 27607040
    s_add_u32 s21, s18, 44384256
    s_add_u32 s22, s18, 61161472
    s_lshl_b32 s18, s17, 12
    s_add_u32 s23, s18, 77938688
    s_add_u32 s24, s18, 86327296
    s_add_u32 s25, s20, 4096
    s_add_u32 s26, s21, 4096
    s_add_u32 s27, s22, 4096
    buffer_load_dwordx4 v[8:11], v3, s[8:11], s20 offen offset:0 sc1
    buffer_load_dwordx4 v[12:15], v3, s[8:11], s20 offen offset:1024 sc1
    buffer_load_dwordx4 v[16:19], v3, s[8:11], s20 offen offset:2048 sc1
    buffer_load_dwordx4 v[20:23], v3, s[8:11], s20 offen offset:3072 sc1
    buffer_load_dwordx4 v[24:27], v3, s[8:11], s25 offen offset:0 sc1
    buffer_load_dwordx4 v[28:31], v3, s[8:11], s25 offen offset:1024 sc1
    buffer_load_dwordx4 v[32:35], v3, s[8:11], s25 offen offset:2048 sc1
    buffer_load_dwordx4 v[36:39], v3, s[8:11], s25 offen offset:3072 sc1
    buffer_load_dwordx4 v[40:43], v3, s[8:11], s21 offen offset:0 sc1
    buffer_load_dwordx4 v[44:47], v3, s[8:11], s21 offen offset:1024 sc1
    buffer_load_dwordx4 v[48:51], v3, s[8:11], s21 offen offset:2048 sc1
    buffer_load_dwordx4 v[52:55], v3, s[8:11], s21 offen offset:3072 sc1
    buffer_load_dwordx4 v[56:59], v3, s[8:11], s26 offen offset:0 sc1
    buffer_load_dwordx4 v[60:63], v3, s[8:11], s26 offen offset:1024 sc1
    buffer_load_dwordx4 v[64:67], v3, s[8:11], s26 offen offset:2048 sc1
    buffer_load_dwordx4 v[68:71], v3, s[8:11], s26 offen offset:3072 sc1
    buffer_load_dwordx4 v[90:93], v3, s[8:11], s22 offen offset:0 sc1
    buffer_load_dwordx4 v[96:99], v3, s[8:11], s22 offen offset:1024 sc1
    buffer_load_dwordx4 v[102:105], v3, s[8:11], s22 offen offset:2048 sc1
    buffer_load_dwordx4 v[108:111], v3, s[8:11], s22 offen offset:3072 sc1
    buffer_load_dwordx4 v[114:117], v3, s[8:11], s27 offen offset:0 sc1
    buffer_load_dwordx4 v[120:123], v3, s[8:11], s27 offen offset:1024 sc1
    buffer_load_dwordx4 v[126:129], v3, s[8:11], s27 offen offset:2048 sc1
    buffer_load_dwordx4 v[132:135], v3, s[8:11], s27 offen offset:3072 sc1
    s_waitcnt vmcnt(8)
    v_mfma_f32_16x16x32_bf16 v[144:147], v[40:43], v[8:11], 0
    v_mfma_f32_16x16x32_bf16 v[152:155], v[40:43], v[24:27], 0
    v_mfma_f32_16x16x32_bf16 v[156:159], v[56:59], v[24:27], 0
    v_mfma_f32_16x16x32_bf16 v[144:147], v[44:47], v[12:15], v[144:147]
    v_mfma_f32_16x16x32_bf16 v[152:155], v[44:47], v[28:31], v[152:155]
    v_mfma_f32_16x16x32_bf16 v[156:159], v[60:63], v[28:31], v[156:159]
    v_mfma_f32_16x16x32_bf16 v[144:147], v[48:51], v[16:19], v[144:147]
    v_mfma_f32_16x16x32_bf16 v[152:155], v[48:51], v[32:35], v[152:155]
    v_mfma_f32_16x16x32_bf16 v[156:159], v[64:67], v[32:35], v[156:159]
    v_mfma_f32_16x16x32_bf16 v[144:147], v[52:55], v[20:23], v[144:147]
    v_mfma_f32_16x16x32_bf16 v[152:155], v[52:55], v[36:39], v[152:155]
    v_mfma_f32_16x16x32_bf16 v[156:159], v[68:71], v[36:39], v[156:159]
L_chw_42:
    v_lshlrev_b32 v5, 7, v0
    v_cmp_gt_u32 vcc, 32, v0
    s_mov_b64 exec, vcc
    buffer_load_dword v6, v5, s[8:11], s70 offen sc1
    s_waitcnt vmcnt(0)
    v_cmp_gt_i32 vcc, s71, v6
    s_mov_b64 exec, -1
    s_cbranch_vccz L_chw_42_d
    s_sleep 4
    s_branch L_chw_42
L_chw_42_d:
    buffer_load_dwordx4 v[72:75], v3, s[8:11], s23 offen offset:0 sc1
    buffer_load_dwordx4 v[76:79], v3, s[8:11], s23 offen offset:1024 sc1
    buffer_load_dwordx4 v[80:83], v3, s[8:11], s23 offen offset:2048 sc1
    buffer_load_dwordx4 v[84:87], v3, s[8:11], s23 offen offset:3072 sc1
    buffer_load_dwordx2 v[88:89], v4, s[8:11], s24 offen offset:0 sc1
    buffer_load_dwordx2 v[94:95], v4, s[8:11], s24 offen offset:512 sc1
    buffer_load_dwordx2 v[100:101], v4, s[8:11], s24 offen offset:1024 sc1
    buffer_load_dwordx2 v[106:107], v4, s[8:11], s24 offen offset:1536 sc1
    buffer_load_dwordx2 v[112:113], v4, s[8:11], s24 offen offset:2048 sc1
    buffer_load_dwordx2 v[118:119], v4, s[8:11], s24 offen offset:2560 sc1
    buffer_load_dwordx2 v[124:125], v4, s[8:11], s24 offen offset:3072 sc1
    buffer_load_dwordx2 v[130:131], v4, s[8:11], s24 offen offset:3584 sc1
    v_mov_b32 v136, 0
    v_mov_b32 v137, 0
    v_cmp_gt_u32 s[28:29], 2, v2
    v_lshlrev_b32 v5, 2, v2
    v_add_u32 v6, 0, v5
    v_cmp_le_u32 s[30:31], v6, v1
    v_add_u32 v6, 1, v5
    v_cmp_le_u32 s[32:33], v6, v1
    v_add_u32 v6, 2, v5
    v_cmp_le_u32 s[34:35], v6, v1
    v_add_u32 v6, 3, v5
    v_cmp_le_u32 s[36:37], v6, v1
    s_lshr_b32 s18, s17, 5
    s_lshl_b32 s18, s18, 18
    s_and_b32 s19, s17, 31
    s_lshl_b32 s19, s19, 12
    s_add_u32 s18, s18, s19
    s_add_u32 s40, s18, 94715904
    s_add_u32 s41, s40, 131072
    s_waitcnt vmcnt(8)
    v_mfma_f32_16x16x32_bf16 v[140:143], v[72:75], v[8:11], 0
    v_mfma_f32_16x16x32_bf16 v[148:151], v[72:75], v[24:27], 0
    v_mfma_f32_16x16x32_bf16 v[140:143], v[76:79], v[12:15], v[140:143]
    v_mfma_f32_16x16x32_bf16 v[148:151], v[76:79], v[28:31], v[148:151]
    v_mfma_f32_16x16x32_bf16 v[140:143], v[80:83], v[16:19], v[140:143]
    v_mfma_f32_16x16x32_bf16 v[148:151], v[80:83], v[32:35], v[148:151]
    v_mfma_f32_16x16x32_bf16 v[140:143], v[84:87], v[20:23], v[140:143]
    v_mfma_f32_16x16x32_bf16 v[148:151], v[84:87], v[36:39], v[148:151]
    v_mov_b32 v188, 0xff800000
    v_mov_b32 v189, 0x3e0293ee
    s_nop 7
    s_nop 3
    v_cndmask_b32 v140, v188, v140, s[28:29]
    v_cndmask_b32 v141, v188, v141, s[28:29]
    v_cndmask_b32 v142, v188, v142, s[28:29]
    v_cndmask_b32 v143, v188, v143, s[28:29]
    v_cndmask_b32 v148, v188, v148, s[28:29]
    v_cndmask_b32 v149, v188, v149, s[28:29]
    v_cndmask_b32 v150, v188, v150, s[28:29]
    v_cndmask_b32 v151, v188, v151, s[28:29]
    v_cndmask_b32 v144, v188, v144, s[30:31]
    v_cndmask_b32 v145, v188, v145, s[32:33]
    v_cndmask_b32 v146, v188, v146, s[34:35]
    v_cndmask_b32 v147, v188, v147, s[36:37]
    v_cndmask_b32 v156, v188, v156, s[30:31]
    v_cndmask_b32 v157, v188, v157, s[32:33]
    v_cndmask_b32 v158, v188, v158, s[34:35]
    v_cndmask_b32 v159, v188, v159, s[36:37]
    v_max_f32 v190, v140, v141
    v_max3_f32 v190, v190, v142, v143
    v_max3_f32 v190, v190, v144, v145
    v_max3_f32 v190, v190, v146, v147
    v_mov_b32 v191, v190
    s_nop 1
    v_permlane16_swap_b32 v190, v191
    v_max_f32 v190, v190, v191
    v_mov_b32 v191, v190
    s_nop 1
    v_permlane32_swap_b32 v190, v191
    v_max_f32 v190, v190, v191
    v_mul_f32 v190, v190, v189
    v_fma_f32 v140, v140, v189, -v190
    v_fma_f32 v141, v141, v189, -v190
    v_fma_f32 v142, v142, v189, -v190
    v_fma_f32 v143, v143, v189, -v190
    v_fma_f32 v144, v144, v189, -v190
    v_fma_f32 v145, v145, v189, -v190
    v_fma_f32 v146, v146, v189, -v190
    v_fma_f32 v147, v147, v189, -v190
    v_exp_f32 v140, v140
    v_exp_f32 v141, v141
    v_exp_f32 v142, v142
    v_exp_f32 v143, v143
    v_exp_f32 v144, v144
    v_exp_f32 v145, v145
    v_exp_f32 v146, v146
    v_exp_f32 v147, v147
    s_nop 0
    v_add_f32 v190, v140, v141
    v_add_f32 v190, v190, v142
    v_add_f32 v190, v190, v143
    v_add_f32 v190, v190, v144
    v_add_f32 v190, v190, v145
    v_add_f32 v190, v190, v146
    v_add_f32 v190, v190, v147
    v_mov_b32 v191, v190
    s_nop 1
    v_permlane16_swap_b32 v190, v191
    v_add_f32 v190, v190, v191
    v_mov_b32 v191, v190
    s_nop 1
    v_permlane32_swap_b32 v190, v191
    v_add_f32 v190, v190, v191
    v_rcp_f32 v190, v190
    s_nop 0
    v_mul_f32 v140, v140, v190
    v_mul_f32 v141, v141, v190
    v_mul_f32 v142, v142, v190
    v_mul_f32 v143, v143, v190
    v_mul_f32 v144, v144, v190
    v_mul_f32 v145, v145, v190
    v_mul_f32 v146, v146, v190
    v_mul_f32 v147, v147, v190
    v_cvt_pk_bf16_f32 v160, v140, v141
    v_cvt_pk_bf16_f32 v161, v142, v143
    v_cvt_pk_bf16_f32 v162, v144, v145
    v_cvt_pk_bf16_f32 v163, v146, v147
    v_max_f32 v192, v148, v149
    v_max3_f32 v192, v192, v150, v151
    v_max3_f32 v192, v192, v152, v153
    v_max3_f32 v192, v192, v154, v155
    v_max3_f32 v192, v192, v156, v157
    v_max3_f32 v192, v192, v158, v159
    v_mov_b32 v193, v192
    s_nop 1
    v_permlane16_swap_b32 v192, v193
    v_max_f32 v192, v192, v193
    v_mov_b32 v193, v192
    s_nop 1
    v_permlane32_swap_b32 v192, v193
    v_max_f32 v192, v192, v193
    v_mul_f32 v192, v192, v189
    v_fma_f32 v148, v148, v189, -v192
    v_fma_f32 v149, v149, v189, -v192
    v_fma_f32 v150, v150, v189, -v192
    v_fma_f32 v151, v151, v189, -v192
    v_fma_f32 v152, v152, v189, -v192
    v_fma_f32 v153, v153, v189, -v192
    v_fma_f32 v154, v154, v189, -v192
    v_fma_f32 v155, v155, v189, -v192
    v_fma_f32 v156, v156, v189, -v192
    v_fma_f32 v157, v157, v189, -v192
    v_fma_f32 v158, v158, v189, -v192
    v_fma_f32 v159, v159, v189, -v192
    v_exp_f32 v148, v148
    v_exp_f32 v149, v149
    v_exp_f32 v150, v150
    v_exp_f32 v151, v151
    v_exp_f32 v152, v152
    v_exp_f32 v153, v153
    v_exp_f32 v154, v154
    v_exp_f32 v155, v155
    v_exp_f32 v156, v156
    v_exp_f32 v157, v157
    v_exp_f32 v158, v158
    v_exp_f32 v159, v159
    s_nop 0
    v_add_f32 v192, v148, v149
    v_add_f32 v192, v192, v150
    v_add_f32 v192, v192, v151
    v_add_f32 v192, v192, v152
    v_add_f32 v192, v192, v153
    v_add_f32 v192, v192, v154
    v_add_f32 v192, v192, v155
    v_add_f32 v192, v192, v156
    v_add_f32 v192, v192, v157
    v_add_f32 v192, v192, v158
    v_add_f32 v192, v192, v159
    v_mov_b32 v193, v192
    s_nop 1
    v_permlane16_swap_b32 v192, v193
    v_add_f32 v192, v192, v193
    v_mov_b32 v193, v192
    s_nop 1
    v_permlane32_swap_b32 v192, v193
    v_add_f32 v192, v192, v193
    v_rcp_f32 v192, v192
    s_nop 0
    v_mul_f32 v148, v148, v192
    v_mul_f32 v149, v149, v192
    v_mul_f32 v150, v150, v192
    v_mul_f32 v151, v151, v192
    v_mul_f32 v152, v152, v192
    v_mul_f32 v153, v153, v192
    v_mul_f32 v154, v154, v192
    v_mul_f32 v155, v155, v192
    v_mul_f32 v156, v156, v192
    v_mul_f32 v157, v157, v192
    v_mul_f32 v158, v158, v192
    v_mul_f32 v159, v159, v192
    v_cvt_pk_bf16_f32 v164, v148, v149
    v_cvt_pk_bf16_f32 v165, v150, v151
    v_cvt_pk_bf16_f32 v166, v152, v153
    v_cvt_pk_bf16_f32 v167, v154, v155
    v_cvt_pk_bf16_f32 v168, v156, v157
    v_cvt_pk_bf16_f32 v169, v158, v159
    v_mov_b32 v170, 0
    v_mov_b32 v171, 0
    s_waitcnt vmcnt(0)
    v_mfma_f32_16x16x32_bf16 v[40:43], v[88:91], v[164:167], 0
    v_mfma_f32_16x16x32_bf16 v[44:47], v[94:97], v[164:167], 0
    v_mfma_f32_16x16x32_bf16 v[40:43], v[92:95], v[168:171], v[40:43]
    v_mfma_f32_16x16x32_bf16 v[44:47], v[98:101], v[168:171], v[44:47]
    v_mfma_f32_16x16x32_bf16 v[48:51], v[100:103], v[164:167], 0
    v_mfma_f32_16x16x32_bf16 v[52:55], v[106:109], v[164:167], 0
    v_mfma_f32_16x16x32_bf16 v[48:51], v[104:107], v[168:171], v[48:51]
    v_mfma_f32_16x16x32_bf16 v[52:55], v[110:113], v[168:171], v[52:55]
    v_mfma_f32_16x16x32_bf16 v[56:59], v[112:115], v[164:167], 0
    v_mfma_f32_16x16x32_bf16 v[60:63], v[118:121], v[164:167], 0
    v_mfma_f32_16x16x32_bf16 v[56:59], v[116:119], v[168:171], v[56:59]
    v_mfma_f32_16x16x32_bf16 v[60:63], v[122:125], v[168:171], v[60:63]
    v_mfma_f32_16x16x32_bf16 v[64:67], v[124:127], v[164:167], 0
    v_mfma_f32_16x16x32_bf16 v[68:71], v[130:133], v[164:167], 0
    v_mfma_f32_16x16x32_bf16 v[64:67], v[128:131], v[168:171], v[64:67]
    v_mfma_f32_16x16x32_bf16 v[68:71], v[134:137], v[168:171], v[68:71]
    v_cvt_pk_bf16_f32 v172, v40, v41
    v_cvt_pk_bf16_f32 v173, v42, v43
    v_cvt_pk_bf16_f32 v174, v44, v45
    v_cvt_pk_bf16_f32 v175, v46, v47
    buffer_store_dwordx4 v[172:175], v3, s[8:11], s41 offen offset:0 sc1
    v_mfma_f32_16x16x32_bf16 v[8:11], v[88:91], v[160:163], 0
    v_mfma_f32_16x16x32_bf16 v[12:15], v[94:97], v[160:163], 0
    v_cvt_pk_bf16_f32 v176, v48, v49
    v_cvt_pk_bf16_f32 v177, v50, v51
    v_cvt_pk_bf16_f32 v178, v52, v53
    v_cvt_pk_bf16_f32 v179, v54, v55
    buffer_store_dwordx4 v[176:179], v3, s[8:11], s41 offen offset:1024 sc1
    v_mfma_f32_16x16x32_bf16 v[16:19], v[100:103], v[160:163], 0
    v_mfma_f32_16x16x32_bf16 v[20:23], v[106:109], v[160:163], 0
    v_cvt_pk_bf16_f32 v180, v56, v57
    v_cvt_pk_bf16_f32 v181, v58, v59
    v_cvt_pk_bf16_f32 v182, v60, v61
    v_cvt_pk_bf16_f32 v183, v62, v63
    buffer_store_dwordx4 v[180:183], v3, s[8:11], s41 offen offset:2048 sc1
    v_mfma_f32_16x16x32_bf16 v[24:27], v[112:115], v[160:163], 0
    v_mfma_f32_16x16x32_bf16 v[28:31], v[118:121], v[160:163], 0
    v_cvt_pk_bf16_f32 v184, v64, v65
    v_cvt_pk_bf16_f32 v185, v66, v67
    v_cvt_pk_bf16_f32 v186, v68, v69
    v_cvt_pk_bf16_f32 v187, v70, v71
    buffer_store_dwordx4 v[184:187], v3, s[8:11], s41 offen offset:3072 sc1
    v_mfma_f32_16x16x32_bf16 v[32:35], v[124:127], v[160:163], 0
    v_mfma_f32_16x16x32_bf16 v[36:39], v[130:133], v[160:163], 0
    v_cvt_pk_bf16_f32 v172, v8, v9
    v_cvt_pk_bf16_f32 v173, v10, v11
    v_cvt_pk_bf16_f32 v174, v12, v13
    v_cvt_pk_bf16_f32 v175, v14, v15
    buffer_store_dwordx4 v[172:175], v3, s[8:11], s40 offen offset:0 sc1
    v_cvt_pk_bf16_f32 v176, v16, v17
    v_cvt_pk_bf16_f32 v177, v18, v19
    v_cvt_pk_bf16_f32 v178, v20, v21
    v_cvt_pk_bf16_f32 v179, v22, v23
    buffer_store_dwordx4 v[176:179], v3, s[8:11], s40 offen offset:1024 sc1
    s_nop 4
    v_cvt_pk_bf16_f32 v180, v24, v25
    v_cvt_pk_bf16_f32 v181, v26, v27
    v_cvt_pk_bf16_f32 v182, v28, v29
    v_cvt_pk_bf16_f32 v183, v30, v31
    buffer_store_dwordx4 v[180:183], v3, s[8:11], s40 offen offset:2048 sc1
    s_nop 1
    v_cvt_pk_bf16_f32 v184, v32, v33
    v_cvt_pk_bf16_f32 v185, v34, v35
    v_cvt_pk_bf16_f32 v186, v36, v37
    v_cvt_pk_bf16_f32 v187, v38, v39
    buffer_store_dwordx4 v[184:187], v3, s[8:11], s40 offen offset:3072 sc1
    s_lshl_b32 s55, s53, 4
    s_add_u32 s55, s55, s54
    s_lshl_b32 s55, s55, 2
    s_add_u32 s55, s55, 120596736
    s_branch L_ch_hend
L_ch_hf:
    s_mul_i32 s71, s53, 3
    s_lshr_b32 s71, s71, 2
    s_add_u32 s71, s71, 34
    s_mov_b32 s70, 120537088
L_chw_43:
    v_lshlrev_b32 v10, 2, v0
    v_cmp_gt_u32 vcc, 1, v0
    s_mov_b64 exec, vcc
    buffer_load_dword v11, v10, s[8:11], s70 offen sc1
    s_waitcnt vmcnt(0)
    v_cmp_gt_i32 vcc, s71, v11
    s_mov_b64 exec, -1
    s_cbranch_vccz L_chw_43_d
    s_sleep 16
    s_branch L_chw_43
L_chw_43_d:
    s_mov_b32 s17, s53
    s_sub_u32 s18, s54, 16
    s_mov_b32 s55, 0
    s_load_dwordx2 s[6:7], s[0:1], 96
    s_waitcnt lgkmcnt(0)
    s_mov_b32 s12, s6
    s_mov_b32 s13, s7
    s_mov_b32 s14, 2621440
    s_mov_b32 s15, 0x00020000
    v_and_b32 v1, 15, v0
    v_lshrrev_b32 v2, 4, v0
    v_lshlrev_b32 v3, 4, v0
    s_lshl_b32 s19, s17, 6
    s_lshl_b32 s20, s16, 4
    s_add_u32 s19, s19, s20
    v_add_u32 v4, s19, v1
    v_lshlrev_b32 v5, 2, v4
    s_mov_b32 s21, 118571008
    buffer_load_dword v7, v5, s[8:11], s21 offen sc1
    v_mul_u32_u24 v4, 1280, v4
    v_lshlrev_b32 v5, 3, v2
    v_add_u32 v4, v4, v5
    s_mul_i32 s22, s18, 160
    s_mul_i32 s23, s16, 20480
    v_add_u32 v5, s23, v3
    s_lshl_b32 s23, s16, 10
    v_add_u32 v6, s23, v3
    v_add_u32 v9, 40960, v6
    s_lshr_b32 s70, s53, 2
    s_lshl_b32 s70, s70, 5
    s_add_u32 s70, s70, 120596224
L_chw_44:
    v_lshlrev_b32 v10, 2, v0
    v_cmp_gt_u32 vcc, 8, v0
    s_mov_b64 exec, vcc
    buffer_load_dword v11, v10, s[8:11], s70 offen sc1
    s_waitcnt vmcnt(0)
    v_cmp_gt_i32 vcc, 0, v11
    s_mov_b64 exec, -1
    s_cbranch_vccz L_chw_44_d
    s_sleep 16
    s_branch L_chw_44
L_chw_44_d:
    s_mul_i32 s24, s18, 276480
    s_add_u32 s24, s24, 25395200
    s_add_u32 s60, s24, 0
    s_add_u32 s61, s24, 55296
    s_add_u32 s62, s24, 110592
    s_add_u32 s63, s24, 165888
    s_add_u32 s64, s24, 221184
    s_mul_i32 s24, s17, 221184
    s_add_u32 s24, s24, 111493120
    s_add_u32 s65, s24, 0
    s_add_u32 s66, s24, 55296
    s_add_u32 s67, s24, 110592
    s_add_u32 s68, s24, 165888
    s_cmp_lt_u32 s16, 2
    s_cselect_b32 s50, 14, 13
    s_lshl_b32 s44, s16, 10
    s_mov_b32 s45, 0
    s_mov_b32 s46, 0
    s_add_u32 s47, s60, s44
    buffer_load_dwordx4 v[32:35], v3, s[8:11], s47 offen
    s_add_u32 s47, s61, s44
    buffer_load_dwordx4 v[36:39], v3, s[8:11], s47 offen
    s_add_u32 s47, s62, s44
    buffer_load_dwordx4 v[40:43], v3, s[8:11], s47 offen
    s_add_u32 s47, s63, s44
    buffer_load_dwordx4 v[44:47], v3, s[8:11], s47 offen
    s_add_u32 s47, s64, s44
    buffer_load_dwordx4 v[48:51], v3, s[8:11], s47 offen
    s_add_u32 s47, s65, s44
    buffer_load_dwordx4 v[52:55], v3, s[8:11], s47 offen sc1
    s_add_u32 s47, s66, s44
    buffer_load_dwordx4 v[56:59], v3, s[8:11], s47 offen sc1
    s_add_u32 s47, s67, s44
    buffer_load_dwordx4 v[60:63], v3, s[8:11], s47 offen sc1
    s_add_u32 s47, s68, s44
    buffer_load_dwordx4 v[64:67], v3, s[8:11], s47 offen sc1
    s_add_u32 s45, s45, 1
    s_cmp_lt_u32 s45, s50
    s_cselect_b32 s47, 4096, 0
    s_add_u32 s44, s44, s47
    s_add_u32 s47, s60, s44
    buffer_load_dwordx4 v[68:71], v3, s[8:11], s47 offen
    s_add_u32 s47, s61, s44
    buffer_load_dwordx4 v[72:75], v3, s[8:11], s47 offen
    s_add_u32 s47, s62, s44
    buffer_load_dwordx4 v[76:79], v3, s[8:11], s47 offen
    s_add_u32 s47, s63, s44
    buffer_load_dwordx4 v[80:83], v3, s[8:11], s47 offen
    s_add_u32 s47, s64, s44
    buffer_load_dwordx4 v[84:87], v3, s[8:11], s47 offen
    s_add_u32 s47, s65, s44
    buffer_load_dwordx4 v[88:91], v3, s[8:11], s47 offen sc1
    s_add_u32 s47, s66, s44
    buffer_load_dwordx4 v[92:95], v3, s[8:11], s47 offen sc1
    s_add_u32 s47, s67, s44
    buffer_load_dwordx4 v[96:99], v3, s[8:11], s47 offen sc1
    s_add_u32 s47, s68, s44
    buffer_load_dwordx4 v[100:103], v3, s[8:11], s47 offen sc1
    s_add_u32 s45, s45, 1
    s_cmp_lt_u32 s45, s50
    s_cselect_b32 s47, 4096, 0
    s_add_u32 s44, s44, s47
    s_add_u32 s47, s60, s44
    buffer_load_dwordx4 v[104:107], v3, s[8:11], s47 offen
    s_add_u32 s47, s61, s44
    buffer_load_dwordx4 v[108:111], v3, s[8:11], s47 offen
    s_add_u32 s47, s62, s44
    buffer_load_dwordx4 v[112:115], v3, s[8:11], s47 offen
    s_add_u32 s47, s63, s44
    buffer_load_dwordx4 v[116:119], v3, s[8:11], s47 offen
    s_add_u32 s47, s64, s44
    buffer_load_dwordx4 v[120:123], v3, s[8:11], s47 offen
    s_add_u32 s47, s65, s44
    buffer_load_dwordx4 v[124:127], v3, s[8:11], s47 offen sc1
    s_add_u32 s47, s66, s44
    buffer_load_dwordx4 v[128:131], v3, s[8:11], s47 offen sc1
    s_add_u32 s47, s67, s44
    buffer_load_dwordx4 v[132:135], v3, s[8:11], s47 offen sc1
    s_add_u32 s47, s68, s44
    buffer_load_dwordx4 v[136:139], v3, s[8:11], s47 offen sc1
    s_add_u32 s45, s45, 1
    s_cmp_lt_u32 s45, s50
    s_cselect_b32 s47, 4096, 0
    s_add_u32 s44, s44, s47
    s_add_u32 s47, s60, s44
    buffer_load_dwordx4 a[0:3], v3, s[8:11], s47 offen
    s_add_u32 s47, s61, s44
    buffer_load_dwordx4 a[4:7], v3, s[8:11], s47 offen
    s_add_u32 s47, s62, s44
    buffer_load_dwordx4 a[8:11], v3, s[8:11], s47 offen
    s_add_u32 s47, s63, s44
    buffer_load_dwordx4 a[12:15], v3, s[8:11], s47 offen
    s_add_u32 s47, s64, s44
    buffer_load_dwordx4 a[16:19], v3, s[8:11], s47 offen
    s_add_u32 s47, s65, s44
    buffer_load_dwordx4 a[20:23], v3, s[8:11], s47 offen sc1
    s_add_u32 s47, s66, s44
    buffer_load_dwordx4 a[24:27], v3, s[8:11], s47 offen sc1
    s_add_u32 s47, s67, s44
    buffer_load_dwordx4 a[28:31], v3, s[8:11], s47 offen sc1
    s_add_u32 s47, s68, s44
    buffer_load_dwordx4 a[32:35], v3, s[8:11], s47 offen sc1
    s_add_u32 s45, s45, 1
    s_cmp_lt_u32 s45, s50
    s_cselect_b32 s47, 4096, 0
    s_add_u32 s44, s44, s47
    s_add_u32 s47, s60, s44
    buffer_load_dwordx4 a[36:39], v3, s[8:11], s47 offen
    s_add_u32 s47, s61, s44
    buffer_load_dwordx4 a[40:43], v3, s[8:11], s47 offen
    s_add_u32 s47, s62, s44
    buffer_load_dwordx4 a[44:47], v3, s[8:11], s47 offen
    s_add_u32 s47, s63, s44
    buffer_load_dwordx4 a[48:51], v3, s[8:11], s47 offen
    s_add_u32 s47, s64, s44
    buffer_load_dwordx4 a[52:55], v3, s[8:11], s47 offen
    s_add_u32 s47, s65, s44
    buffer_load_dwordx4 a[56:59], v3, s[8:11], s47 offen sc1
    s_add_u32 s47, s66, s44
    buffer_load_dwordx4 a[60:63], v3, s[8:11], s47 offen sc1
    s_add_u32 s47, s67, s44
    buffer_load_dwordx4 a[64:67], v3, s[8:11], s47 offen sc1
    s_add_u32 s47, s68, s44
    buffer_load_dwordx4 a[68:71], v3, s[8:11], s47 offen sc1
    s_add_u32 s45, s45, 1
    s_cmp_lt_u32 s45, s50
    s_cselect_b32 s47, 4096, 0
    s_add_u32 s44, s44, s47
    v_mov_b32 v140, 0
    v_mov_b32 v141, 0
    v_mov_b32 v142, 0
    v_mov_b32 v143, 0
    v_mov_b32 v144, 0
    v_mov_b32 v145, 0
    v_mov_b32 v146, 0
    v_mov_b32 v147, 0
    v_mov_b32 v148, 0
    v_mov_b32 v149, 0
    v_mov_b32 v150, 0
    v_mov_b32 v151, 0
    v_mov_b32 v152, 0
    v_mov_b32 v153, 0
    v_mov_b32 v154, 0
    v_mov_b32 v155, 0
    v_mov_b32 v156, 0
    v_mov_b32 v157, 0
    v_mov_b32 v158, 0
    v_mov_b32 v159, 0
    v_mov_b32 v160, 0
    v_mov_b32 v161, 0
    v_mov_b32 v162, 0
    v_mov_b32 v163, 0
    v_mov_b32 v164, 0
    v_mov_b32 v165, 0
    v_mov_b32 v166, 0
    v_mov_b32 v167, 0
    v_mov_b32 v168, 0
    v_mov_b32 v169, 0
    v_mov_b32 v170, 0
    v_mov_b32 v171, 0
    v_mov_b32 v172, 0
    v_mov_b32 v173, 0
    v_mov_b32 v174, 0
    v_mov_b32 v175, 0
    v_mov_b32 v176, 0
    v_mov_b32 v177, 0
    v_mov_b32 v178, 0
    v_mov_b32 v179, 0
    v_mov_b32 v180, 0
    v_mov_b32 v181, 0
    v_mov_b32 v182, 0
    v_mov_b32 v183, 0
    v_mov_b32 v184, 0
    v_mov_b32 v185, 0
    v_mov_b32 v186, 0
    v_mov_b32 v187, 0
    v_mov_b32 v188, 0
    v_mov_b32 v189, 0
    v_mov_b32 v190, 0
    v_mov_b32 v191, 0
    v_mov_b32 v192, 0
    v_mov_b32 v193, 0
    v_mov_b32 v194, 0
    v_mov_b32 v195, 0
    v_mov_b32 v196, 0
    v_mov_b32 v197, 0
    v_mov_b32 v198, 0
    v_mov_b32 v199, 0
    v_mov_b32 v200, 0
    v_mov_b32 v201, 0
    v_mov_b32 v202, 0
    v_mov_b32 v203, 0
    v_mov_b32 v204, 0
    v_mov_b32 v205, 0
    v_mov_b32 v206, 0
    v_mov_b32 v207, 0
    v_mov_b32 v208, 0
    v_mov_b32 v209, 0
    v_mov_b32 v210, 0
    v_mov_b32 v211, 0
    v_mov_b32 v212, 0
    v_mov_b32 v213, 0
    v_mov_b32 v214, 0
    v_mov_b32 v215, 0
    v_mov_b32 v216, 0
    v_mov_b32 v217, 0
    v_mov_b32 v218, 0
    v_mov_b32 v219, 0
L_fn_loopb:
    s_add_u32 s47, s60, s44
    buffer_load_dwordx4 a[72:75], v3, s[8:11], s47 offen
    s_add_u32 s47, s61, s44
    buffer_load_dwordx4 a[76:79], v3, s[8:11], s47 offen
    s_add_u32 s47, s62, s44
    buffer_load_dwordx4 a[80:83], v3, s[8:11], s47 offen
    s_add_u32 s47, s63, s44
    buffer_load_dwordx4 a[84:87], v3, s[8:11], s47 offen
    s_add_u32 s47, s64, s44
    buffer_load_dwordx4 a[88:91], v3, s[8:11], s47 offen
    s_add_u32 s47, s65, s44
    buffer_load_dwordx4 a[92:95], v3, s[8:11], s47 offen sc1
    s_add_u32 s47, s66, s44
    buffer_load_dwordx4 a[96:99], v3, s[8:11], s47 offen sc1
    s_add_u32 s47, s67, s44
    buffer_load_dwordx4 a[100:103], v3, s[8:11], s47 offen sc1
    s_add_u32 s47, s68, s44
    buffer_load_dwordx4 a[104:107], v3, s[8:11], s47 offen sc1
    s_add_u32 s45, s45, 1
    s_cmp_lt_u32 s45, s50
    s_cselect_b32 s47, 4096, 0
    s_add_u32 s44, s44, s47
    s_waitcnt vmcnt(45)
    v_mfma_f32_16x16x32_bf16 v[140:143], v[32:35], v[52:55], v[140:143]
    v_mfma_f32_16x16x32_bf16 v[144:147], v[32:35], v[56:59], v[144:147]
    v_mfma_f32_16x16x32_bf16 v[148:151], v[32:35], v[60:63], v[148:151]
    v_mfma_f32_16x16x32_bf16 v[152:155], v[32:35], v[64:67], v[152:155]
    v_mfma_f32_16x16x32_bf16 v[156:159], v[36:39], v[52:55], v[156:159]
    v_mfma_f32_16x16x32_bf16 v[160:163], v[36:39], v[56:59], v[160:163]
    v_mfma_f32_16x16x32_bf16 v[164:167], v[36:39], v[60:63], v[164:167]
    v_mfma_f32_16x16x32_bf16 v[168:171], v[36:39], v[64:67], v[168:171]
    v_mfma_f32_16x16x32_bf16 v[172:175], v[40:43], v[52:55], v[172:175]
    v_mfma_f32_16x16x32_bf16 v[176:179], v[40:43], v[56:59], v[176:179]
    v_mfma_f32_16x16x32_bf16 v[180:183], v[40:43], v[60:63], v[180:183]
    v_mfma_f32_16x16x32_bf16 v[184:187], v[40:43], v[64:67], v[184:187]
    v_mfma_f32_16x16x32_bf16 v[188:191], v[44:47], v[52:55], v[188:191]
    v_mfma_f32_16x16x32_bf16 v[192:195], v[44:47], v[56:59], v[192:195]
    v_mfma_f32_16x16x32_bf16 v[196:199], v[44:47], v[60:63], v[196:199]
    v_mfma_f32_16x16x32_bf16 v[200:203], v[44:47], v[64:67], v[200:203]
    v_mfma_f32_16x16x32_bf16 v[204:207], v[48:51], v[52:55], v[204:207]
    v_mfma_f32_16x16x32_bf16 v[208:211], v[48:51], v[56:59], v[208:211]
    v_mfma_f32_16x16x32_bf16 v[212:215], v[48:51], v[60:63], v[212:215]
    v_mfma_f32_16x16x32_bf16 v[216:219], v[48:51], v[64:67], v[216:219]
    s_add_u32 s46, s46, 1
    s_cmp_ge_u32 s46, s50
    s_cbranch_scc1 L_fn_endb
    s_add_u32 s47, s60, s44
    buffer_load_dwordx4 v[32:35], v3, s[8:11], s47 offen
    s_add_u32 s47, s61, s44
    buffer_load_dwordx4 v[36:39], v3, s[8:11], s47 offen
    s_add_u32 s47, s62, s44
    buffer_load_dwordx4 v[40:43], v3, s[8:11], s47 offen
    s_add_u32 s47, s63, s44
    buffer_load_dwordx4 v[44:47], v3, s[8:11], s47 offen
    s_add_u32 s47, s64, s44
    buffer_load_dwordx4 v[48:51], v3, s[8:11], s47 offen
    s_add_u32 s47, s65, s44
    buffer_load_dwordx4 v[52:55], v3, s[8:11], s47 offen sc1
    s_add_u32 s47, s66, s44
    buffer_load_dwordx4 v[56:59], v3, s[8:11], s47 offen sc1
    s_add_u32 s47, s67, s44
    buffer_load_dwordx4 v[60:63], v3, s[8:11], s47 offen sc1
    s_add_u32 s47, s68, s44
    buffer_load_dwordx4 v[64:67], v3, s[8:11], s47 offen sc1
    s_add_u32 s45, s45, 1
    s_cmp_lt_u32 s45, s50
    s_cselect_b32 s47, 4096, 0
    s_add_u32 s44, s44, s47
    s_waitcnt vmcnt(45)
    v_mfma_f32_16x16x32_bf16 v[140:143], v[68:71], v[88:91], v[140:143]
    v_mfma_f32_16x16x32_bf16 v[144:147], v[68:71], v[92:95], v[144:147]
    v_mfma_f32_16x16x32_bf16 v[148:151], v[68:71], v[96:99], v[148:151]
    v_mfma_f32_16x16x32_bf16 v[152:155], v[68:71], v[100:103], v[152:155]
    v_mfma_f32_16x16x32_bf16 v[156:159], v[72:75], v[88:91], v[156:159]
    v_mfma_f32_16x16x32_bf16 v[160:163], v[72:75], v[92:95], v[160:163]
    v_mfma_f32_16x16x32_bf16 v[164:167], v[72:75], v[96:99], v[164:167]
    v_mfma_f32_16x16x32_bf16 v[168:171], v[72:75], v[100:103], v[168:171]
    v_mfma_f32_16x16x32_bf16 v[172:175], v[76:79], v[88:91], v[172:175]
    v_mfma_f32_16x16x32_bf16 v[176:179], v[76:79], v[92:95], v[176:179]
    v_mfma_f32_16x16x32_bf16 v[180:183], v[76:79], v[96:99], v[180:183]
    v_mfma_f32_16x16x32_bf16 v[184:187], v[76:79], v[100:103], v[184:187]
    v_mfma_f32_16x16x32_bf16 v[188:191], v[80:83], v[88:91], v[188:191]
    v_mfma_f32_16x16x32_bf16 v[192:195], v[80:83], v[92:95], v[192:195]
    v_mfma_f32_16x16x32_bf16 v[196:199], v[80:83], v[96:99], v[196:199]
    v_mfma_f32_16x16x32_bf16 v[200:203], v[80:83], v[100:103], v[200:203]
    v_mfma_f32_16x16x32_bf16 v[204:207], v[84:87], v[88:91], v[204:207]
    v_mfma_f32_16x16x32_bf16 v[208:211], v[84:87], v[92:95], v[208:211]
    v_mfma_f32_16x16x32_bf16 v[212:215], v[84:87], v[96:99], v[212:215]
    v_mfma_f32_16x16x32_bf16 v[216:219], v[84:87], v[100:103], v[216:219]
    s_add_u32 s46, s46, 1
    s_cmp_ge_u32 s46, s50
    s_cbranch_scc1 L_fn_endb
    s_add_u32 s47, s60, s44
    buffer_load_dwordx4 v[68:71], v3, s[8:11], s47 offen
    s_add_u32 s47, s61, s44
    buffer_load_dwordx4 v[72:75], v3, s[8:11], s47 offen
    s_add_u32 s47, s62, s44
    buffer_load_dwordx4 v[76:79], v3, s[8:11], s47 offen
    s_add_u32 s47, s63, s44
    buffer_load_dwordx4 v[80:83], v3, s[8:11], s47 offen
    s_add_u32 s47, s64, s44
    buffer_load_dwordx4 v[84:87], v3, s[8:11], s47 offen
    s_add_u32 s47, s65, s44
    buffer_load_dwordx4 v[88:91], v3, s[8:11], s47 offen sc1
    s_add_u32 s47, s66, s44
    buffer_load_dwordx4 v[92:95], v3, s[8:11], s47 offen sc1
    s_add_u32 s47, s67, s44
    buffer_load_dwordx4 v[96:99], v3, s[8:11], s47 offen sc1
    s_add_u32 s47, s68, s44
    buffer_load_dwordx4 v[100:103], v3, s[8:11], s47 offen sc1
    s_add_u32 s45, s45, 1
    s_cmp_lt_u32 s45, s50
    s_cselect_b32 s47, 4096, 0
    s_add_u32 s44, s44, s47
    s_waitcnt vmcnt(45)
    v_mfma_f32_16x16x32_bf16 v[140:143], v[104:107], v[124:127], v[140:143]
    v_mfma_f32_16x16x32_bf16 v[144:147], v[104:107], v[128:131], v[144:147]
    v_mfma_f32_16x16x32_bf16 v[148:151], v[104:107], v[132:135], v[148:151]
    v_mfma_f32_16x16x32_bf16 v[152:155], v[104:107], v[136:139], v[152:155]
    v_mfma_f32_16x16x32_bf16 v[156:159], v[108:111], v[124:127], v[156:159]
    v_mfma_f32_16x16x32_bf16 v[160:163], v[108:111], v[128:131], v[160:163]
    v_mfma_f32_16x16x32_bf16 v[164:167], v[108:111], v[132:135], v[164:167]
    v_mfma_f32_16x16x32_bf16 v[168:171], v[108:111], v[136:139], v[168:171]
    v_mfma_f32_16x16x32_bf16 v[172:175], v[112:115], v[124:127], v[172:175]
    v_mfma_f32_16x16x32_bf16 v[176:179], v[112:115], v[128:131], v[176:179]
    v_mfma_f32_16x16x32_bf16 v[180:183], v[112:115], v[132:135], v[180:183]
    v_mfma_f32_16x16x32_bf16 v[184:187], v[112:115], v[136:139], v[184:187]
    v_mfma_f32_16x16x32_bf16 v[188:191], v[116:119], v[124:127], v[188:191]
    v_mfma_f32_16x16x32_bf16 v[192:195], v[116:119], v[128:131], v[192:195]
    v_mfma_f32_16x16x32_bf16 v[196:199], v[116:119], v[132:135], v[196:199]
    v_mfma_f32_16x16x32_bf16 v[200:203], v[116:119], v[136:139], v[200:203]
    v_mfma_f32_16x16x32_bf16 v[204:207], v[120:123], v[124:127], v[204:207]
    v_mfma_f32_16x16x32_bf16 v[208:211], v[120:123], v[128:131], v[208:211]
    v_mfma_f32_16x16x32_bf16 v[212:215], v[120:123], v[132:135], v[212:215]
    v_mfma_f32_16x16x32_bf16 v[216:219], v[120:123], v[136:139], v[216:219]
    s_add_u32 s46, s46, 1
    s_cmp_ge_u32 s46, s50
    s_cbranch_scc1 L_fn_endb
    s_add_u32 s47, s60, s44
    buffer_load_dwordx4 v[104:107], v3, s[8:11], s47 offen
    s_add_u32 s47, s61, s44
    buffer_load_dwordx4 v[108:111], v3, s[8:11], s47 offen
    s_add_u32 s47, s62, s44
    buffer_load_dwordx4 v[112:115], v3, s[8:11], s47 offen
    s_add_u32 s47, s63, s44
    buffer_load_dwordx4 v[116:119], v3, s[8:11], s47 offen
    s_add_u32 s47, s64, s44
    buffer_load_dwordx4 v[120:123], v3, s[8:11], s47 offen
    s_add_u32 s47, s65, s44
    buffer_load_dwordx4 v[124:127], v3, s[8:11], s47 offen sc1
    s_add_u32 s47, s66, s44
    buffer_load_dwordx4 v[128:131], v3, s[8:11], s47 offen sc1
    s_add_u32 s47, s67, s44
    buffer_load_dwordx4 v[132:135], v3, s[8:11], s47 offen sc1
    s_add_u32 s47, s68, s44
    buffer_load_dwordx4 v[136:139], v3, s[8:11], s47 offen sc1
    s_add_u32 s45, s45, 1
    s_cmp_lt_u32 s45, s50
    s_cselect_b32 s47, 4096, 0
    s_add_u32 s44, s44, s47
    s_waitcnt vmcnt(45)
    v_mfma_f32_16x16x32_bf16 v[140:143], a[0:3], a[20:23], v[140:143]
    v_mfma_f32_16x16x32_bf16 v[144:147], a[0:3], a[24:27], v[144:147]
    v_mfma_f32_16x16x32_bf16 v[148:151], a[0:3], a[28:31], v[148:151]
    v_mfma_f32_16x16x32_bf16 v[152:155], a[0:3], a[32:35], v[152:155]
    v_mfma_f32_16x16x32_bf16 v[156:159], a[4:7], a[20:23], v[156:159]
    v_mfma_f32_16x16x32_bf16 v[160:163], a[4:7], a[24:27], v[160:163]
    v_mfma_f32_16x16x32_bf16 v[164:167], a[4:7], a[28:31], v[164:167]
    v_mfma_f32_16x16x32_bf16 v[168:171], a[4:7], a[32:35], v[168:171]
    v_mfma_f32_16x16x32_bf16 v[172:175], a[8:11], a[20:23], v[172:175]
    v_mfma_f32_16x16x32_bf16 v[176:179], a[8:11], a[24:27], v[176:179]
    v_mfma_f32_16x16x32_bf16 v[180:183], a[8:11], a[28:31], v[180:183]
    v_mfma_f32_16x16x32_bf16 v[184:187], a[8:11], a[32:35], v[184:187]
    v_mfma_f32_16x16x32_bf16 v[188:191], a[12:15], a[20:23], v[188:191]
    v_mfma_f32_16x16x32_bf16 v[192:195], a[12:15], a[24:27], v[192:195]
    v_mfma_f32_16x16x32_bf16 v[196:199], a[12:15], a[28:31], v[196:199]
    v_mfma_f32_16x16x32_bf16 v[200:203], a[12:15], a[32:35], v[200:203]
    v_mfma_f32_16x16x32_bf16 v[204:207], a[16:19], a[20:23], v[204:207]
    v_mfma_f32_16x16x32_bf16 v[208:211], a[16:19], a[24:27], v[208:211]
    v_mfma_f32_16x16x32_bf16 v[212:215], a[16:19], a[28:31], v[212:215]
    v_mfma_f32_16x16x32_bf16 v[216:219], a[16:19], a[32:35], v[216:219]
    s_add_u32 s46, s46, 1
    s_cmp_ge_u32 s46, s50
    s_cbranch_scc1 L_fn_endb
    s_add_u32 s47, s60, s44
    buffer_load_dwordx4 a[0:3], v3, s[8:11], s47 offen
    s_add_u32 s47, s61, s44
    buffer_load_dwordx4 a[4:7], v3, s[8:11], s47 offen
    s_add_u32 s47, s62, s44
    buffer_load_dwordx4 a[8:11], v3, s[8:11], s47 offen
    s_add_u32 s47, s63, s44
    buffer_load_dwordx4 a[12:15], v3, s[8:11], s47 offen
    s_add_u32 s47, s64, s44
    buffer_load_dwordx4 a[16:19], v3, s[8:11], s47 offen
    s_add_u32 s47, s65, s44
    buffer_load_dwordx4 a[20:23], v3, s[8:11], s47 offen sc1
    s_add_u32 s47, s66, s44
    buffer_load_dwordx4 a[24:27], v3, s[8:11], s47 offen sc1
    s_add_u32 s47, s67, s44
    buffer_load_dwordx4 a[28:31], v3, s[8:11], s47 offen sc1
    s_add_u32 s47, s68, s44
    buffer_load_dwordx4 a[32:35], v3, s[8:11], s47 offen sc1
    s_add_u32 s45, s45, 1
    s_cmp_lt_u32 s45, s50
    s_cselect_b32 s47, 4096, 0
    s_add_u32 s44, s44, s47
    s_waitcnt vmcnt(45)
    v_mfma_f32_16x16x32_bf16 v[140:143], a[36:39], a[56:59], v[140:143]
    v_mfma_f32_16x16x32_bf16 v[144:147], a[36:39], a[60:63], v[144:147]
    v_mfma_f32_16x16x32_bf16 v[148:151], a[36:39], a[64:67], v[148:151]
    v_mfma_f32_16x16x32_bf16 v[152:155], a[36:39], a[68:71], v[152:155]
    v_mfma_f32_16x16x32_bf16 v[156:159], a[40:43], a[56:59], v[156:159]
    v_mfma_f32_16x16x32_bf16 v[160:163], a[40:43], a[60:63], v[160:163]
    v_mfma_f32_16x16x32_bf16 v[164:167], a[40:43], a[64:67], v[164:167]
    v_mfma_f32_16x16x32_bf16 v[168:171], a[40:43], a[68:71], v[168:171]
    v_mfma_f32_16x16x32_bf16 v[172:175], a[44:47], a[56:59], v[172:175]
    v_mfma_f32_16x16x32_bf16 v[176:179], a[44:47], a[60:63], v[176:179]
    v_mfma_f32_16x16x32_bf16 v[180:183], a[44:47], a[64:67], v[180:183]
    v_mfma_f32_16x16x32_bf16 v[184:187], a[44:47], a[68:71], v[184:187]
    v_mfma_f32_16x16x32_bf16 v[188:191], a[48:51], a[56:59], v[188:191]
    v_mfma_f32_16x16x32_bf16 v[192:195], a[48:51], a[60:63], v[192:195]
    v_mfma_f32_16x16x32_bf16 v[196:199], a[48:51], a[64:67], v[196:199]
    v_mfma_f32_16x16x32_bf16 v[200:203], a[48:51], a[68:71], v[200:203]
    v_mfma_f32_16x16x32_bf16 v[204:207], a[52:55], a[56:59], v[204:207]
    v_mfma_f32_16x16x32_bf16 v[208:211], a[52:55], a[60:63], v[208:211]
    v_mfma_f32_16x16x32_bf16 v[212:215], a[52:55], a[64:67], v[212:215]
    v_mfma_f32_16x16x32_bf16 v[216:219], a[52:55], a[68:71], v[216:219]
    s_add_u32 s46, s46, 1
    s_cmp_ge_u32 s46, s50
    s_cbranch_scc1 L_fn_endb
    s_add_u32 s47, s60, s44
    buffer_load_dwordx4 a[36:39], v3, s[8:11], s47 offen
    s_add_u32 s47, s61, s44
    buffer_load_dwordx4 a[40:43], v3, s[8:11], s47 offen
    s_add_u32 s47, s62, s44
    buffer_load_dwordx4 a[44:47], v3, s[8:11], s47 offen
    s_add_u32 s47, s63, s44
    buffer_load_dwordx4 a[48:51], v3, s[8:11], s47 offen
    s_add_u32 s47, s64, s44
    buffer_load_dwordx4 a[52:55], v3, s[8:11], s47 offen
    s_add_u32 s47, s65, s44
    buffer_load_dwordx4 a[56:59], v3, s[8:11], s47 offen sc1
    s_add_u32 s47, s66, s44
    buffer_load_dwordx4 a[60:63], v3, s[8:11], s47 offen sc1
    s_add_u32 s47, s67, s44
    buffer_load_dwordx4 a[64:67], v3, s[8:11], s47 offen sc1
    s_add_u32 s47, s68, s44
    buffer_load_dwordx4 a[68:71], v3, s[8:11], s47 offen sc1
    s_add_u32 s45, s45, 1
    s_cmp_lt_u32 s45, s50
    s_cselect_b32 s47, 4096, 0
    s_add_u32 s44, s44, s47
    s_waitcnt vmcnt(45)
    v_mfma_f32_16x16x32_bf16 v[140:143], a[72:75], a[92:95], v[140:143]
    v_mfma_f32_16x16x32_bf16 v[144:147], a[72:75], a[96:99], v[144:147]
    v_mfma_f32_16x16x32_bf16 v[148:151], a[72:75], a[100:103], v[148:151]
    v_mfma_f32_16x16x32_bf16 v[152:155], a[72:75], a[104:107], v[152:155]
    v_mfma_f32_16x16x32_bf16 v[156:159], a[76:79], a[92:95], v[156:159]
    v_mfma_f32_16x16x32_bf16 v[160:163], a[76:79], a[96:99], v[160:163]
    v_mfma_f32_16x16x32_bf16 v[164:167], a[76:79], a[100:103], v[164:167]
    v_mfma_f32_16x16x32_bf16 v[168:171], a[76:79], a[104:107], v[168:171]
    v_mfma_f32_16x16x32_bf16 v[172:175], a[80:83], a[92:95], v[172:175]
    v_mfma_f32_16x16x32_bf16 v[176:179], a[80:83], a[96:99], v[176:179]
    v_mfma_f32_16x16x32_bf16 v[180:183], a[80:83], a[100:103], v[180:183]
    v_mfma_f32_16x16x32_bf16 v[184:187], a[80:83], a[104:107], v[184:187]
    v_mfma_f32_16x16x32_bf16 v[188:191], a[84:87], a[92:95], v[188:191]
    v_mfma_f32_16x16x32_bf16 v[192:195], a[84:87], a[96:99], v[192:195]
    v_mfma_f32_16x16x32_bf16 v[196:199], a[84:87], a[100:103], v[196:199]
    v_mfma_f32_16x16x32_bf16 v[200:203], a[84:87], a[104:107], v[200:203]
    v_mfma_f32_16x16x32_bf16 v[204:207], a[88:91], a[92:95], v[204:207]
    v_mfma_f32_16x16x32_bf16 v[208:211], a[88:91], a[96:99], v[208:211]
    v_mfma_f32_16x16x32_bf16 v[212:215], a[88:91], a[100:103], v[212:215]
    v_mfma_f32_16x16x32_bf16 v[216:219], a[88:91], a[104:107], v[216:219]
    s_add_u32 s46, s46, 1
    s_cmp_ge_u32 s46, s50
    s_cbranch_scc1 L_fn_endb
    s_branch L_fn_loopb
L_fn_endb:
    s_nop 7
    s_nop 3
    ds_write_b128 v5, v[140:143] offset:0
    ds_write_b128 v5, v[144:147] offset:1024
    ds_write_b128 v5, v[148:151] offset:2048
    ds_write_b128 v5, v[152:155] offset:3072
    ds_write_b128 v5, v[156:159] offset:4096
    ds_write_b128 v5, v[160:163] offset:5120
    ds_write_b128 v5, v[164:167] offset:6144
    ds_write_b128 v5, v[168:171] offset:7168
    ds_write_b128 v5, v[172:175] offset:8192
    ds_write_b128 v5, v[176:179] offset:9216
    ds_write_b128 v5, v[180:183] offset:10240
    ds_write_b128 v5, v[184:187] offset:11264
    ds_write_b128 v5, v[188:191] offset:12288
    ds_write_b128 v5, v[192:195] offset:13312
    ds_write_b128 v5, v[196:199] offset:14336
    ds_write_b128 v5, v[200:203] offset:15360
    ds_write_b128 v5, v[204:207] offset:16384
    ds_write_b128 v5, v[208:211] offset:17408
    ds_write_b128 v5, v[212:215] offset:18432
    ds_write_b128 v5, v[216:219] offset:19456
    s_waitcnt vmcnt(0) lgkmcnt(0)
    s_barrier
    ds_read_b128 v[32:35], v6 offset:0
    ds_read_b128 v[36:39], v6 offset:20480
    ds_read_b128 v[40:43], v9 offset:0
    ds_read_b128 v[44:47], v9 offset:20480
    ds_read_b128 v[48:51], v6 offset:4096
    ds_read_b128 v[52:55], v6 offset:24576
    ds_read_b128 v[56:59], v9 offset:4096
    ds_read_b128 v[60:63], v9 offset:24576
    ds_read_b128 v[64:67], v6 offset:8192
    ds_read_b128 v[68:71], v6 offset:28672
    ds_read_b128 v[72:75], v9 offset:8192
    ds_read_b128 v[76:79], v9 offset:28672
    ds_read_b128 v[80:83], v6 offset:12288
    ds_read_b128 v[84:87], v6 offset:32768
    ds_read_b128 v[88:91], v9 offset:12288
    ds_read_b128 v[92:95], v9 offset:32768
    ds_read_b128 v[96:99], v6 offset:16384
    ds_read_b128 v[100:103], v6 offset:36864
    ds_read_b128 v[104:107], v9 offset:16384
    ds_read_b128 v[108:111], v9 offset:36864
    s_waitcnt lgkmcnt(0)
    s_barrier
    v_add_f32 v32, v32, v36
    v_add_f32 v40, v40, v44
    v_add_f32 v33, v33, v37
    v_add_f32 v41, v41, v45
    v_add_f32 v34, v34, v38
    v_add_f32 v42, v42, v46
    v_add_f32 v35, v35, v39
    v_add_f32 v43, v43, v47
    v_add_f32 v32, v32, v40
    v_add_f32 v33, v33, v41
    v_add_f32 v34, v34, v42
    v_add_f32 v35, v35, v43
    v_cvt_pk_bf16_f32 v36, v32, v33
    v_cvt_pk_bf16_f32 v37, v34, v35
    v_lshlrev_b32 v32, 16, v36
    v_and_b32 v33, 0xffff0000, v36
    v_lshlrev_b32 v34, 16, v37
    v_and_b32 v35, 0xffff0000, v37
    v_add_f32 v48, v48, v52
    v_add_f32 v56, v56, v60
    v_add_f32 v49, v49, v53
    v_add_f32 v57, v57, v61
    v_add_f32 v50, v50, v54
    v_add_f32 v58, v58, v62
    v_add_f32 v51, v51, v55
    v_add_f32 v59, v59, v63
    v_add_f32 v48, v48, v56
    v_add_f32 v49, v49, v57
    v_add_f32 v50, v50, v58
    v_add_f32 v51, v51, v59
    v_cvt_pk_bf16_f32 v52, v48, v49
    v_cvt_pk_bf16_f32 v53, v50, v51
    v_lshlrev_b32 v48, 16, v52
    v_and_b32 v49, 0xffff0000, v52
    v_lshlrev_b32 v50, 16, v53
    v_and_b32 v51, 0xffff0000, v53
    v_add_f32 v64, v64, v68
    v_add_f32 v72, v72, v76
    v_add_f32 v65, v65, v69
    v_add_f32 v73, v73, v77
    v_add_f32 v66, v66, v70
    v_add_f32 v74, v74, v78
    v_add_f32 v67, v67, v71
    v_add_f32 v75, v75, v79
    v_add_f32 v64, v64, v72
    v_add_f32 v65, v65, v73
    v_add_f32 v66, v66, v74
    v_add_f32 v67, v67, v75
    v_cvt_pk_bf16_f32 v68, v64, v65
    v_cvt_pk_bf16_f32 v69, v66, v67
    v_lshlrev_b32 v64, 16, v68
    v_and_b32 v65, 0xffff0000, v68
    v_lshlrev_b32 v66, 16, v69
    v_and_b32 v67, 0xffff0000, v69
    v_add_f32 v80, v80, v84
    v_add_f32 v88, v88, v92
    v_add_f32 v81, v81, v85
    v_add_f32 v89, v89, v93
    v_add_f32 v82, v82, v86
    v_add_f32 v90, v90, v94
    v_add_f32 v83, v83, v87
    v_add_f32 v91, v91, v95
    v_add_f32 v80, v80, v88
    v_add_f32 v81, v81, v89
    v_add_f32 v82, v82, v90
    v_add_f32 v83, v83, v91
    v_cvt_pk_bf16_f32 v84, v80, v81
    v_cvt_pk_bf16_f32 v85, v82, v83
    v_lshlrev_b32 v80, 16, v84
    v_and_b32 v81, 0xffff0000, v84
    v_lshlrev_b32 v82, 16, v85
    v_and_b32 v83, 0xffff0000, v85
    v_add_f32 v96, v96, v100
    v_add_f32 v104, v104, v108
    v_add_f32 v97, v97, v101
    v_add_f32 v105, v105, v109
    v_add_f32 v98, v98, v102
    v_add_f32 v106, v106, v110
    v_add_f32 v99, v99, v103
    v_add_f32 v107, v107, v111
    v_add_f32 v96, v96, v104
    v_add_f32 v97, v97, v105
    v_add_f32 v98, v98, v106
    v_add_f32 v99, v99, v107
    v_cvt_pk_bf16_f32 v100, v96, v97
    v_cvt_pk_bf16_f32 v101, v98, v99
    v_lshlrev_b32 v96, 16, v100
    v_and_b32 v97, 0xffff0000, v100
    v_lshlrev_b32 v98, 16, v101
    v_and_b32 v99, 0xffff0000, v101
    v_sub_f32 v8, 1.0, v7
    v_cvt_pk_bf16_f32 v8, v8, v8
    v_lshlrev_b32 v8, 16, v8
    v_mul_f32 v220, v8, v32
    v_mul_f32 v221, v8, v33
    v_mul_f32 v222, v8, v34
    v_mul_f32 v223, v8, v35
    v_cvt_pk_bf16_f32 v220, v220, v221
    v_cvt_pk_bf16_f32 v221, v222, v223
    v_mul_f32 v224, v8, v48
    v_mul_f32 v225, v8, v49
    v_mul_f32 v226, v8, v50
    v_mul_f32 v227, v8, v51
    v_cvt_pk_bf16_f32 v224, v224, v225
    v_cvt_pk_bf16_f32 v225, v226, v227
    v_mul_f32 v228, v8, v64
    v_mul_f32 v229, v8, v65
    v_mul_f32 v230, v8, v66
    v_mul_f32 v231, v8, v67
    v_cvt_pk_bf16_f32 v228, v228, v229
    v_cvt_pk_bf16_f32 v229, v230, v231
    v_mul_f32 v232, v8, v80
    v_mul_f32 v233, v8, v81
    v_mul_f32 v234, v8, v82
    v_mul_f32 v235, v8, v83
    v_cvt_pk_bf16_f32 v232, v232, v233
    v_cvt_pk_bf16_f32 v233, v234, v235
    v_mul_f32 v236, v8, v96
    v_mul_f32 v237, v8, v97
    v_mul_f32 v238, v8, v98
    v_mul_f32 v239, v8, v99
    v_cvt_pk_bf16_f32 v236, v236, v237
    v_cvt_pk_bf16_f32 v237, v238, v239
    s_lshl_b32 s70, s53, 6
    s_add_u32 s70, s70, 120596736
L_chw_45:
    v_lshlrev_b32 v10, 2, v0
    v_cmp_gt_u32 vcc, 16, v0
    s_mov_b64 exec, vcc
    buffer_load_dword v11, v10, s[8:11], s70 offen sc1
    s_waitcnt vmcnt(0)
    v_cmp_gt_i32 vcc, 0, v11
    s_mov_b64 exec, -1
    s_cbranch_vccz L_chw_45_d
    s_sleep 16
    s_branch L_chw_45
L_chw_45_d:
    s_mul_i32 s24, s18, 655360
    s_add_u32 s24, s24, 15728640
    s_add_u32 s60, s24, 0
    s_add_u32 s61, s24, 131072
    s_add_u32 s62, s24, 262144
    s_add_u32 s63, s24, 393216
    s_add_u32 s64, s24, 524288
    s_lshl_b32 s24, s17, 19
    s_add_u32 s24, s24, 94715904
    s_add_u32 s65, s24, 0
    s_add_u32 s66, s24, 131072
    s_add_u32 s67, s24, 262144
    s_add_u32 s68, s24, 393216
    s_mov_b32 s50, 32
    s_lshl_b32 s44, s16, 10
    s_mov_b32 s45, 0
    s_mov_b32 s46, 0
    s_add_u32 s47, s60, s44
    buffer_load_dwordx4 v[32:35], v3, s[8:11], s47 offen
    s_add_u32 s47, s61, s44
    buffer_load_dwordx4 v[36:39], v3, s[8:11], s47 offen
    s_add_u32 s47, s62, s44
    buffer_load_dwordx4 v[40:43], v3, s[8:11], s47 offen
    s_add_u32 s47, s63, s44
    buffer_load_dwordx4 v[44:47], v3, s[8:11], s47 offen
    s_add_u32 s47, s64, s44
    buffer_load_dwordx4 v[48:51], v3, s[8:11], s47 offen
    s_add_u32 s47, s65, s44
    buffer_load_dwordx4 v[52:55], v3, s[8:11], s47 offen sc1
    s_add_u32 s47, s66, s44
    buffer_load_dwordx4 v[56:59], v3, s[8:11], s47 offen sc1
    s_add_u32 s47, s67, s44
    buffer_load_dwordx4 v[60:63], v3, s[8:11], s47 offen sc1
    s_add_u32 s47, s68, s44
    buffer_load_dwordx4 v[64:67], v3, s[8:11], s47 offen sc1
    s_add_u32 s45, s45, 1
    s_cmp_lt_u32 s45, s50
    s_cselect_b32 s47, 4096, 0
    s_add_u32 s44, s44, s47
    s_add_u32 s47, s60, s44
    buffer_load_dwordx4 v[68:71], v3, s[8:11], s47 offen
    s_add_u32 s47, s61, s44
    buffer_load_dwordx4 v[72:75], v3, s[8:11], s47 offen
    s_add_u32 s47, s62, s44
    buffer_load_dwordx4 v[76:79], v3, s[8:11], s47 offen
    s_add_u32 s47, s63, s44
    buffer_load_dwordx4 v[80:83], v3, s[8:11], s47 offen
    s_add_u32 s47, s64, s44
    buffer_load_dwordx4 v[84:87], v3, s[8:11], s47 offen
    s_add_u32 s47, s65, s44
    buffer_load_dwordx4 v[88:91], v3, s[8:11], s47 offen sc1
    s_add_u32 s47, s66, s44
    buffer_load_dwordx4 v[92:95], v3, s[8:11], s47 offen sc1
    s_add_u32 s47, s67, s44
    buffer_load_dwordx4 v[96:99], v3, s[8:11], s47 offen sc1
    s_add_u32 s47, s68, s44
    buffer_load_dwordx4 v[100:103], v3, s[8:11], s47 offen sc1
    s_add_u32 s45, s45, 1
    s_cmp_lt_u32 s45, s50
    s_cselect_b32 s47, 4096, 0
    s_add_u32 s44, s44, s47
    s_add_u32 s47, s60, s44
    buffer_load_dwordx4 v[104:107], v3, s[8:11], s47 offen
    s_add_u32 s47, s61, s44
    buffer_load_dwordx4 v[108:111], v3, s[8:11], s47 offen
    s_add_u32 s47, s62, s44
    buffer_load_dwordx4 v[112:115], v3, s[8:11], s47 offen
    s_add_u32 s47, s63, s44
    buffer_load_dwordx4 v[116:119], v3, s[8:11], s47 offen
    s_add_u32 s47, s64, s44
    buffer_load_dwordx4 v[120:123], v3, s[8:11], s47 offen
    s_add_u32 s47, s65, s44
    buffer_load_dwordx4 v[124:127], v3, s[8:11], s47 offen sc1
    s_add_u32 s47, s66, s44
    buffer_load_dwordx4 v[128:131], v3, s[8:11], s47 offen sc1
    s_add_u32 s47, s67, s44
    buffer_load_dwordx4 v[132:135], v3, s[8:11], s47 offen sc1
    s_add_u32 s47, s68, s44
    buffer_load_dwordx4 v[136:139], v3, s[8:11], s47 offen sc1
    s_add_u32 s45, s45, 1
    s_cmp_lt_u32 s45, s50
    s_cselect_b32 s47, 4096, 0
    s_add_u32 s44, s44, s47
    s_add_u32 s47, s60, s44
    buffer_load_dwordx4 a[0:3], v3, s[8:11], s47 offen
    s_add_u32 s47, s61, s44
    buffer_load_dwordx4 a[4:7], v3, s[8:11], s47 offen
    s_add_u32 s47, s62, s44
    buffer_load_dwordx4 a[8:11], v3, s[8:11], s47 offen
    s_add_u32 s47, s63, s44
    buffer_load_dwordx4 a[12:15], v3, s[8:11], s47 offen
    s_add_u32 s47, s64, s44
    buffer_load_dwordx4 a[16:19], v3, s[8:11], s47 offen
    s_add_u32 s47, s65, s44
    buffer_load_dwordx4 a[20:23], v3, s[8:11], s47 offen sc1
    s_add_u32 s47, s66, s44
    buffer_load_dwordx4 a[24:27], v3, s[8:11], s47 offen sc1
    s_add_u32 s47, s67, s44
    buffer_load_dwordx4 a[28:31], v3, s[8:11], s47 offen sc1
    s_add_u32 s47, s68, s44
    buffer_load_dwordx4 a[32:35], v3, s[8:11], s47 offen sc1
    s_add_u32 s45, s45, 1
    s_cmp_lt_u32 s45, s50
    s_cselect_b32 s47, 4096, 0
    s_add_u32 s44, s44, s47
    s_add_u32 s47, s60, s44
    buffer_load_dwordx4 a[36:39], v3, s[8:11], s47 offen
    s_add_u32 s47, s61, s44
    buffer_load_dwordx4 a[40:43], v3, s[8:11], s47 offen
    s_add_u32 s47, s62, s44
    buffer_load_dwordx4 a[44:47], v3, s[8:11], s47 offen
    s_add_u32 s47, s63, s44
    buffer_load_dwordx4 a[48:51], v3, s[8:11], s47 offen
    s_add_u32 s47, s64, s44
    buffer_load_dwordx4 a[52:55], v3, s[8:11], s47 offen
    s_add_u32 s47, s65, s44
    buffer_load_dwordx4 a[56:59], v3, s[8:11], s47 offen sc1
    s_add_u32 s47, s66, s44
    buffer_load_dwordx4 a[60:63], v3, s[8:11], s47 offen sc1
    s_add_u32 s47, s67, s44
    buffer_load_dwordx4 a[64:67], v3, s[8:11], s47 offen sc1
    s_add_u32 s47, s68, s44
    buffer_load_dwordx4 a[68:71], v3, s[8:11], s47 offen sc1
    s_add_u32 s45, s45, 1
    s_cmp_lt_u32 s45, s50
    s_cselect_b32 s47, 4096, 0
    s_add_u32 s44, s44, s47
    v_mov_b32 v140, 0
    v_mov_b32 v141, 0
    v_mov_b32 v142, 0
    v_mov_b32 v143, 0
    v_mov_b32 v144, 0
    v_mov_b32 v145, 0
    v_mov_b32 v146, 0
    v_mov_b32 v147, 0
    v_mov_b32 v148, 0
    v_mov_b32 v149, 0
    v_mov_b32 v150, 0
    v_mov_b32 v151, 0
    v_mov_b32 v152, 0
    v_mov_b32 v153, 0
    v_mov_b32 v154, 0
    v_mov_b32 v155, 0
    v_mov_b32 v156, 0
    v_mov_b32 v157, 0
    v_mov_b32 v158, 0
    v_mov_b32 v159, 0
    v_mov_b32 v160, 0
    v_mov_b32 v161, 0
    v_mov_b32 v162, 0
    v_mov_b32 v163, 0
    v_mov_b32 v164, 0
    v_mov_b32 v165, 0
    v_mov_b32 v166, 0
    v_mov_b32 v167, 0
    v_mov_b32 v168, 0
    v_mov_b32 v169, 0
    v_mov_b32 v170, 0
    v_mov_b32 v171, 0
    v_mov_b32 v172, 0
    v_mov_b32 v173, 0
    v_mov_b32 v174, 0
    v_mov_b32 v175, 0
    v_mov_b32 v176, 0
    v_mov_b32 v177, 0
    v_mov_b32 v178, 0
    v_mov_b32 v179, 0
    v_mov_b32 v180, 0
    v_mov_b32 v181, 0
    v_mov_b32 v182, 0
    v_mov_b32 v183, 0
    v_mov_b32 v184, 0
    v_mov_b32 v185, 0
    v_mov_b32 v186, 0
    v_mov_b32 v187, 0
    v_mov_b32 v188, 0
    v_mov_b32 v189, 0
    v_mov_b32 v190, 0
    v_mov_b32 v191, 0
    v_mov_b32 v192, 0
    v_mov_b32 v193, 0
    v_mov_b32 v194, 0
    v_mov_b32 v195, 0
    v_mov_b32 v196, 0
    v_mov_b32 v197, 0
    v_mov_b32 v198, 0
    v_mov_b32 v199, 0
    v_mov_b32 v200, 0
    v_mov_b32 v201, 0
    v_mov_b32 v202, 0
    v_mov_b32 v203, 0
    v_mov_b32 v204, 0
    v_mov_b32 v205, 0
    v_mov_b32 v206, 0
    v_mov_b32 v207, 0
    v_mov_b32 v208, 0
    v_mov_b32 v209, 0
    v_mov_b32 v210, 0
    v_mov_b32 v211, 0
    v_mov_b32 v212, 0
    v_mov_b32 v213, 0
    v_mov_b32 v214, 0
    v_mov_b32 v215, 0
    v_mov_b32 v216, 0
    v_mov_b32 v217, 0
    v_mov_b32 v218, 0
    v_mov_b32 v219, 0
L_fn_loopa:
    s_add_u32 s47, s60, s44
    buffer_load_dwordx4 a[72:75], v3, s[8:11], s47 offen
    s_add_u32 s47, s61, s44
    buffer_load_dwordx4 a[76:79], v3, s[8:11], s47 offen
    s_add_u32 s47, s62, s44
    buffer_load_dwordx4 a[80:83], v3, s[8:11], s47 offen
    s_add_u32 s47, s63, s44
    buffer_load_dwordx4 a[84:87], v3, s[8:11], s47 offen
    s_add_u32 s47, s64, s44
    buffer_load_dwordx4 a[88:91], v3, s[8:11], s47 offen
    s_add_u32 s47, s65, s44
    buffer_load_dwordx4 a[92:95], v3, s[8:11], s47 offen sc1
    s_add_u32 s47, s66, s44
    buffer_load_dwordx4 a[96:99], v3, s[8:11], s47 offen sc1
    s_add_u32 s47, s67, s44
    buffer_load_dwordx4 a[100:103], v3, s[8:11], s47 offen sc1
    s_add_u32 s47, s68, s44
    buffer_load_dwordx4 a[104:107], v3, s[8:11], s47 offen sc1
    s_add_u32 s45, s45, 1
    s_cmp_lt_u32 s45, s50
    s_cselect_b32 s47, 4096, 0
    s_add_u32 s44, s44, s47
    s_waitcnt vmcnt(45)
    v_mfma_f32_16x16x32_bf16 v[140:143], v[32:35], v[52:55], v[140:143]
    v_mfma_f32_16x16x32_bf16 v[144:147], v[32:35], v[56:59], v[144:147]
    v_mfma_f32_16x16x32_bf16 v[148:151], v[32:35], v[60:63], v[148:151]
    v_mfma_f32_16x16x32_bf16 v[152:155], v[32:35], v[64:67], v[152:155]
    v_mfma_f32_16x16x32_bf16 v[156:159], v[36:39], v[52:55], v[156:159]
    v_mfma_f32_16x16x32_bf16 v[160:163], v[36:39], v[56:59], v[160:163]
    v_mfma_f32_16x16x32_bf16 v[164:167], v[36:39], v[60:63], v[164:167]
    v_mfma_f32_16x16x32_bf16 v[168:171], v[36:39], v[64:67], v[168:171]
    v_mfma_f32_16x16x32_bf16 v[172:175], v[40:43], v[52:55], v[172:175]
    v_mfma_f32_16x16x32_bf16 v[176:179], v[40:43], v[56:59], v[176:179]
    v_mfma_f32_16x16x32_bf16 v[180:183], v[40:43], v[60:63], v[180:183]
    v_mfma_f32_16x16x32_bf16 v[184:187], v[40:43], v[64:67], v[184:187]
    v_mfma_f32_16x16x32_bf16 v[188:191], v[44:47], v[52:55], v[188:191]
    v_mfma_f32_16x16x32_bf16 v[192:195], v[44:47], v[56:59], v[192:195]
    v_mfma_f32_16x16x32_bf16 v[196:199], v[44:47], v[60:63], v[196:199]
    v_mfma_f32_16x16x32_bf16 v[200:203], v[44:47], v[64:67], v[200:203]
    v_mfma_f32_16x16x32_bf16 v[204:207], v[48:51], v[52:55], v[204:207]
    v_mfma_f32_16x16x32_bf16 v[208:211], v[48:51], v[56:59], v[208:211]
    v_mfma_f32_16x16x32_bf16 v[212:215], v[48:51], v[60:63], v[212:215]
    v_mfma_f32_16x16x32_bf16 v[216:219], v[48:51], v[64:67], v[216:219]
    s_add_u32 s46, s46, 1
    s_cmp_ge_u32 s46, s50
    s_cbranch_scc1 L_fn_enda
    s_add_u32 s47, s60, s44
    buffer_load_dwordx4 v[32:35], v3, s[8:11], s47 offen
    s_add_u32 s47, s61, s44
    buffer_load_dwordx4 v[36:39], v3, s[8:11], s47 offen
    s_add_u32 s47, s62, s44
    buffer_load_dwordx4 v[40:43], v3, s[8:11], s47 offen
    s_add_u32 s47, s63, s44
    buffer_load_dwordx4 v[44:47], v3, s[8:11], s47 offen
    s_add_u32 s47, s64, s44
    buffer_load_dwordx4 v[48:51], v3, s[8:11], s47 offen
    s_add_u32 s47, s65, s44
    buffer_load_dwordx4 v[52:55], v3, s[8:11], s47 offen sc1
    s_add_u32 s47, s66, s44
    buffer_load_dwordx4 v[56:59], v3, s[8:11], s47 offen sc1
    s_add_u32 s47, s67, s44
    buffer_load_dwordx4 v[60:63], v3, s[8:11], s47 offen sc1
    s_add_u32 s47, s68, s44
    buffer_load_dwordx4 v[64:67], v3, s[8:11], s47 offen sc1
    s_add_u32 s45, s45, 1
    s_cmp_lt_u32 s45, s50
    s_cselect_b32 s47, 4096, 0
    s_add_u32 s44, s44, s47
    s_waitcnt vmcnt(45)
    v_mfma_f32_16x16x32_bf16 v[140:143], v[68:71], v[88:91], v[140:143]
    v_mfma_f32_16x16x32_bf16 v[144:147], v[68:71], v[92:95], v[144:147]
    v_mfma_f32_16x16x32_bf16 v[148:151], v[68:71], v[96:99], v[148:151]
    v_mfma_f32_16x16x32_bf16 v[152:155], v[68:71], v[100:103], v[152:155]
    v_mfma_f32_16x16x32_bf16 v[156:159], v[72:75], v[88:91], v[156:159]
    v_mfma_f32_16x16x32_bf16 v[160:163], v[72:75], v[92:95], v[160:163]
    v_mfma_f32_16x16x32_bf16 v[164:167], v[72:75], v[96:99], v[164:167]
    v_mfma_f32_16x16x32_bf16 v[168:171], v[72:75], v[100:103], v[168:171]
    v_mfma_f32_16x16x32_bf16 v[172:175], v[76:79], v[88:91], v[172:175]
    v_mfma_f32_16x16x32_bf16 v[176:179], v[76:79], v[92:95], v[176:179]
    v_mfma_f32_16x16x32_bf16 v[180:183], v[76:79], v[96:99], v[180:183]
    v_mfma_f32_16x16x32_bf16 v[184:187], v[76:79], v[100:103], v[184:187]
    v_mfma_f32_16x16x32_bf16 v[188:191], v[80:83], v[88:91], v[188:191]
    v_mfma_f32_16x16x32_bf16 v[192:195], v[80:83], v[92:95], v[192:195]
    v_mfma_f32_16x16x32_bf16 v[196:199], v[80:83], v[96:99], v[196:199]
    v_mfma_f32_16x16x32_bf16 v[200:203], v[80:83], v[100:103], v[200:203]
    v_mfma_f32_16x16x32_bf16 v[204:207], v[84:87], v[88:91], v[204:207]
    v_mfma_f32_16x16x32_bf16 v[208:211], v[84:87], v[92:95], v[208:211]
    v_mfma_f32_16x16x32_bf16 v[212:215], v[84:87], v[96:99], v[212:215]
    v_mfma_f32_16x16x32_bf16 v[216:219], v[84:87], v[100:103], v[216:219]
    s_add_u32 s46, s46, 1
    s_cmp_ge_u32 s46, s50
    s_cbranch_scc1 L_fn_enda
    s_add_u32 s47, s60, s44
    buffer_load_dwordx4 v[68:71], v3, s[8:11], s47 offen
    s_add_u32 s47, s61, s44
    buffer_load_dwordx4 v[72:75], v3, s[8:11], s47 offen
    s_add_u32 s47, s62, s44
    buffer_load_dwordx4 v[76:79], v3, s[8:11], s47 offen
    s_add_u32 s47, s63, s44
    buffer_load_dwordx4 v[80:83], v3, s[8:11], s47 offen
    s_add_u32 s47, s64, s44
    buffer_load_dwordx4 v[84:87], v3, s[8:11], s47 offen
    s_add_u32 s47, s65, s44
    buffer_load_dwordx4 v[88:91], v3, s[8:11], s47 offen sc1
    s_add_u32 s47, s66, s44
    buffer_load_dwordx4 v[92:95], v3, s[8:11], s47 offen sc1
    s_add_u32 s47, s67, s44
    buffer_load_dwordx4 v[96:99], v3, s[8:11], s47 offen sc1
    s_add_u32 s47, s68, s44
    buffer_load_dwordx4 v[100:103], v3, s[8:11], s47 offen sc1
    s_add_u32 s45, s45, 1
    s_cmp_lt_u32 s45, s50
    s_cselect_b32 s47, 4096, 0
    s_add_u32 s44, s44, s47
    s_waitcnt vmcnt(45)
    v_mfma_f32_16x16x32_bf16 v[140:143], v[104:107], v[124:127], v[140:143]
    v_mfma_f32_16x16x32_bf16 v[144:147], v[104:107], v[128:131], v[144:147]
    v_mfma_f32_16x16x32_bf16 v[148:151], v[104:107], v[132:135], v[148:151]
    v_mfma_f32_16x16x32_bf16 v[152:155], v[104:107], v[136:139], v[152:155]
    v_mfma_f32_16x16x32_bf16 v[156:159], v[108:111], v[124:127], v[156:159]
    v_mfma_f32_16x16x32_bf16 v[160:163], v[108:111], v[128:131], v[160:163]
    v_mfma_f32_16x16x32_bf16 v[164:167], v[108:111], v[132:135], v[164:167]
    v_mfma_f32_16x16x32_bf16 v[168:171], v[108:111], v[136:139], v[168:171]
    v_mfma_f32_16x16x32_bf16 v[172:175], v[112:115], v[124:127], v[172:175]
    v_mfma_f32_16x16x32_bf16 v[176:179], v[112:115], v[128:131], v[176:179]
    v_mfma_f32_16x16x32_bf16 v[180:183], v[112:115], v[132:135], v[180:183]
    v_mfma_f32_16x16x32_bf16 v[184:187], v[112:115], v[136:139], v[184:187]
    v_mfma_f32_16x16x32_bf16 v[188:191], v[116:119], v[124:127], v[188:191]
    v_mfma_f32_16x16x32_bf16 v[192:195], v[116:119], v[128:131], v[192:195]
    v_mfma_f32_16x16x32_bf16 v[196:199], v[116:119], v[132:135], v[196:199]
    v_mfma_f32_16x16x32_bf16 v[200:203], v[116:119], v[136:139], v[200:203]
    v_mfma_f32_16x16x32_bf16 v[204:207], v[120:123], v[124:127], v[204:207]
    v_mfma_f32_16x16x32_bf16 v[208:211], v[120:123], v[128:131], v[208:211]
    v_mfma_f32_16x16x32_bf16 v[212:215], v[120:123], v[132:135], v[212:215]
    v_mfma_f32_16x16x32_bf16 v[216:219], v[120:123], v[136:139], v[216:219]
    s_add_u32 s46, s46, 1
    s_cmp_ge_u32 s46, s50
    s_cbranch_scc1 L_fn_enda
    s_add_u32 s47, s60, s44
    buffer_load_dwordx4 v[104:107], v3, s[8:11], s47 offen
    s_add_u32 s47, s61, s44
    buffer_load_dwordx4 v[108:111], v3, s[8:11], s47 offen
    s_add_u32 s47, s62, s44
    buffer_load_dwordx4 v[112:115], v3, s[8:11], s47 offen
    s_add_u32 s47, s63, s44
    buffer_load_dwordx4 v[116:119], v3, s[8:11], s47 offen
    s_add_u32 s47, s64, s44
    buffer_load_dwordx4 v[120:123], v3, s[8:11], s47 offen
    s_add_u32 s47, s65, s44
    buffer_load_dwordx4 v[124:127], v3, s[8:11], s47 offen sc1
    s_add_u32 s47, s66, s44
    buffer_load_dwordx4 v[128:131], v3, s[8:11], s47 offen sc1
    s_add_u32 s47, s67, s44
    buffer_load_dwordx4 v[132:135], v3, s[8:11], s47 offen sc1
    s_add_u32 s47, s68, s44
    buffer_load_dwordx4 v[136:139], v3, s[8:11], s47 offen sc1
    s_add_u32 s45, s45, 1
    s_cmp_lt_u32 s45, s50
    s_cselect_b32 s47, 4096, 0
    s_add_u32 s44, s44, s47
    s_waitcnt vmcnt(45)
    v_mfma_f32_16x16x32_bf16 v[140:143], a[0:3], a[20:23], v[140:143]
    v_mfma_f32_16x16x32_bf16 v[144:147], a[0:3], a[24:27], v[144:147]
    v_mfma_f32_16x16x32_bf16 v[148:151], a[0:3], a[28:31], v[148:151]
    v_mfma_f32_16x16x32_bf16 v[152:155], a[0:3], a[32:35], v[152:155]
    v_mfma_f32_16x16x32_bf16 v[156:159], a[4:7], a[20:23], v[156:159]
    v_mfma_f32_16x16x32_bf16 v[160:163], a[4:7], a[24:27], v[160:163]
    v_mfma_f32_16x16x32_bf16 v[164:167], a[4:7], a[28:31], v[164:167]
    v_mfma_f32_16x16x32_bf16 v[168:171], a[4:7], a[32:35], v[168:171]
    v_mfma_f32_16x16x32_bf16 v[172:175], a[8:11], a[20:23], v[172:175]
    v_mfma_f32_16x16x32_bf16 v[176:179], a[8:11], a[24:27], v[176:179]
    v_mfma_f32_16x16x32_bf16 v[180:183], a[8:11], a[28:31], v[180:183]
    v_mfma_f32_16x16x32_bf16 v[184:187], a[8:11], a[32:35], v[184:187]
    v_mfma_f32_16x16x32_bf16 v[188:191], a[12:15], a[20:23], v[188:191]
    v_mfma_f32_16x16x32_bf16 v[192:195], a[12:15], a[24:27], v[192:195]
    v_mfma_f32_16x16x32_bf16 v[196:199], a[12:15], a[28:31], v[196:199]
    v_mfma_f32_16x16x32_bf16 v[200:203], a[12:15], a[32:35], v[200:203]
    v_mfma_f32_16x16x32_bf16 v[204:207], a[16:19], a[20:23], v[204:207]
    v_mfma_f32_16x16x32_bf16 v[208:211], a[16:19], a[24:27], v[208:211]
    v_mfma_f32_16x16x32_bf16 v[212:215], a[16:19], a[28:31], v[212:215]
    v_mfma_f32_16x16x32_bf16 v[216:219], a[16:19], a[32:35], v[216:219]
    s_add_u32 s46, s46, 1
    s_cmp_ge_u32 s46, s50
    s_cbranch_scc1 L_fn_enda
    s_add_u32 s47, s60, s44
    buffer_load_dwordx4 a[0:3], v3, s[8:11], s47 offen
    s_add_u32 s47, s61, s44
    buffer_load_dwordx4 a[4:7], v3, s[8:11], s47 offen
    s_add_u32 s47, s62, s44
    buffer_load_dwordx4 a[8:11], v3, s[8:11], s47 offen
    s_add_u32 s47, s63, s44
    buffer_load_dwordx4 a[12:15], v3, s[8:11], s47 offen
    s_add_u32 s47, s64, s44
    buffer_load_dwordx4 a[16:19], v3, s[8:11], s47 offen
    s_add_u32 s47, s65, s44
    buffer_load_dwordx4 a[20:23], v3, s[8:11], s47 offen sc1
    s_add_u32 s47, s66, s44
    buffer_load_dwordx4 a[24:27], v3, s[8:11], s47 offen sc1
    s_add_u32 s47, s67, s44
    buffer_load_dwordx4 a[28:31], v3, s[8:11], s47 offen sc1
    s_add_u32 s47, s68, s44
    buffer_load_dwordx4 a[32:35], v3, s[8:11], s47 offen sc1
    s_add_u32 s45, s45, 1
    s_cmp_lt_u32 s45, s50
    s_cselect_b32 s47, 4096, 0
    s_add_u32 s44, s44, s47
    s_waitcnt vmcnt(45)
    v_mfma_f32_16x16x32_bf16 v[140:143], a[36:39], a[56:59], v[140:143]
    v_mfma_f32_16x16x32_bf16 v[144:147], a[36:39], a[60:63], v[144:147]
    v_mfma_f32_16x16x32_bf16 v[148:151], a[36:39], a[64:67], v[148:151]
    v_mfma_f32_16x16x32_bf16 v[152:155], a[36:39], a[68:71], v[152:155]
    v_mfma_f32_16x16x32_bf16 v[156:159], a[40:43], a[56:59], v[156:159]
    v_mfma_f32_16x16x32_bf16 v[160:163], a[40:43], a[60:63], v[160:163]
    v_mfma_f32_16x16x32_bf16 v[164:167], a[40:43], a[64:67], v[164:167]
    v_mfma_f32_16x16x32_bf16 v[168:171], a[40:43], a[68:71], v[168:171]
    v_mfma_f32_16x16x32_bf16 v[172:175], a[44:47], a[56:59], v[172:175]
    v_mfma_f32_16x16x32_bf16 v[176:179], a[44:47], a[60:63], v[176:179]
    v_mfma_f32_16x16x32_bf16 v[180:183], a[44:47], a[64:67], v[180:183]
    v_mfma_f32_16x16x32_bf16 v[184:187], a[44:47], a[68:71], v[184:187]
    v_mfma_f32_16x16x32_bf16 v[188:191], a[48:51], a[56:59], v[188:191]
    v_mfma_f32_16x16x32_bf16 v[192:195], a[48:51], a[60:63], v[192:195]
    v_mfma_f32_16x16x32_bf16 v[196:199], a[48:51], a[64:67], v[196:199]
    v_mfma_f32_16x16x32_bf16 v[200:203], a[48:51], a[68:71], v[200:203]
    v_mfma_f32_16x16x32_bf16 v[204:207], a[52:55], a[56:59], v[204:207]
    v_mfma_f32_16x16x32_bf16 v[208:211], a[52:55], a[60:63], v[208:211]
    v_mfma_f32_16x16x32_bf16 v[212:215], a[52:55], a[64:67], v[212:215]
    v_mfma_f32_16x16x32_bf16 v[216:219], a[52:55], a[68:71], v[216:219]
    s_add_u32 s46, s46, 1
    s_cmp_ge_u32 s46, s50
    s_cbranch_scc1 L_fn_enda
    s_add_u32 s47, s60, s44
    buffer_load_dwordx4 a[36:39], v3, s[8:11], s47 offen
    s_add_u32 s47, s61, s44
    buffer_load_dwordx4 a[40:43], v3, s[8:11], s47 offen
    s_add_u32 s47, s62, s44
    buffer_load_dwordx4 a[44:47], v3, s[8:11], s47 offen
    s_add_u32 s47, s63, s44
    buffer_load_dwordx4 a[48:51], v3, s[8:11], s47 offen
    s_add_u32 s47, s64, s44
    buffer_load_dwordx4 a[52:55], v3, s[8:11], s47 offen
    s_add_u32 s47, s65, s44
    buffer_load_dwordx4 a[56:59], v3, s[8:11], s47 offen sc1
    s_add_u32 s47, s66, s44
    buffer_load_dwordx4 a[60:63], v3, s[8:11], s47 offen sc1
    s_add_u32 s47, s67, s44
    buffer_load_dwordx4 a[64:67], v3, s[8:11], s47 offen sc1
    s_add_u32 s47, s68, s44
    buffer_load_dwordx4 a[68:71], v3, s[8:11], s47 offen sc1
    s_add_u32 s45, s45, 1
    s_cmp_lt_u32 s45, s50
    s_cselect_b32 s47, 4096, 0
    s_add_u32 s44, s44, s47
    s_waitcnt vmcnt(45)
    v_mfma_f32_16x16x32_bf16 v[140:143], a[72:75], a[92:95], v[140:143]
    v_mfma_f32_16x16x32_bf16 v[144:147], a[72:75], a[96:99], v[144:147]
    v_mfma_f32_16x16x32_bf16 v[148:151], a[72:75], a[100:103], v[148:151]
    v_mfma_f32_16x16x32_bf16 v[152:155], a[72:75], a[104:107], v[152:155]
    v_mfma_f32_16x16x32_bf16 v[156:159], a[76:79], a[92:95], v[156:159]
    v_mfma_f32_16x16x32_bf16 v[160:163], a[76:79], a[96:99], v[160:163]
    v_mfma_f32_16x16x32_bf16 v[164:167], a[76:79], a[100:103], v[164:167]
    v_mfma_f32_16x16x32_bf16 v[168:171], a[76:79], a[104:107], v[168:171]
    v_mfma_f32_16x16x32_bf16 v[172:175], a[80:83], a[92:95], v[172:175]
    v_mfma_f32_16x16x32_bf16 v[176:179], a[80:83], a[96:99], v[176:179]
    v_mfma_f32_16x16x32_bf16 v[180:183], a[80:83], a[100:103], v[180:183]
    v_mfma_f32_16x16x32_bf16 v[184:187], a[80:83], a[104:107], v[184:187]
    v_mfma_f32_16x16x32_bf16 v[188:191], a[84:87], a[92:95], v[188:191]
    v_mfma_f32_16x16x32_bf16 v[192:195], a[84:87], a[96:99], v[192:195]
    v_mfma_f32_16x16x32_bf16 v[196:199], a[84:87], a[100:103], v[196:199]
    v_mfma_f32_16x16x32_bf16 v[200:203], a[84:87], a[104:107], v[200:203]
    v_mfma_f32_16x16x32_bf16 v[204:207], a[88:91], a[92:95], v[204:207]
    v_mfma_f32_16x16x32_bf16 v[208:211], a[88:91], a[96:99], v[208:211]
    v_mfma_f32_16x16x32_bf16 v[212:215], a[88:91], a[100:103], v[212:215]
    v_mfma_f32_16x16x32_bf16 v[216:219], a[88:91], a[104:107], v[216:219]
    s_add_u32 s46, s46, 1
    s_cmp_ge_u32 s46, s50
    s_cbranch_scc1 L_fn_enda
    s_branch L_fn_loopa
L_fn_enda:
    s_nop 7
    s_nop 3
    ds_write_b128 v5, v[140:143] offset:0
    ds_write_b128 v5, v[144:147] offset:1024
    ds_write_b128 v5, v[148:151] offset:2048
    ds_write_b128 v5, v[152:155] offset:3072
    ds_write_b128 v5, v[156:159] offset:4096
    ds_write_b128 v5, v[160:163] offset:5120
    ds_write_b128 v5, v[164:167] offset:6144
    ds_write_b128 v5, v[168:171] offset:7168
    ds_write_b128 v5, v[172:175] offset:8192
    ds_write_b128 v5, v[176:179] offset:9216
    ds_write_b128 v5, v[180:183] offset:10240
    ds_write_b128 v5, v[184:187] offset:11264
    ds_write_b128 v5, v[188:191] offset:12288
    ds_write_b128 v5, v[192:195] offset:13312
    ds_write_b128 v5, v[196:199] offset:14336
    ds_write_b128 v5, v[200:203] offset:15360
    ds_write_b128 v5, v[204:207] offset:16384
    ds_write_b128 v5, v[208:211] offset:17408
    ds_write_b128 v5, v[212:215] offset:18432
    ds_write_b128 v5, v[216:219] offset:19456
    s_waitcnt vmcnt(0) lgkmcnt(0)
    s_barrier
    ds_read_b128 v[32:35], v6 offset:0
    ds_read_b128 v[36:39], v6 offset:20480
    ds_read_b128 v[40:43], v9 offset:0
    ds_read_b128 v[44:47], v9 offset:20480
    ds_read_b128 v[48:51], v6 offset:4096
    ds_read_b128 v[52:55], v6 offset:24576
    ds_read_b128 v[56:59], v9 offset:4096
    ds_read_b128 v[60:63], v9 offset:24576
    ds_read_b128 v[64:67], v6 offset:8192
    ds_read_b128 v[68:71], v6 offset:28672
    ds_read_b128 v[72:75], v9 offset:8192
    ds_read_b128 v[76:79], v9 offset:28672
    ds_read_b128 v[80:83], v6 offset:12288
    ds_read_b128 v[84:87], v6 offset:32768
    ds_read_b128 v[88:91], v9 offset:12288
    ds_read_b128 v[92:95], v9 offset:32768
    ds_read_b128 v[96:99], v6 offset:16384
    ds_read_b128 v[100:103], v6 offset:36864
    ds_read_b128 v[104:107], v9 offset:16384
    ds_read_b128 v[108:111], v9 offset:36864
    s_waitcnt lgkmcnt(0)
    s_barrier
    v_add_f32 v32, v32, v36
    v_add_f32 v40, v40, v44
    v_add_f32 v33, v33, v37
    v_add_f32 v41, v41, v45
    v_add_f32 v34, v34, v38
    v_add_f32 v42, v42, v46
    v_add_f32 v35, v35, v39
    v_add_f32 v43, v43, v47
    v_add_f32 v32, v32, v40
    v_add_f32 v33, v33, v41
    v_add_f32 v34, v34, v42
    v_add_f32 v35, v35, v43
    v_cvt_pk_bf16_f32 v36, v32, v33
    v_cvt_pk_bf16_f32 v37, v34, v35
    v_lshlrev_b32 v32, 16, v36
    v_and_b32 v33, 0xffff0000, v36
    v_lshlrev_b32 v34, 16, v37
    v_and_b32 v35, 0xffff0000, v37
    v_add_f32 v48, v48, v52
    v_add_f32 v56, v56, v60
    v_add_f32 v49, v49, v53
    v_add_f32 v57, v57, v61
    v_add_f32 v50, v50, v54
    v_add_f32 v58, v58, v62
    v_add_f32 v51, v51, v55
    v_add_f32 v59, v59, v63
    v_add_f32 v48, v48, v56
    v_add_f32 v49, v49, v57
    v_add_f32 v50, v50, v58
    v_add_f32 v51, v51, v59
    v_cvt_pk_bf16_f32 v52, v48, v49
    v_cvt_pk_bf16_f32 v53, v50, v51
    v_lshlrev_b32 v48, 16, v52
    v_and_b32 v49, 0xffff0000, v52
    v_lshlrev_b32 v50, 16, v53
    v_and_b32 v51, 0xffff0000, v53
    v_add_f32 v64, v64, v68
    v_add_f32 v72, v72, v76
    v_add_f32 v65, v65, v69
    v_add_f32 v73, v73, v77
    v_add_f32 v66, v66, v70
    v_add_f32 v74, v74, v78
    v_add_f32 v67, v67, v71
    v_add_f32 v75, v75, v79
    v_add_f32 v64, v64, v72
    v_add_f32 v65, v65, v73
    v_add_f32 v66, v66, v74
    v_add_f32 v67, v67, v75
    v_cvt_pk_bf16_f32 v68, v64, v65
    v_cvt_pk_bf16_f32 v69, v66, v67
    v_lshlrev_b32 v64, 16, v68
    v_and_b32 v65, 0xffff0000, v68
    v_lshlrev_b32 v66, 16, v69
    v_and_b32 v67, 0xffff0000, v69
    v_add_f32 v80, v80, v84
    v_add_f32 v88, v88, v92
    v_add_f32 v81, v81, v85
    v_add_f32 v89, v89, v93
    v_add_f32 v82, v82, v86
    v_add_f32 v90, v90, v94
    v_add_f32 v83, v83, v87
    v_add_f32 v91, v91, v95
    v_add_f32 v80, v80, v88
    v_add_f32 v81, v81, v89
    v_add_f32 v82, v82, v90
    v_add_f32 v83, v83, v91
    v_cvt_pk_bf16_f32 v84, v80, v81
    v_cvt_pk_bf16_f32 v85, v82, v83
    v_lshlrev_b32 v80, 16, v84
    v_and_b32 v81, 0xffff0000, v84
    v_lshlrev_b32 v82, 16, v85
    v_and_b32 v83, 0xffff0000, v85
    v_add_f32 v96, v96, v100
    v_add_f32 v104, v104, v108
    v_add_f32 v97, v97, v101
    v_add_f32 v105, v105, v109
    v_add_f32 v98, v98, v102
    v_add_f32 v106, v106, v110
    v_add_f32 v99, v99, v103
    v_add_f32 v107, v107, v111
    v_add_f32 v96, v96, v104
    v_add_f32 v97, v97, v105
    v_add_f32 v98, v98, v106
    v_add_f32 v99, v99, v107
    v_cvt_pk_bf16_f32 v100, v96, v97
    v_cvt_pk_bf16_f32 v101, v98, v99
    v_lshlrev_b32 v96, 16, v100
    v_and_b32 v97, 0xffff0000, v100
    v_lshlrev_b32 v98, 16, v101
    v_and_b32 v99, 0xffff0000, v101
    v_mul_f32 v32, v7, v32
    v_mul_f32 v33, v7, v33
    v_mul_f32 v34, v7, v34
    v_mul_f32 v35, v7, v35
    v_cvt_pk_bf16_f32 v36, v32, v33
    v_cvt_pk_bf16_f32 v37, v34, v35
    v_lshlrev_b32 v32, 16, v36
    v_and_b32 v33, 0xffff0000, v36
    v_lshlrev_b32 v34, 16, v37
    v_and_b32 v35, 0xffff0000, v37
    v_lshlrev_b32 v40, 16, v220
    v_and_b32 v41, 0xffff0000, v220
    v_lshlrev_b32 v42, 16, v221
    v_and_b32 v43, 0xffff0000, v221
    v_add_f32 v32, v32, v40
    v_add_f32 v33, v33, v41
    v_add_f32 v34, v34, v42
    v_add_f32 v35, v35, v43
    v_cvt_pk_bf16_f32 v36, v32, v33
    v_cvt_pk_bf16_f32 v37, v34, v35
    buffer_store_dwordx2 v[36:37], v4, s[12:15], s22 offen offset:0
    v_mul_f32 v48, v7, v48
    v_mul_f32 v49, v7, v49
    v_mul_f32 v50, v7, v50
    v_mul_f32 v51, v7, v51
    v_cvt_pk_bf16_f32 v52, v48, v49
    v_cvt_pk_bf16_f32 v53, v50, v51
    v_lshlrev_b32 v48, 16, v52
    v_and_b32 v49, 0xffff0000, v52
    v_lshlrev_b32 v50, 16, v53
    v_and_b32 v51, 0xffff0000, v53
    v_lshlrev_b32 v56, 16, v224
    v_and_b32 v57, 0xffff0000, v224
    v_lshlrev_b32 v58, 16, v225
    v_and_b32 v59, 0xffff0000, v225
    v_add_f32 v48, v48, v56
    v_add_f32 v49, v49, v57
    v_add_f32 v50, v50, v58
    v_add_f32 v51, v51, v59
    v_cvt_pk_bf16_f32 v52, v48, v49
    v_cvt_pk_bf16_f32 v53, v50, v51
    buffer_store_dwordx2 v[52:53], v4, s[12:15], s22 offen offset:32
    v_mul_f32 v64, v7, v64
    v_mul_f32 v65, v7, v65
    v_mul_f32 v66, v7, v66
    v_mul_f32 v67, v7, v67
    v_cvt_pk_bf16_f32 v68, v64, v65
    v_cvt_pk_bf16_f32 v69, v66, v67
    v_lshlrev_b32 v64, 16, v68
    v_and_b32 v65, 0xffff0000, v68
    v_lshlrev_b32 v66, 16, v69
    v_and_b32 v67, 0xffff0000, v69
    v_lshlrev_b32 v72, 16, v228
    v_and_b32 v73, 0xffff0000, v228
    v_lshlrev_b32 v74, 16, v229
    v_and_b32 v75, 0xffff0000, v229
    v_add_f32 v64, v64, v72
    v_add_f32 v65, v65, v73
    v_add_f32 v66, v66, v74
    v_add_f32 v67, v67, v75
    v_cvt_pk_bf16_f32 v68, v64, v65
    v_cvt_pk_bf16_f32 v69, v66, v67
    buffer_store_dwordx2 v[68:69], v4, s[12:15], s22 offen offset:64
    v_mul_f32 v80, v7, v80
    v_mul_f32 v81, v7, v81
    v_mul_f32 v82, v7, v82
    v_mul_f32 v83, v7, v83
    v_cvt_pk_bf16_f32 v84, v80, v81
    v_cvt_pk_bf16_f32 v85, v82, v83
    v_lshlrev_b32 v80, 16, v84
    v_and_b32 v81, 0xffff0000, v84
    v_lshlrev_b32 v82, 16, v85
    v_and_b32 v83, 0xffff0000, v85
    v_lshlrev_b32 v88, 16, v232
    v_and_b32 v89, 0xffff0000, v232
    v_lshlrev_b32 v90, 16, v233
    v_and_b32 v91, 0xffff0000, v233
    v_add_f32 v80, v80, v88
    v_add_f32 v81, v81, v89
    v_add_f32 v82, v82, v90
    v_add_f32 v83, v83, v91
    v_cvt_pk_bf16_f32 v84, v80, v81
    v_cvt_pk_bf16_f32 v85, v82, v83
    buffer_store_dwordx2 v[84:85], v4, s[12:15], s22 offen offset:96
    v_mul_f32 v96, v7, v96
    v_mul_f32 v97, v7, v97
    v_mul_f32 v98, v7, v98
    v_mul_f32 v99, v7, v99
    v_cvt_pk_bf16_f32 v100, v96, v97
    v_cvt_pk_bf16_f32 v101, v98, v99
    v_lshlrev_b32 v96, 16, v100
    v_and_b32 v97, 0xffff0000, v100
    v_lshlrev_b32 v98, 16, v101
    v_and_b32 v99, 0xffff0000, v101
    v_lshlrev_b32 v104, 16, v236
    v_and_b32 v105, 0xffff0000, v236
    v_lshlrev_b32 v106, 16, v237
    v_and_b32 v107, 0xffff0000, v237
    v_add_f32 v96, v96, v104
    v_add_f32 v97, v97, v105
    v_add_f32 v98, v98, v106
    v_add_f32 v99, v99, v107
    v_cvt_pk_bf16_f32 v100, v96, v97
    v_cvt_pk_bf16_f32 v101, v98, v99
    buffer_store_dwordx2 v[100:101], v4, s[12:15], s22 offen offset:128
    s_branch L_ch_hend
L_ch_hl:
    s_mul_hi_u32 s18, s17, 0xccccccd
    s_mul_i32 s19, s18, 20
    s_sub_u32 s19, s17, s19
    s_mov_b32 s55, 0
    s_add_u32 s20, s18, 25
    s_lshl_b32 s20, s20, 2
    s_mov_b32 s28, 4
    s_mov_b32 s35, 1
    s_cmp_lt_u32 s18, 5
    s_cbranch_scc1 L_ch_hl2
    s_add_u32 s20, s18, 115
    s_mov_b32 s28, 2
    s_mov_b32 s35, 4
L_ch_hl2:
    s_lshr_b32 s72, s20, 1
    s_lshr_b32 s53, s20, 2
    s_mul_i32 s30, s35, 55296
    s_lshl_b32 s32, s35, 6
    s_lshl_b32 s33, s35, 17
    s_mul_i32 s34, s35, 20480
    s_and_b32 s31, s35, 1
    s_lshr_b32 s36, s35, 2
    s_add_u32 s36, s36, 1
    s_load_dwordx2 s[6:7], s[0:1], 96
    s_waitcnt lgkmcnt(0)
    s_mov_b32 s12, s6
    s_mov_b32 s13, s7
    s_mov_b32 s14, 2621440
    s_mov_b32 s15, 0x00020000
    v_and_b32 v1, 15, v0
    v_lshrrev_b32 v2, 4, v0
    v_lshlrev_b32 v3, 4, v0
    s_lshl_b32 s21, s20, 4
    v_add_u32 v4, s21, v1
    v_lshlrev_b32 v26, 2, v4
    v_mul_u32_u24 v4, 1280, v4
    v_lshlrev_b32 v5, 3, v2
    v_add_u32 v4, v4, v5
    s_and_b32 s24, s16, 1
    s_lshl_b32 s22, s19, 1
    s_add_u32 s22, s22, s24
    s_lshl_b32 s22, s22, 5
    s_lshl_b32 s23, s16, 10
    v_add_u32 v9, s23, v3
    v_add_u32 v5, s23, v3
    s_lshl_b32 s24, s24, 12
    v_add_u32 v6, s24, v3
    s_mul_i32 s60, s19, 110592
    s_add_u32 s60, s60, 25395200
    s_add_u32 s61, s60, 55296
    s_add_u32 s44, s60, 0
    buffer_load_dwordx4 a[0:3], v9, s[8:11], s44 offen
    s_add_u32 s44, s61, 0
    buffer_load_dwordx4 a[128:131], v9, s[8:11], s44 offen
    s_add_u32 s44, s60, 4096
    buffer_load_dwordx4 a[4:7], v9, s[8:11], s44 offen
    s_add_u32 s44, s61, 4096
    buffer_load_dwordx4 a[132:135], v9, s[8:11], s44 offen
    s_add_u32 s44, s60, 8192
    buffer_load_dwordx4 a[8:11], v9, s[8:11], s44 offen
    s_add_u32 s44, s61, 8192
    buffer_load_dwordx4 a[136:139], v9, s[8:11], s44 offen
    s_add_u32 s44, s60, 12288
    buffer_load_dwordx4 a[12:15], v9, s[8:11], s44 offen
    s_add_u32 s44, s61, 12288
    buffer_load_dwordx4 a[140:143], v9, s[8:11], s44 offen
    s_add_u32 s44, s60, 16384
    buffer_load_dwordx4 a[16:19], v9, s[8:11], s44 offen
    s_add_u32 s44, s61, 16384
    buffer_load_dwordx4 a[144:147], v9, s[8:11], s44 offen
    s_add_u32 s44, s60, 20480
    buffer_load_dwordx4 a[20:23], v9, s[8:11], s44 offen
    s_add_u32 s44, s61, 20480
    buffer_load_dwordx4 a[148:151], v9, s[8:11], s44 offen
    s_add_u32 s44, s60, 24576
    buffer_load_dwordx4 a[24:27], v9, s[8:11], s44 offen
    s_add_u32 s44, s61, 24576
    buffer_load_dwordx4 a[152:155], v9, s[8:11], s44 offen
    s_add_u32 s44, s60, 28672
    buffer_load_dwordx4 a[28:31], v9, s[8:11], s44 offen
    s_add_u32 s44, s61, 28672
    buffer_load_dwordx4 a[156:159], v9, s[8:11], s44 offen
    s_add_u32 s44, s60, 32768
    buffer_load_dwordx4 a[32:35], v9, s[8:11], s44 offen
    s_add_u32 s44, s61, 32768
    buffer_load_dwordx4 a[160:163], v9, s[8:11], s44 offen
    s_add_u32 s44, s60, 36864
    buffer_load_dwordx4 a[36:39], v9, s[8:11], s44 offen
    s_add_u32 s44, s61, 36864
    buffer_load_dwordx4 a[164:167], v9, s[8:11], s44 offen
    s_add_u32 s44, s60, 40960
    buffer_load_dwordx4 a[40:43], v9, s[8:11], s44 offen
    s_add_u32 s44, s61, 40960
    buffer_load_dwordx4 a[168:171], v9, s[8:11], s44 offen
    s_add_u32 s44, s60, 45056
    buffer_load_dwordx4 a[44:47], v9, s[8:11], s44 offen
    s_add_u32 s44, s61, 45056
    buffer_load_dwordx4 a[172:175], v9, s[8:11], s44 offen
    s_add_u32 s44, s60, 49152
    buffer_load_dwordx4 a[48:51], v9, s[8:11], s44 offen
    s_add_u32 s44, s61, 49152
    buffer_load_dwordx4 a[176:179], v9, s[8:11], s44 offen
    s_cmp_lt_u32 s16, 2
    s_cselect_b32 s47, 0, 4096
    s_sub_u32 s44, s60, s47
    s_add_u32 s44, s44, 53248
    buffer_load_dwordx4 a[52:55], v9, s[8:11], s44 offen
    s_cmp_lt_u32 s16, 2
    s_cselect_b32 s47, 0, 4096
    s_sub_u32 s44, s61, s47
    s_add_u32 s44, s44, 53248
    buffer_load_dwordx4 a[180:183], v9, s[8:11], s44 offen
    s_lshr_b32 s70, s53, 2
    s_lshl_b32 s70, s70, 5
    s_add_u32 s70, s70, 120596224
L_chw_46:
    v_lshlrev_b32 v10, 2, v0
    v_cmp_gt_u32 vcc, 8, v0
    s_mov_b64 exec, vcc
    buffer_load_dword v11, v10, s[8:11], s70 offen sc1
    s_waitcnt vmcnt(0)
    v_cmp_gt_i32 vcc, 0, v11
    s_mov_b64 exec, -1
    s_cbranch_vccz L_chw_46_d
    s_sleep 16
    s_branch L_chw_46
L_chw_46_d:
    s_mul_i32 s62, s20, 55296
    s_add_u32 s62, s62, 111493120
    s_mov_b32 s21, 118571008
    s_mov_b32 s29, 0
    v_add_u32 v27, 8192, v9
L_fl_b:
    buffer_load_dword v22, v26, s[8:11], s21 offen sc1
    s_add_u32 s45, s62, 0
    buffer_load_dwordx4 v[32:35], v9, s[8:11], s45 offen sc1
    s_add_u32 s45, s62, 4096
    buffer_load_dwordx4 v[36:39], v9, s[8:11], s45 offen sc1
    s_add_u32 s45, s62, 8192
    buffer_load_dwordx4 v[40:43], v9, s[8:11], s45 offen sc1
    s_add_u32 s45, s62, 12288
    buffer_load_dwordx4 v[44:47], v9, s[8:11], s45 offen sc1
    s_add_u32 s45, s62, 16384
    buffer_load_dwordx4 v[48:51], v9, s[8:11], s45 offen sc1
    s_add_u32 s45, s62, 20480
    buffer_load_dwordx4 v[52:55], v9, s[8:11], s45 offen sc1
    s_add_u32 s45, s62, 24576
    buffer_load_dwordx4 v[56:59], v9, s[8:11], s45 offen sc1
    s_add_u32 s45, s62, 28672
    buffer_load_dwordx4 v[60:63], v9, s[8:11], s45 offen sc1
    s_add_u32 s45, s62, 32768
    buffer_load_dwordx4 v[64:67], v9, s[8:11], s45 offen sc1
    s_add_u32 s45, s62, 36864
    buffer_load_dwordx4 v[68:71], v9, s[8:11], s45 offen sc1
    s_add_u32 s45, s62, 40960
    buffer_load_dwordx4 v[72:75], v9, s[8:11], s45 offen sc1
    s_add_u32 s45, s62, 45056
    buffer_load_dwordx4 v[76:79], v9, s[8:11], s45 offen sc1
    s_add_u32 s45, s62, 49152
    buffer_load_dwordx4 v[80:83], v9, s[8:11], s45 offen sc1
    s_cmp_lt_u32 s16, 2
    s_cselect_b32 s47, 0, 4096
    s_sub_u32 s45, s62, s47
    s_add_u32 s45, s45, 53248
    buffer_load_dwordx4 v[84:87], v9, s[8:11], s45 offen sc1
    s_waitcnt vmcnt(13)
    v_mfma_f32_16x16x32_bf16 v[12:15], a[0:3], v[32:35], 0
    v_mfma_f32_16x16x32_bf16 v[16:19], a[128:131], v[32:35], 0
    s_waitcnt vmcnt(12)
    v_mfma_f32_16x16x32_bf16 v[12:15], a[4:7], v[36:39], v[12:15]
    v_mfma_f32_16x16x32_bf16 v[16:19], a[132:135], v[36:39], v[16:19]
    s_waitcnt vmcnt(11)
    v_mfma_f32_16x16x32_bf16 v[12:15], a[8:11], v[40:43], v[12:15]
    v_mfma_f32_16x16x32_bf16 v[16:19], a[136:139], v[40:43], v[16:19]
    s_waitcnt vmcnt(10)
    v_mfma_f32_16x16x32_bf16 v[12:15], a[12:15], v[44:47], v[12:15]
    v_mfma_f32_16x16x32_bf16 v[16:19], a[140:143], v[44:47], v[16:19]
    s_waitcnt vmcnt(9)
    v_mfma_f32_16x16x32_bf16 v[12:15], a[16:19], v[48:51], v[12:15]
    v_mfma_f32_16x16x32_bf16 v[16:19], a[144:147], v[48:51], v[16:19]
    s_waitcnt vmcnt(8)
    v_mfma_f32_16x16x32_bf16 v[12:15], a[20:23], v[52:55], v[12:15]
    v_mfma_f32_16x16x32_bf16 v[16:19], a[148:151], v[52:55], v[16:19]
    s_waitcnt vmcnt(7)
    v_mfma_f32_16x16x32_bf16 v[12:15], a[24:27], v[56:59], v[12:15]
    v_mfma_f32_16x16x32_bf16 v[16:19], a[152:155], v[56:59], v[16:19]
    s_waitcnt vmcnt(6)
    v_mfma_f32_16x16x32_bf16 v[12:15], a[28:31], v[60:63], v[12:15]
    v_mfma_f32_16x16x32_bf16 v[16:19], a[156:159], v[60:63], v[16:19]
    s_waitcnt vmcnt(5)
    v_mfma_f32_16x16x32_bf16 v[12:15], a[32:35], v[64:67], v[12:15]
    v_mfma_f32_16x16x32_bf16 v[16:19], a[160:163], v[64:67], v[16:19]
    s_waitcnt vmcnt(4)
    v_mfma_f32_16x16x32_bf16 v[12:15], a[36:39], v[68:71], v[12:15]
    v_mfma_f32_16x16x32_bf16 v[16:19], a[164:167], v[68:71], v[16:19]
    s_waitcnt vmcnt(3)
    v_mfma_f32_16x16x32_bf16 v[12:15], a[40:43], v[72:75], v[12:15]
    v_mfma_f32_16x16x32_bf16 v[16:19], a[168:171], v[72:75], v[16:19]
    s_waitcnt vmcnt(2)
    v_mfma_f32_16x16x32_bf16 v[12:15], a[44:47], v[76:79], v[12:15]
    v_mfma_f32_16x16x32_bf16 v[16:19], a[172:175], v[76:79], v[16:19]
    s_waitcnt vmcnt(1)
    v_mfma_f32_16x16x32_bf16 v[12:15], a[48:51], v[80:83], v[12:15]
    v_mfma_f32_16x16x32_bf16 v[16:19], a[176:179], v[80:83], v[16:19]
    s_waitcnt vmcnt(0)
    s_cmp_ge_u32 s16, 2
    s_cbranch_scc1 L_fl_47
    v_mfma_f32_16x16x32_bf16 v[12:15], a[52:55], v[84:87], v[12:15]
    v_mfma_f32_16x16x32_bf16 v[16:19], a[180:183], v[84:87], v[16:19]
L_fl_47:
    s_nop 7
    s_nop 3
    ds_write_b128 v5, v[12:15]
    ds_write_b128 v5, v[16:19] offset:4096
    s_waitcnt lgkmcnt(0)
    s_barrier
    ds_read_b128 v[32:35], v6 offset:0
    ds_read_b128 v[36:39], v6 offset:1024
    ds_read_b128 v[40:43], v6 offset:2048
    ds_read_b128 v[44:47], v6 offset:3072
    s_waitcnt lgkmcnt(0)
    s_barrier
    v_add_f32 v32, v32, v36
    v_add_f32 v40, v40, v44
    v_add_f32 v33, v33, v37
    v_add_f32 v41, v41, v45
    v_add_f32 v34, v34, v38
    v_add_f32 v42, v42, v46
    v_add_f32 v35, v35, v39
    v_add_f32 v43, v43, v47
    v_add_f32 v32, v32, v40
    v_add_f32 v33, v33, v41
    v_add_f32 v34, v34, v42
    v_add_f32 v35, v35, v43
    v_cvt_pk_bf16_f32 v36, v32, v33
    v_cvt_pk_bf16_f32 v37, v34, v35
    v_lshlrev_b32 v32, 16, v36
    v_and_b32 v33, 0xffff0000, v36
    v_lshlrev_b32 v34, 16, v37
    v_and_b32 v35, 0xffff0000, v37
    v_sub_f32 v8, 1.0, v22
    v_cvt_pk_bf16_f32 v8, v8, v8
    v_lshlrev_b32 v8, 16, v8
    v_mul_f32 v32, v8, v32
    v_mul_f32 v33, v8, v33
    v_mul_f32 v34, v8, v34
    v_mul_f32 v35, v8, v35
    v_cvt_pk_bf16_f32 v20, v32, v33
    v_cvt_pk_bf16_f32 v21, v34, v35
    ds_write_b96 v27, v[20:22]
    s_waitcnt lgkmcnt(0)
    v_add_u32 v27, 4096, v27
    s_add_u32 s62, s62, s30
    s_add_u32 s21, s21, s32
    s_add_u32 s29, s29, 1
    s_cmp_lt_u32 s29, s28
    s_cbranch_scc1 L_fl_b
    s_lshl_b32 s60, s19, 18
    s_add_u32 s60, s60, 15728640
    s_add_u32 s61, s60, 131072
    s_add_u32 s44, s60, 0
    buffer_load_dwordx4 a[0:3], v9, s[8:11], s44 offen
    s_add_u32 s44, s61, 0
    buffer_load_dwordx4 a[128:131], v9, s[8:11], s44 offen
    s_add_u32 s44, s60, 4096
    buffer_load_dwordx4 a[4:7], v9, s[8:11], s44 offen
    s_add_u32 s44, s61, 4096
    buffer_load_dwordx4 a[132:135], v9, s[8:11], s44 offen
    s_add_u32 s44, s60, 8192
    buffer_load_dwordx4 a[8:11], v9, s[8:11], s44 offen
    s_add_u32 s44, s61, 8192
    buffer_load_dwordx4 a[136:139], v9, s[8:11], s44 offen
    s_add_u32 s44, s60, 12288
    buffer_load_dwordx4 a[12:15], v9, s[8:11], s44 offen
    s_add_u32 s44, s61, 12288
    buffer_load_dwordx4 a[140:143], v9, s[8:11], s44 offen
    s_add_u32 s44, s60, 16384
    buffer_load_dwordx4 a[16:19], v9, s[8:11], s44 offen
    s_add_u32 s44, s61, 16384
    buffer_load_dwordx4 a[144:147], v9, s[8:11], s44 offen
    s_add_u32 s44, s60, 20480
    buffer_load_dwordx4 a[20:23], v9, s[8:11], s44 offen
    s_add_u32 s44, s61, 20480
    buffer_load_dwordx4 a[148:151], v9, s[8:11], s44 offen
    s_add_u32 s44, s60, 24576
    buffer_load_dwordx4 a[24:27], v9, s[8:11], s44 offen
    s_add_u32 s44, s61, 24576
    buffer_load_dwordx4 a[152:155], v9, s[8:11], s44 offen
    s_add_u32 s44, s60, 28672
    buffer_load_dwordx4 a[28:31], v9, s[8:11], s44 offen
    s_add_u32 s44, s61, 28672
    buffer_load_dwordx4 a[156:159], v9, s[8:11], s44 offen
    s_add_u32 s44, s60, 32768
    buffer_load_dwordx4 a[32:35], v9, s[8:11], s44 offen
    s_add_u32 s44, s61, 32768
    buffer_load_dwordx4 a[160:163], v9, s[8:11], s44 offen
    s_add_u32 s44, s60, 36864
    buffer_load_dwordx4 a[36:39], v9, s[8:11], s44 offen
    s_add_u32 s44, s61, 36864
    buffer_load_dwordx4 a[164:167], v9, s[8:11], s44 offen
    s_add_u32 s44, s60, 40960
    buffer_load_dwordx4 a[40:43], v9, s[8:11], s44 offen
    s_add_u32 s44, s61, 40960
    buffer_load_dwordx4 a[168:171], v9, s[8:11], s44 offen
    s_add_u32 s44, s60, 45056
    buffer_load_dwordx4 a[44:47], v9, s[8:11], s44 offen
    s_add_u32 s44, s61, 45056
    buffer_load_dwordx4 a[172:175], v9, s[8:11], s44 offen
    s_add_u32 s44, s60, 49152
    buffer_load_dwordx4 a[48:51], v9, s[8:11], s44 offen
    s_add_u32 s44, s61, 49152
    buffer_load_dwordx4 a[176:179], v9, s[8:11], s44 offen
    s_add_u32 s44, s60, 53248
    buffer_load_dwordx4 a[52:55], v9, s[8:11], s44 offen
    s_add_u32 s44, s61, 53248
    buffer_load_dwordx4 a[180:183], v9, s[8:11], s44 offen
    s_add_u32 s44, s60, 57344
    buffer_load_dwordx4 a[56:59], v9, s[8:11], s44 offen
    s_add_u32 s44, s61, 57344
    buffer_load_dwordx4 a[184:187], v9, s[8:11], s44 offen
    s_add_u32 s44, s60, 61440
    buffer_load_dwordx4 a[60:63], v9, s[8:11], s44 offen
    s_add_u32 s44, s61, 61440
    buffer_load_dwordx4 a[188:191], v9, s[8:11], s44 offen
    s_add_u32 s44, s60, 65536
    buffer_load_dwordx4 a[64:67], v9, s[8:11], s44 offen
    s_add_u32 s44, s61, 65536
    buffer_load_dwordx4 a[192:195], v9, s[8:11], s44 offen
    s_add_u32 s44, s60, 69632
    buffer_load_dwordx4 a[68:71], v9, s[8:11], s44 offen
    s_add_u32 s44, s61, 69632
    buffer_load_dwordx4 a[196:199], v9, s[8:11], s44 offen
    s_add_u32 s44, s60, 73728
    buffer_load_dwordx4 a[72:75], v9, s[8:11], s44 offen
    s_add_u32 s44, s61, 73728
    buffer_load_dwordx4 a[200:203], v9, s[8:11], s44 offen
    s_add_u32 s44, s60, 77824
    buffer_load_dwordx4 a[76:79], v9, s[8:11], s44 offen
    s_add_u32 s44, s61, 77824
    buffer_load_dwordx4 a[204:207], v9, s[8:11], s44 offen
    s_add_u32 s44, s60, 81920
    buffer_load_dwordx4 a[80:83], v9, s[8:11], s44 offen
    s_add_u32 s44, s61, 81920
    buffer_load_dwordx4 a[208:211], v9, s[8:11], s44 offen
    s_add_u32 s44, s60, 86016
    buffer_load_dwordx4 a[84:87], v9, s[8:11], s44 offen
    s_add_u32 s44, s61, 86016
    buffer_load_dwordx4 a[212:215], v9, s[8:11], s44 offen
    s_add_u32 s44, s60, 90112
    buffer_load_dwordx4 a[88:91], v9, s[8:11], s44 offen
    s_add_u32 s44, s61, 90112
    buffer_load_dwordx4 a[216:219], v9, s[8:11], s44 offen
    s_add_u32 s44, s60, 94208
    buffer_load_dwordx4 a[92:95], v9, s[8:11], s44 offen
    s_add_u32 s44, s61, 94208
    buffer_load_dwordx4 a[220:223], v9, s[8:11], s44 offen
    s_add_u32 s44, s60, 98304
    buffer_load_dwordx4 a[96:99], v9, s[8:11], s44 offen
    s_add_u32 s44, s61, 98304
    buffer_load_dwordx4 a[224:227], v9, s[8:11], s44 offen
    s_add_u32 s44, s60, 102400
    buffer_load_dwordx4 a[100:103], v9, s[8:11], s44 offen
    s_add_u32 s44, s61, 102400
    buffer_load_dwordx4 a[228:231], v9, s[8:11], s44 offen
    s_add_u32 s44, s60, 106496
    buffer_load_dwordx4 a[104:107], v9, s[8:11], s44 offen
    s_add_u32 s44, s61, 106496
    buffer_load_dwordx4 a[232:235], v9, s[8:11], s44 offen
    s_add_u32 s44, s60, 110592
    buffer_load_dwordx4 a[108:111], v9, s[8:11], s44 offen
    s_add_u32 s44, s61, 110592
    buffer_load_dwordx4 a[236:239], v9, s[8:11], s44 offen
    s_add_u32 s44, s60, 114688
    buffer_load_dwordx4 a[112:115], v9, s[8:11], s44 offen
    s_add_u32 s44, s61, 114688
    buffer_load_dwordx4 a[240:243], v9, s[8:11], s44 offen
    s_add_u32 s44, s60, 118784
    buffer_load_dwordx4 a[116:119], v9, s[8:11], s44 offen
    s_add_u32 s44, s61, 118784
    buffer_load_dwordx4 a[244:247], v9, s[8:11], s44 offen
    s_add_u32 s44, s60, 122880
    buffer_load_dwordx4 a[120:123], v9, s[8:11], s44 offen
    s_add_u32 s44, s61, 122880
    buffer_load_dwordx4 a[248:251], v9, s[8:11], s44 offen
    s_add_u32 s44, s60, 126976
    buffer_load_dwordx4 a[124:127], v9, s[8:11], s44 offen
    s_add_u32 s44, s61, 126976
    buffer_load_dwordx4 a[252:255], v9, s[8:11], s44 offen
    s_lshl_b32 s62, s20, 17
    s_add_u32 s62, s62, 94715904
    s_mov_b32 s29, 0
    v_add_u32 v27, 8192, v9
L_fl_a:
    ds_read_b96 v[20:22], v27
    s_and_b32 s47, s29, s31
    s_cbranch_scc1 L_fl_a2
    s_cmp_lg_u32 s16, 0
    s_cbranch_scc1 L_chl_48_w
    s_load_dwordx2 s[6:7], s[0:1], 104
    s_waitcnt lgkmcnt(0)
    s_mov_b32 s84, s6
    s_mov_b32 s85, s7
    s_mov_b32 s86, 256
    s_mov_b32 s87, 0x00020000
    v_mov_b32 v28, 0
    buffer_load_dword v29, v28, s[84:87], 0 offen offset:192 sc1
    s_cmp_eq_u32 s72, 63
    s_cbranch_scc1 L_chl_48_c
    s_cmp_eq_u32 s72, 62
    s_cbranch_scc1 L_chl_48_b
    s_mov_b32 s70, 120537088
    s_mov_b32 s71, s72
L_chw_49:
    v_lshlrev_b32 v10, 2, v0
    v_cmp_gt_u32 vcc, 1, v0
    s_mov_b64 exec, vcc
    buffer_load_dword v11, v10, s[8:11], s70 offen sc1
    s_waitcnt vmcnt(0)
    v_cmp_gt_i32 vcc, s71, v11
    s_mov_b64 exec, -1
    s_cbranch_vccz L_chw_49_d
    s_sleep 32
    s_branch L_chw_49
L_chw_49_d:
L_chl_48_b:
    s_lshl_b32 s70, s72, 5
    s_add_u32 s70, s70, 120596736
L_chw_50:
    v_lshlrev_b32 v10, 2, v0
    v_cmp_gt_u32 vcc, 8, v0
    s_mov_b64 exec, vcc
    buffer_load_dword v11, v10, s[8:11], s70 offen sc1
    s_waitcnt vmcnt(0)
    v_cmp_gt_i32 vcc, 0, v11
    s_mov_b64 exec, -1
    s_cbranch_vccz L_chw_50_d
    s_sleep 4
    s_branch L_chw_50
L_chw_50_d:
    v_mov_b32 v28, 69760
    ds_write_b32 v28, v29
    s_waitcnt lgkmcnt(0)
L_chl_48_w:
    s_cmp_eq_u32 s72, 63
    s_cbranch_scc1 L_chl_48_c
    s_waitcnt vmcnt(0)
    s_barrier
    s_branch L_chl_48_e
L_chl_48_c:
    s_and_b32 s70, s20, 1
    s_lshl_b32 s70, s70, 2
    s_add_u32 s70, s70, s16
    s_lshl_b32 s70, s70, 7
    s_add_u32 s70, s70, 120601088
    v_lshlrev_b32 v10, 2, v0
    v_mov_b32 v11, -1
    v_cmp_gt_u32 vcc, 32, v0
    s_mov_b64 exec, vcc
L_chw_51:
    buffer_load_dword v11, v10, s[8:11], s70 offen sc1
    s_sleep 4
    v_cmp_gt_i32 vcc, 0, v11
    s_cbranch_vccnz L_chw_51
    s_mov_b64 exec, -1
    s_cmp_lg_u32 s16, 0
    s_cbranch_scc1 L_chl_48_e
    v_mov_b32 v28, 69760
    ds_write_b32 v28, v29
    s_waitcnt lgkmcnt(0)
L_chl_48_e:
    s_add_u32 s72, s72, s36
L_fl_a2:
    s_add_u32 s45, s62, 0
    buffer_load_dwordx4 v[32:35], v9, s[8:11], s45 offen sc1
    s_add_u32 s45, s62, 4096
    buffer_load_dwordx4 v[36:39], v9, s[8:11], s45 offen sc1
    s_add_u32 s45, s62, 8192
    buffer_load_dwordx4 v[40:43], v9, s[8:11], s45 offen sc1
    s_add_u32 s45, s62, 12288
    buffer_load_dwordx4 v[44:47], v9, s[8:11], s45 offen sc1
    s_add_u32 s45, s62, 16384
    buffer_load_dwordx4 v[48:51], v9, s[8:11], s45 offen sc1
    s_add_u32 s45, s62, 20480
    buffer_load_dwordx4 v[52:55], v9, s[8:11], s45 offen sc1
    s_add_u32 s45, s62, 24576
    buffer_load_dwordx4 v[56:59], v9, s[8:11], s45 offen sc1
    s_add_u32 s45, s62, 28672
    buffer_load_dwordx4 v[60:63], v9, s[8:11], s45 offen sc1
    s_add_u32 s45, s62, 32768
    buffer_load_dwordx4 v[64:67], v9, s[8:11], s45 offen sc1
    s_add_u32 s45, s62, 36864
    buffer_load_dwordx4 v[68:71], v9, s[8:11], s45 offen sc1
    s_add_u32 s45, s62, 40960
    buffer_load_dwordx4 v[72:75], v9, s[8:11], s45 offen sc1
    s_add_u32 s45, s62, 45056
    buffer_load_dwordx4 v[76:79], v9, s[8:11], s45 offen sc1
    s_add_u32 s45, s62, 49152
    buffer_load_dwordx4 v[80:83], v9, s[8:11], s45 offen sc1
    s_add_u32 s45, s62, 53248
    buffer_load_dwordx4 v[84:87], v9, s[8:11], s45 offen sc1
    s_add_u32 s45, s62, 57344
    buffer_load_dwordx4 v[88:91], v9, s[8:11], s45 offen sc1
    s_add_u32 s45, s62, 61440
    buffer_load_dwordx4 v[92:95], v9, s[8:11], s45 offen sc1
    s_add_u32 s45, s62, 65536
    buffer_load_dwordx4 v[96:99], v9, s[8:11], s45 offen sc1
    s_add_u32 s45, s62, 69632
    buffer_load_dwordx4 v[100:103], v9, s[8:11], s45 offen sc1
    s_add_u32 s45, s62, 73728
    buffer_load_dwordx4 v[104:107], v9, s[8:11], s45 offen sc1
    s_add_u32 s45, s62, 77824
    buffer_load_dwordx4 v[108:111], v9, s[8:11], s45 offen sc1
    s_add_u32 s45, s62, 81920
    buffer_load_dwordx4 v[112:115], v9, s[8:11], s45 offen sc1
    s_add_u32 s45, s62, 86016
    buffer_load_dwordx4 v[116:119], v9, s[8:11], s45 offen sc1
    s_add_u32 s45, s62, 90112
    buffer_load_dwordx4 v[120:123], v9, s[8:11], s45 offen sc1
    s_add_u32 s45, s62, 94208
    buffer_load_dwordx4 v[124:127], v9, s[8:11], s45 offen sc1
    s_add_u32 s45, s62, 98304
    buffer_load_dwordx4 v[128:131], v9, s[8:11], s45 offen sc1
    s_add_u32 s45, s62, 102400
    buffer_load_dwordx4 v[132:135], v9, s[8:11], s45 offen sc1
    s_add_u32 s45, s62, 106496
    buffer_load_dwordx4 v[136:139], v9, s[8:11], s45 offen sc1
    s_add_u32 s45, s62, 110592
    buffer_load_dwordx4 v[140:143], v9, s[8:11], s45 offen sc1
    s_add_u32 s45, s62, 114688
    buffer_load_dwordx4 v[144:147], v9, s[8:11], s45 offen sc1
    s_add_u32 s45, s62, 118784
    buffer_load_dwordx4 v[148:151], v9, s[8:11], s45 offen sc1
    s_add_u32 s45, s62, 122880
    buffer_load_dwordx4 v[152:155], v9, s[8:11], s45 offen sc1
    s_add_u32 s45, s62, 126976
    buffer_load_dwordx4 v[156:159], v9, s[8:11], s45 offen sc1
    s_waitcnt vmcnt(31)
    v_mfma_f32_16x16x32_bf16 v[12:15], a[0:3], v[32:35], 0
    v_mfma_f32_16x16x32_bf16 v[16:19], a[128:131], v[32:35], 0
    s_waitcnt vmcnt(30)
    v_mfma_f32_16x16x32_bf16 v[12:15], a[4:7], v[36:39], v[12:15]
    v_mfma_f32_16x16x32_bf16 v[16:19], a[132:135], v[36:39], v[16:19]
    s_waitcnt vmcnt(29)
    v_mfma_f32_16x16x32_bf16 v[12:15], a[8:11], v[40:43], v[12:15]
    v_mfma_f32_16x16x32_bf16 v[16:19], a[136:139], v[40:43], v[16:19]
    s_waitcnt vmcnt(28)
    v_mfma_f32_16x16x32_bf16 v[12:15], a[12:15], v[44:47], v[12:15]
    v_mfma_f32_16x16x32_bf16 v[16:19], a[140:143], v[44:47], v[16:19]
    s_waitcnt vmcnt(27)
    v_mfma_f32_16x16x32_bf16 v[12:15], a[16:19], v[48:51], v[12:15]
    v_mfma_f32_16x16x32_bf16 v[16:19], a[144:147], v[48:51], v[16:19]
    s_waitcnt vmcnt(26)
    v_mfma_f32_16x16x32_bf16 v[12:15], a[20:23], v[52:55], v[12:15]
    v_mfma_f32_16x16x32_bf16 v[16:19], a[148:151], v[52:55], v[16:19]
    s_waitcnt vmcnt(25)
    v_mfma_f32_16x16x32_bf16 v[12:15], a[24:27], v[56:59], v[12:15]
    v_mfma_f32_16x16x32_bf16 v[16:19], a[152:155], v[56:59], v[16:19]
    s_waitcnt vmcnt(24)
    v_mfma_f32_16x16x32_bf16 v[12:15], a[28:31], v[60:63], v[12:15]
    v_mfma_f32_16x16x32_bf16 v[16:19], a[156:159], v[60:63], v[16:19]
    s_waitcnt vmcnt(23)
    v_mfma_f32_16x16x32_bf16 v[12:15], a[32:35], v[64:67], v[12:15]
    v_mfma_f32_16x16x32_bf16 v[16:19], a[160:163], v[64:67], v[16:19]
    s_waitcnt vmcnt(22)
    v_mfma_f32_16x16x32_bf16 v[12:15], a[36:39], v[68:71], v[12:15]
    v_mfma_f32_16x16x32_bf16 v[16:19], a[164:167], v[68:71], v[16:19]
    s_waitcnt vmcnt(21)
    v_mfma_f32_16x16x32_bf16 v[12:15], a[40:43], v[72:75], v[12:15]
    v_mfma_f32_16x16x32_bf16 v[16:19], a[168:171], v[72:75], v[16:19]
    s_waitcnt vmcnt(20)
    v_mfma_f32_16x16x32_bf16 v[12:15], a[44:47], v[76:79], v[12:15]
    v_mfma_f32_16x16x32_bf16 v[16:19], a[172:175], v[76:79], v[16:19]
    s_waitcnt vmcnt(19)
    v_mfma_f32_16x16x32_bf16 v[12:15], a[48:51], v[80:83], v[12:15]
    v_mfma_f32_16x16x32_bf16 v[16:19], a[176:179], v[80:83], v[16:19]
    s_waitcnt vmcnt(18)
    v_mfma_f32_16x16x32_bf16 v[12:15], a[52:55], v[84:87], v[12:15]
    v_mfma_f32_16x16x32_bf16 v[16:19], a[180:183], v[84:87], v[16:19]
    s_waitcnt vmcnt(17)
    v_mfma_f32_16x16x32_bf16 v[12:15], a[56:59], v[88:91], v[12:15]
    v_mfma_f32_16x16x32_bf16 v[16:19], a[184:187], v[88:91], v[16:19]
    s_waitcnt vmcnt(16)
    v_mfma_f32_16x16x32_bf16 v[12:15], a[60:63], v[92:95], v[12:15]
    v_mfma_f32_16x16x32_bf16 v[16:19], a[188:191], v[92:95], v[16:19]
    s_waitcnt vmcnt(15)
    v_mfma_f32_16x16x32_bf16 v[12:15], a[64:67], v[96:99], v[12:15]
    v_mfma_f32_16x16x32_bf16 v[16:19], a[192:195], v[96:99], v[16:19]
    s_waitcnt vmcnt(14)
    v_mfma_f32_16x16x32_bf16 v[12:15], a[68:71], v[100:103], v[12:15]
    v_mfma_f32_16x16x32_bf16 v[16:19], a[196:199], v[100:103], v[16:19]
    s_waitcnt vmcnt(13)
    v_mfma_f32_16x16x32_bf16 v[12:15], a[72:75], v[104:107], v[12:15]
    v_mfma_f32_16x16x32_bf16 v[16:19], a[200:203], v[104:107], v[16:19]
    s_waitcnt vmcnt(12)
    v_mfma_f32_16x16x32_bf16 v[12:15], a[76:79], v[108:111], v[12:15]
    v_mfma_f32_16x16x32_bf16 v[16:19], a[204:207], v[108:111], v[16:19]
    s_waitcnt vmcnt(11)
    v_mfma_f32_16x16x32_bf16 v[12:15], a[80:83], v[112:115], v[12:15]
    v_mfma_f32_16x16x32_bf16 v[16:19], a[208:211], v[112:115], v[16:19]
    s_waitcnt vmcnt(10)
    v_mfma_f32_16x16x32_bf16 v[12:15], a[84:87], v[116:119], v[12:15]
    v_mfma_f32_16x16x32_bf16 v[16:19], a[212:215], v[116:119], v[16:19]
    s_waitcnt vmcnt(9)
    v_mfma_f32_16x16x32_bf16 v[12:15], a[88:91], v[120:123], v[12:15]
    v_mfma_f32_16x16x32_bf16 v[16:19], a[216:219], v[120:123], v[16:19]
    s_waitcnt vmcnt(8)
    v_mfma_f32_16x16x32_bf16 v[12:15], a[92:95], v[124:127], v[12:15]
    v_mfma_f32_16x16x32_bf16 v[16:19], a[220:223], v[124:127], v[16:19]
    s_waitcnt vmcnt(7)
    v_mfma_f32_16x16x32_bf16 v[12:15], a[96:99], v[128:131], v[12:15]
    v_mfma_f32_16x16x32_bf16 v[16:19], a[224:227], v[128:131], v[16:19]
    s_waitcnt vmcnt(6)
    v_mfma_f32_16x16x32_bf16 v[12:15], a[100:103], v[132:135], v[12:15]
    v_mfma_f32_16x16x32_bf16 v[16:19], a[228:231], v[132:135], v[16:19]
    s_waitcnt vmcnt(5)
    v_mfma_f32_16x16x32_bf16 v[12:15], a[104:107], v[136:139], v[12:15]
    v_mfma_f32_16x16x32_bf16 v[16:19], a[232:235], v[136:139], v[16:19]
    s_waitcnt vmcnt(4)
    v_mfma_f32_16x16x32_bf16 v[12:15], a[108:111], v[140:143], v[12:15]
    v_mfma_f32_16x16x32_bf16 v[16:19], a[236:239], v[140:143], v[16:19]
    s_waitcnt vmcnt(3)
    v_mfma_f32_16x16x32_bf16 v[12:15], a[112:115], v[144:147], v[12:15]
    v_mfma_f32_16x16x32_bf16 v[16:19], a[240:243], v[144:147], v[16:19]
    s_waitcnt vmcnt(2)
    v_mfma_f32_16x16x32_bf16 v[12:15], a[116:119], v[148:151], v[12:15]
    v_mfma_f32_16x16x32_bf16 v[16:19], a[244:247], v[148:151], v[16:19]
    s_waitcnt vmcnt(1)
    v_mfma_f32_16x16x32_bf16 v[12:15], a[120:123], v[152:155], v[12:15]
    v_mfma_f32_16x16x32_bf16 v[16:19], a[248:251], v[152:155], v[16:19]
    s_waitcnt vmcnt(0)
    v_mfma_f32_16x16x32_bf16 v[12:15], a[124:127], v[156:159], v[12:15]
    v_mfma_f32_16x16x32_bf16 v[16:19], a[252:255], v[156:159], v[16:19]
    s_nop 7
    s_nop 3
    ds_write_b128 v5, v[12:15]
    ds_write_b128 v5, v[16:19] offset:4096
    s_waitcnt lgkmcnt(0)
    s_barrier
    ds_read_b128 v[32:35], v6 offset:0
    ds_read_b128 v[36:39], v6 offset:1024
    ds_read_b128 v[40:43], v6 offset:2048
    ds_read_b128 v[44:47], v6 offset:3072
    s_waitcnt lgkmcnt(0)
    s_barrier
    v_add_f32 v32, v32, v36
    v_add_f32 v40, v40, v44
    v_add_f32 v33, v33, v37
    v_add_f32 v41, v41, v45
    v_add_f32 v34, v34, v38
    v_add_f32 v42, v42, v46
    v_add_f32 v35, v35, v39
    v_add_f32 v43, v43, v47
    v_add_f32 v32, v32, v40
    v_add_f32 v33, v33, v41
    v_add_f32 v34, v34, v42
    v_add_f32 v35, v35, v43
    v_cvt_pk_bf16_f32 v36, v32, v33
    v_cvt_pk_bf16_f32 v37, v34, v35
    v_lshlrev_b32 v32, 16, v36
    v_and_b32 v33, 0xffff0000, v36
    v_lshlrev_b32 v34, 16, v37
    v_and_b32 v35, 0xffff0000, v37
    v_mul_f32 v32, v22, v32
    v_mul_f32 v33, v22, v33
    v_mul_f32 v34, v22, v34
    v_mul_f32 v35, v22, v35
    v_cvt_pk_bf16_f32 v36, v32, v33
    v_cvt_pk_bf16_f32 v37, v34, v35
    v_lshlrev_b32 v32, 16, v36
    v_and_b32 v33, 0xffff0000, v36
    v_lshlrev_b32 v34, 16, v37
    v_and_b32 v35, 0xffff0000, v37
    v_lshlrev_b32 v40, 16, v20
    v_and_b32 v41, 0xffff0000, v20
    v_lshlrev_b32 v42, 16, v21
    v_and_b32 v43, 0xffff0000, v21
    v_add_f32 v32, v32, v40
    v_add_f32 v33, v33, v41
    v_add_f32 v34, v34, v42
    v_add_f32 v35, v35, v43
    v_cvt_pk_bf16_f32 v24, v32, v33
    v_cvt_pk_bf16_f32 v25, v34, v35
    s_cmp_ge_u32 s16, 2
    s_cbranch_scc1 L_fl_52
    buffer_store_dwordx2 v[24:25], v4, s[12:15], s22 offen
L_fl_52:
    v_add_u32 v27, 4096, v27
    s_add_u32 s62, s62, s33
    s_add_u32 s22, s22, s34
    s_add_u32 s29, s29, 1
    s_cmp_lt_u32 s29, s28
    s_cbranch_scc1 L_fl_a
    v_mov_b32 v28, 69760
    ds_read_b32 v29, v28
    s_waitcnt lgkmcnt(0)
    v_readfirstlane_b32 s18, v29
    s_cmp_lt_u32 s18, 1055
    s_cbranch_scc1 L_ch_hend
    s_cmp_eq_u32 s92, 1
    s_cbranch_scc1 L_ch_done
    s_branch L_ch_hend
L_ch_done:
    s_endpgm
.section .rodata,"a"
.p2align 6
.amdhsa_kernel chain_kernel
  .amdhsa_next_free_vgpr 512
  .amdhsa_next_free_sgpr 102
  .amdhsa_accum_offset 256
  .amdhsa_group_segment_fixed_size 0
  .amdhsa_kernarg_size 120
  .amdhsa_user_sgpr_count 2
  .amdhsa_user_sgpr_kernarg_segment_ptr 1
  .amdhsa_system_sgpr_workgroup_id_x 1
.end_amdhsa_kernel
```
